```python
import torch

def _softmax(x, axis=-1):
    return torch.softmax(x, dim=axis)
def _gelu(x):
    return torch.nn.functional.gelu(x, approximate="tanh")
def _silu(x):
    return torch.nn.functional.silu(x)
def _sigmoid(x):
    return torch.sigmoid(x)
def _layernorm(x, axis=-1, eps=1e-5):
    m = x.mean(dim=axis, keepdim=True)
    v = x.var(dim=axis, keepdim=True, unbiased=False)
    return (x - m) / torch.sqrt(v + eps)
def _scatter_add(tgt, idx, src, axis=0):
    return tgt.clone().index_add_(axis, idx, src)
def _segment_sum(src, seg, n):
    out = torch.zeros((n,) + src.shape[1:], dtype=src.dtype)
    return out.index_add_(0, seg, src)
def _pad(x, pw):
    flat = tuple(v for pair in reversed(pw) for v in pair)
    return torch.nn.functional.pad(x, flat)

kernel_name = 'sequential_preLN__sliding_block__dense_activation_squared_relu__prompt'

def setup_inputs():

    _w = (lambda a: (lambda t: t.to(torch.bfloat16) if t.is_floating_point() else t)(torch.as_tensor(a)))
    def _A_setup():
        B, S, D = 1, 2048, 640
        return {
            "x": _w((lambda *s: torch.randn(*s, dtype=torch.bfloat16) * 0.05)(B, S, D)),
            "wqkv": _w((lambda *s: torch.randn(*s, dtype=torch.bfloat16) * 0.05)(D, 3 * D)),
            "wo": _w((lambda *s: torch.randn(*s, dtype=torch.bfloat16) * 0.05)(D, D)),
        }
    _A_in = _A_setup()

    def _B_setup():
        B, S, D, F = 1, 2048, 640, 1728
        return {
            "x": _w((lambda *s: torch.randn(*s, dtype=torch.bfloat16) * 0.05)(B, S, D)),
            "w1": _w((lambda *s: torch.randn(*s, dtype=torch.bfloat16) * 0.05)(D, F)),
            "b1": _w((lambda *s: torch.randn(*s, dtype=torch.bfloat16) * 0.4)(F)),
            "w2": _w((lambda *s: torch.randn(*s, dtype=torch.bfloat16) * 0.05)(F, D)),
            "b2": _w((lambda *s: torch.randn(*s, dtype=torch.bfloat16) * 3.2)(D)),
        }
    _B_in = _B_setup()

    return {
        "A_x": _A_in["x"],
        "A_wqkv": _A_in["wqkv"],
        "A_wo": _A_in["wo"],
        "B_x": _B_in["x"],
        "B_w1": _B_in["w1"],
        "B_b1": _B_in["b1"],
        "B_w2": _B_in["w2"],
        "B_b2": _B_in["b2"],
    }

def reference(A_x, A_wqkv, A_wo, B_x, B_w1, B_b1, B_w2, B_b2):
    def _A_ref(x, wqkv, wo):
        B, S, D = x.shape
        H = 32; Dh = D // H; W = 256
        qkv = (lambda x, *d: x.permute(*d))((x @ wqkv).reshape(B, S, 3, H, Dh), 2, 0, 3, 1, 4)
        q, k, v = qkv[0], qkv[1], qkv[2]
        scores = torch.einsum("bhqd,bhkd->bhqk", q, k) * (Dh ** -0.5)
        idx = torch.arange(S)
        mask = (idx[:, None] - idx[None, :] >= 0) & (idx[:, None] - idx[None, :] < W)
        scores = torch.where(mask[None, None], scores, -1e9)
        p = _softmax(scores, axis=-1)
        o = torch.einsum("bhqk,bhkd->bhqd", p, v)
        return (lambda x, *d: x.permute(*d))(o, 0, 2, 1, 3).reshape(B, S, D) @ wo

    def _B_ref(x, w1, b1, w2, b2):
        h = torch.einsum("bsd,df->bsf", x, w1) + b1
        zero = torch.zeros_like(h)
        r = torch.where(h > zero, h, zero)
        h = r * r
        out = torch.einsum("bsf,fd->bsd", h, w2) + b2
        return out

    x = A_x
    h = x + _A_ref(_layernorm(x, axis=-1), A_wqkv, A_wo)
    h2 = h + _B_ref(_layernorm(h, axis=-1), B_w1, B_b1, B_w2, B_b2)
    return h2
```

```asm
; @launch grid=(256,1,1) block=(256,1,1) lds=163840
.amdgcn_target "amdgcn-amd-amdhsa--gfx950"
.text
.globl sequential_preLN__sliding_block__dense_activation_squared_relu__prompt_kernel
.p2align 8
.type sequential_preLN__sliding_block__dense_activation_squared_relu__prompt_kernel,@function
sequential_preLN__sliding_block__dense_activation_squared_relu__prompt_kernel:
    s_cmp_ge_u32 s2, 256
    s_cbranch_scc1 L_end
    s_load_dwordx4 s[44:47], s[0:1], 0
    s_load_dwordx2 s[64:65], s[0:1], 80
    s_load_dwordx2 s[48:49], s[0:1], 16
    s_load_dwordx4 s[52:55], s[0:1], 32
    s_load_dwordx4 s[56:59], s[0:1], 48
    s_load_dwordx4 s[60:63], s[0:1], 64
    s_getpc_b64 s[66:67]
L_pc:
    s_lshr_b32 s68, s2, 3
    v_lshrrev_b32 v1, 6, v0
    v_and_b32 v0, 63, v0
    v_lshl_add_u32 v2, s68, 2, v1
    v_lshlrev_b32 v2, 2, v2
    v_add_u32 v2, v2, v0
    v_lshlrev_b32 v2, 7, v2
    v_min_u32 v2, L_codeend-L_pc, v2
    s_mov_b64 exec, 15
    global_load_dword v199, v2, s[66:67]
    s_mov_b64 exec, -1
    s_and_b32 s38, s2, 7
    v_readfirstlane_b32 s3, v1
    s_lshr_b32 s39, s2, 3
    s_mov_b32 s41, 0x3f803f80
    s_getreg_b32 s71, hwreg(HW_REG_XCC_ID, 0, 4)
    v_lshlrev_b32 v220, 4, v0
    s_mov_b32 s6, 2621440
    s_mov_b32 s7, 0x20000
    s_mov_b32 s10, 2457600
    s_mov_b32 s11, 0x20000
    s_mov_b32 s14, 819200
    s_mov_b32 s15, 0x20000
    s_mov_b32 s18, 2211840
    s_mov_b32 s19, 0x20000
    s_mov_b32 s22, 2211840
    s_mov_b32 s23, 0x20000
    s_mov_b32 s26, 268435456
    s_mov_b32 s27, 0x20000
    s_mov_b32 s30, 2621440
    s_mov_b32 s31, 0x20000
    s_and_b32 s67, s38, 1
    s_lshl_b32 s67, s67, 3
    s_and_b32 s68, s39, 7
    s_add_u32 s67, s67, s68
    s_cmp_eq_u32 s67, 15
    s_cbranch_scc1 L_idle1
    s_lshr_b32 s66, s38, 1
    s_lshl_b32 s66, s66, 2
    s_lshr_b32 s68, s39, 3
    s_add_u32 s66, s66, s68
    v_lshrrev_b32 v1, 3, v0
    v_and_b32 v2, 7, v0
    v_lshrrev_b32 v3, 4, v0
    s_lshl_b32 s68, s3, 5
    v_add_u32 v4, s68, v1
    v_add_u32 v5, 0, v4
    v_mul_u32_u24 v5, 1280, v5
    v_add_u32 v6, 0, v3
    v_and_b32 v6, 7, v6
    v_xor_b32 v6, v6, v2
    v_lshl_add_u32 v8, v6, 4, v5
    v_add_u32 v5, 8, v4
    v_mul_u32_u24 v5, 1280, v5
    v_add_u32 v6, 4, v3
    v_and_b32 v6, 7, v6
    v_xor_b32 v6, v6, v2
    v_lshl_add_u32 v9, v6, 4, v5
    v_add_u32 v5, 16, v4
    v_mul_u32_u24 v5, 1280, v5
    v_add_u32 v6, 8, v3
    v_and_b32 v6, 7, v6
    v_xor_b32 v6, v6, v2
    v_lshl_add_u32 v10, v6, 4, v5
    v_add_u32 v5, 24, v4
    v_mul_u32_u24 v5, 1280, v5
    v_add_u32 v6, 12, v3
    v_and_b32 v6, 7, v6
    v_xor_b32 v6, v6, v2
    v_lshl_add_u32 v11, v6, 4, v5
    v_and_b32 v2, 15, v0
    v_lshlrev_b32 v5, 2, v3
    v_sub_u32 v5, v2, v5
    v_and_b32 v5, 15, v5
    v_lshlrev_b32 v5, 4, v5
    s_lshl_b32 s68, s3, 4
    v_add_u32 v6, s68, v3
    v_add_u32 v7, 0, v6
    v_mul_u32_u24 v7, 3840, v7
    v_add_u32 v12, v7, v5
    v_add_u32 v7, 4, v6
    v_mul_u32_u24 v7, 3840, v7
    v_add_u32 v13, v7, v5
    v_add_u32 v7, 8, v6
    v_mul_u32_u24 v7, 3840, v7
    v_add_u32 v14, v7, v5
    v_add_u32 v7, 12, v6
    v_mul_u32_u24 v7, 3840, v7
    v_add_u32 v15, v7, v5
    s_waitcnt lgkmcnt(0)
    s_mov_b32 s4, s44
    s_mov_b32 s5, s45
    s_mov_b32 s8, s46
    s_mov_b32 s9, s47
    s_mov_b32 s12, s48
    s_mov_b32 s13, s49
    s_mov_b32 s16, s52
    s_mov_b32 s17, s53
    s_mov_b32 s32, s54
    s_mov_b32 s33, s55
    s_mov_b32 s20, s56
    s_mov_b32 s21, s57
    s_mov_b32 s34, s58
    s_mov_b32 s35, s59
    s_mov_b32 s28, s60
    s_mov_b32 s29, s61
    s_mov_b32 s36, s62
    s_mov_b32 s37, s63
    s_mov_b32 s24, s64
    s_mov_b32 s25, s65
    s_mov_b32 s44, s66
    s_mov_b32 s45, s67
    s_mul_i32 s48, s44, 163840
    s_lshl_b32 s49, s45, 8
    s_and_b32 s68, s44, 1
    s_mul_i32 s46, s68, 5
    s_lshr_b32 s68, s39, 3
    s_mul_i32 s46, s68, 3
    s_and_b32 s68, s39, 7
    s_mul_i32 s68, s68, 1
    s_add_u32 s46, s46, s68
    s_mul_hi_u32 s68, s46, 0x1999999a
    s_mul_i32 s68, s68, 10
    s_sub_u32 s46, s46, s68
    s_lshl_b32 s50, s3, 12
    s_lshl_b32 s51, s46, 7
    s_add_u32 s51, s51, s48
    s_mul_i32 s52, s46, 245760
    s_add_u32 s52, s52, s49
    s_add_u32 s46, s46, 1
    s_cmp_eq_u32 s46, 10
    s_cselect_b32 s46, 0, s46
    s_add_u32 m0, s50, 0
    s_nop 0
    buffer_load_dwordx4 v8, s[4:7], s51 offen lds
    s_add_u32 m0, s50, 16384
    s_nop 0
    buffer_load_dwordx4 v12, s[8:11], s52 offen lds
    s_add_u32 m0, s50, 1024
    s_nop 0
    buffer_load_dwordx4 v9, s[4:7], s51 offen lds
    s_add_u32 m0, s50, 17408
    s_nop 0
    buffer_load_dwordx4 v13, s[8:11], s52 offen lds
    s_add_u32 m0, s50, 2048
    s_nop 0
    buffer_load_dwordx4 v10, s[4:7], s51 offen lds
    s_add_u32 m0, s50, 18432
    s_nop 0
    buffer_load_dwordx4 v14, s[8:11], s52 offen lds
    s_add_u32 m0, s50, 3072
    s_nop 0
    buffer_load_dwordx4 v11, s[4:7], s51 offen lds
    s_add_u32 m0, s50, 19456
    s_nop 0
    buffer_load_dwordx4 v15, s[8:11], s52 offen lds
    s_add_u32 s50, s50, 32768
    s_and_b32 s50, s50, 0x1ffff
    s_lshl_b32 s51, s46, 7
    s_add_u32 s51, s51, s48
    s_mul_i32 s52, s46, 245760
    s_add_u32 s52, s52, s49
    s_add_u32 s46, s46, 1
    s_cmp_eq_u32 s46, 10
    s_cselect_b32 s46, 0, s46
    s_add_u32 m0, s50, 0
    s_nop 0
    buffer_load_dwordx4 v8, s[4:7], s51 offen lds
    s_add_u32 m0, s50, 16384
    s_nop 0
    buffer_load_dwordx4 v12, s[8:11], s52 offen lds
    s_add_u32 m0, s50, 1024
    s_nop 0
    buffer_load_dwordx4 v9, s[4:7], s51 offen lds
    s_add_u32 m0, s50, 17408
    s_nop 0
    buffer_load_dwordx4 v13, s[8:11], s52 offen lds
    s_add_u32 m0, s50, 2048
    s_nop 0
    buffer_load_dwordx4 v10, s[4:7], s51 offen lds
    s_add_u32 m0, s50, 18432
    s_nop 0
    buffer_load_dwordx4 v14, s[8:11], s52 offen lds
    s_add_u32 m0, s50, 3072
    s_nop 0
    buffer_load_dwordx4 v11, s[4:7], s51 offen lds
    s_add_u32 m0, s50, 19456
    s_nop 0
    buffer_load_dwordx4 v15, s[8:11], s52 offen lds
    s_add_u32 s50, s50, 32768
    s_and_b32 s50, s50, 0x1ffff
    s_lshl_b32 s60, s39, 2
    s_add_u32 s60, s60, s3
    s_cmp_ge_u32 s60, 55
    s_cbranch_scc1 L_sw_1
    s_lshl_b32 s61, s60, 7
    s_mov_b32 s62, s32
    s_mov_b32 s63, s33
    s_sub_u32 s64, s60, 27
    s_lshl_b32 s65, s64, 7
    s_cmp_ge_u32 s60, 27
    s_cselect_b32 s61, s65, s61
    s_cselect_b32 s62, s34, s62
    s_cselect_b32 s63, s35, s63
    s_sub_u32 s64, s60, 37
    s_lshl_b32 s65, s64, 21
    s_cmp_ge_u32 s60, 37
    s_cselect_b32 s61, s65, s61
    s_cselect_b32 s62, s28, s62
    s_cselect_b32 s63, s29, s63
    s_sub_u32 s64, s60, 39
    s_lshl_b32 s65, s64, 21
    s_add_u32 s65, s65, 0
    s_cmp_ge_u32 s60, 39
    s_cselect_b32 s61, s65, s61
    s_cselect_b32 s62, s24, s62
    s_cselect_b32 s63, s25, s63
    s_add_u32 s62, s62, s61
    s_addc_u32 s63, s63, 0
    s_load_dword s43, s[62:63], 0
L_sw_1:
    s_mul_hi_u32 s66, s45, 0x33333334
    s_mul_i32 s66, s66, 5
    s_sub_u32 s66, s45, s66
    s_lshl_b32 s66, s66, 11
    s_getpc_b64 s[68:69]
L_pc2:
    s_add_u32 s68, s68, L_qtab-L_pc2
    s_addc_u32 s69, s69, 0
    v_lshl_add_u32 v1, v0, 2, s66
    global_load_dword v226, v1, s[68:69] offset:0
    global_load_dword v227, v1, s[68:69] offset:256
    global_load_dword v228, v1, s[68:69] offset:512
    global_load_dword v229, v1, s[68:69] offset:768
    global_load_dword v230, v1, s[68:69] offset:1024
    global_load_dword v231, v1, s[68:69] offset:1280
    global_load_dword v232, v1, s[68:69] offset:1536
    global_load_dword v233, v1, s[68:69] offset:1792
    s_and_b32 s66, s3, 1
    s_lshr_b32 s67, s3, 1
    v_and_b32 v1, 31, v0
    v_lshrrev_b32 v2, 5, v0
    v_lshrrev_b32 v4, 1, v1
    v_and_b32 v4, 7, v4
    v_xor_b32 v4, v4, v2
    v_lshlrev_b32 v4, 4, v4
    s_xor_b32 s68, s67, 0
    s_lshl_b32 s68, s68, 5
    s_lshl_b32 s69, s66, 6
    s_add_u32 s68, s68, s69
    v_add_u32 v3, s68, v1
    v_lshl_add_u32 v16, v3, 7, v4
    v_xor_b32 v17, 32, v16
    v_xor_b32 v18, 64, v16
    v_xor_b32 v19, 0x60, v16
    s_xor_b32 s68, s67, 1
    s_lshl_b32 s68, s68, 5
    s_lshl_b32 s69, s66, 6
    s_add_u32 s68, s68, s69
    v_add_u32 v3, s68, v1
    v_lshl_add_u32 v20, v3, 7, v4
    v_xor_b32 v21, 32, v20
    v_xor_b32 v22, 64, v20
    v_xor_b32 v23, 0x60, v20
    v_lshrrev_b32 v1, 4, v0
    v_and_b32 v1, 1, v1
    v_bfe_u32 v3, v0, 2, 2
    v_and_b32 v4, 3, v0
    v_lshl_add_u32 v5, v2, 3, v3
    v_lshlrev_b32 v5, 8, v5
    v_and_b32 v6, 1, v4
    v_lshl_add_u32 v5, v6, 3, v5
    v_add_u32 v5, 16384, v5
    v_lshrrev_b32 v4, 1, v4
    v_lshl_add_u32 v4, v1, 1, v4
    v_lshl_add_u32 v4, v3, 2, v4
    s_xor_b32 s68, s66, 0
    s_lshl_b32 s69, s67, 1
    s_add_u32 s68, s68, s69
    s_lshl_b32 s68, s68, 2
    v_add_u32 v6, s68, v4
    v_and_b32 v6, 15, v6
    v_lshl_add_u32 v24, v6, 4, v5
    s_xor_b32 s68, s66, 1
    s_lshl_b32 s69, s67, 1
    s_add_u32 s68, s68, s69
    s_lshl_b32 s68, s68, 2
    v_add_u32 v6, s68, v4
    v_and_b32 v6, 15, v6
    v_lshl_add_u32 v25, v6, 4, v5
    v_mov_b32 v26, 0
    v_mov_b32 v27, 0
    v_mov_b32 v28, 0
    v_mov_b32 v29, 0
    v_mov_b32 v30, 0
    v_mov_b32 v31, 0
    v_add_u32 v176, 0x10000, v16
    v_add_u32 v177, 0x10000, v17
    v_add_u32 v178, 0x10000, v18
    v_add_u32 v179, 0x10000, v19
    v_add_u32 v180, 0x10000, v20
    v_add_u32 v181, 0x10000, v21
    v_add_u32 v182, 0x10000, v22
    v_add_u32 v183, 0x10000, v23
    v_add_u32 v184, 0x10000, v24
    v_add_u32 v185, 0x10000, v25
    s_lshl_b32 s50, s3, 12
    s_waitcnt vmcnt(16)
    s_barrier
    ds_read_b128 v[32:35], v16 offset:0
    ds_read_b64_tr_b16 v[128:129], v24 offset:0
    ds_read_b64_tr_b16 v[130:131], v24 offset:1024
    ds_read_b128 v[160:163], v20 offset:0
    ds_read_b64_tr_b16 v[168:169], v25 offset:0
    ds_read_b64_tr_b16 v[170:171], v25 offset:1024
    s_lshl_b32 s51, s46, 7
    s_add_u32 s51, s51, s48
    s_mul_i32 s52, s46, 245760
    s_add_u32 s52, s52, s49
    s_add_u32 s46, s46, 1
    s_cmp_eq_u32 s46, 10
    s_cselect_b32 s46, 0, s46
    s_add_u32 m0, s50, 65536
    s_nop 0
    buffer_load_dwordx4 v8, s[4:7], s51 offen lds
    s_add_u32 m0, s50, 81920
    s_nop 0
    buffer_load_dwordx4 v12, s[8:11], s52 offen lds
    s_add_u32 m0, s50, 66560
    s_nop 0
    buffer_load_dwordx4 v9, s[4:7], s51 offen lds
    s_add_u32 m0, s50, 82944
    s_nop 0
    buffer_load_dwordx4 v13, s[8:11], s52 offen lds
    s_waitcnt lgkmcnt(0)
    s_waitcnt lgkmcnt(3)
    v_mfma_f32_32x32x16_bf16 v[64:79], v[128:131], v[32:35], 0
    ds_read_b128 v[36:39], v17 offset:0
    ds_read_b64_tr_b16 v[132:133], v24 offset:4096
    ds_read_b64_tr_b16 v[134:135], v24 offset:5120
    s_waitcnt lgkmcnt(5)
    v_mfma_f32_32x32x16_bf16 v[80:95], v[128:131], v[160:163], 0
    ds_read_b128 v[164:167], v21 offset:0
    ds_read_b64_tr_b16 v[172:173], v25 offset:4096
    s_waitcnt lgkmcnt(5)
    s_add_u32 m0, s50, 67584
    v_mfma_f32_32x32x16_bf16 v[96:111], v[168:171], v[32:35], 0
    ds_read_b64_tr_b16 v[174:175], v25 offset:5120
    buffer_load_dwordx4 v10, s[4:7], s51 offen lds
    s_add_u32 m0, s50, 83968
    v_mfma_f32_32x32x16_bf16 v[112:127], v[168:171], v[160:163], 0
    buffer_load_dwordx4 v14, s[8:11], s52 offen lds
    s_waitcnt lgkmcnt(3)
    v_mfma_f32_32x32x16_bf16 v[64:79], v[132:135], v[36:39], v[64:79]
    ds_read_b128 v[40:43], v18 offset:0
    ds_read_b64_tr_b16 v[136:137], v24 offset:8192
    ds_read_b64_tr_b16 v[138:139], v24 offset:9216
    s_waitcnt lgkmcnt(5)
    v_mfma_f32_32x32x16_bf16 v[80:95], v[132:135], v[164:167], v[80:95]
    ds_read_b128 v[160:163], v22 offset:0
    ds_read_b64_tr_b16 v[168:169], v25 offset:8192
    s_waitcnt lgkmcnt(5)
    s_add_u32 m0, s50, 68608
    v_mfma_f32_32x32x16_bf16 v[96:111], v[172:175], v[36:39], v[96:111]
    ds_read_b64_tr_b16 v[170:171], v25 offset:9216
    buffer_load_dwordx4 v11, s[4:7], s51 offen lds
    s_add_u32 m0, s50, 84992
    v_mfma_f32_32x32x16_bf16 v[112:127], v[172:175], v[164:167], v[112:127]
    buffer_load_dwordx4 v15, s[8:11], s52 offen lds
    s_waitcnt vmcnt(16)
    s_barrier
    s_waitcnt vmcnt(8)
    s_mul_i32 s60, s3, 8704
    s_lshl_b32 s61, s3, 5
    v_and_b32 v1, 0xffff, v226
    v_bfe_u32 v2, v226, 16, 3
    v_mad_u32_u24 v1, v2, s61, v1
    v_lshlrev_b32 v234, 4, v1
    v_lshrrev_b32 v226, 19, v226
    v_lshl_add_u32 v226, v226, 4, s60
    v_and_b32 v1, 0xffff, v227
    v_bfe_u32 v2, v227, 16, 3
    v_mad_u32_u24 v1, v2, s61, v1
    v_lshlrev_b32 v235, 4, v1
    v_lshrrev_b32 v227, 19, v227
    v_lshl_add_u32 v227, v227, 4, s60
    v_and_b32 v1, 0xffff, v228
    v_bfe_u32 v2, v228, 16, 3
    v_mad_u32_u24 v1, v2, s61, v1
    v_lshlrev_b32 v236, 4, v1
    v_lshrrev_b32 v228, 19, v228
    v_lshl_add_u32 v228, v228, 4, s60
    v_and_b32 v1, 0xffff, v229
    v_bfe_u32 v2, v229, 16, 3
    v_mad_u32_u24 v1, v2, s61, v1
    v_lshlrev_b32 v237, 4, v1
    v_lshrrev_b32 v229, 19, v229
    v_lshl_add_u32 v229, v229, 4, s60
    v_and_b32 v1, 0xffff, v230
    v_bfe_u32 v2, v230, 16, 3
    v_mad_u32_u24 v1, v2, s61, v1
    v_lshlrev_b32 v238, 4, v1
    v_lshrrev_b32 v230, 19, v230
    v_lshl_add_u32 v230, v230, 4, s60
    v_and_b32 v1, 0xffff, v231
    v_bfe_u32 v2, v231, 16, 3
    v_mad_u32_u24 v1, v2, s61, v1
    v_lshlrev_b32 v239, 4, v1
    v_lshrrev_b32 v231, 19, v231
    v_lshl_add_u32 v231, v231, 4, s60
    v_and_b32 v1, 0xffff, v232
    v_bfe_u32 v2, v232, 16, 3
    v_mad_u32_u24 v1, v2, s61, v1
    v_lshlrev_b32 v240, 4, v1
    v_lshrrev_b32 v232, 19, v232
    v_lshl_add_u32 v232, v232, 4, s60
    v_and_b32 v1, 0xffff, v233
    v_bfe_u32 v2, v233, 16, 3
    v_mad_u32_u24 v1, v2, s61, v1
    v_lshlrev_b32 v241, 4, v1
    v_lshrrev_b32 v233, 19, v233
    v_lshl_add_u32 v233, v233, 4, s60
    s_lshl_b32 s51, s46, 7
    s_add_u32 s51, s51, s48
    s_mul_i32 s52, s46, 245760
    s_add_u32 s52, s52, s49
    s_add_u32 s46, s46, 1
    s_cmp_eq_u32 s46, 10
    s_cselect_b32 s46, 0, s46
    s_waitcnt lgkmcnt(3)
    v_mfma_f32_32x32x16_bf16 v[64:79], v[136:139], v[40:43], v[64:79]
    ds_read_b128 v[44:47], v19 offset:0
    ds_read_b64_tr_b16 v[140:141], v24 offset:12288
    ds_read_b64_tr_b16 v[142:143], v24 offset:13312
    s_waitcnt lgkmcnt(5)
    v_mfma_f32_32x32x16_bf16 v[80:95], v[136:139], v[160:163], v[80:95]
    ds_read_b128 v[164:167], v23 offset:0
    ds_read_b64_tr_b16 v[172:173], v25 offset:12288
    s_waitcnt lgkmcnt(5)
    s_add_u32 m0, s50, 98304
    v_mfma_f32_32x32x16_bf16 v[96:111], v[168:171], v[40:43], v[96:111]
    ds_read_b64_tr_b16 v[174:175], v25 offset:13312
    buffer_load_dwordx4 v8, s[4:7], s51 offen lds
    s_add_u32 m0, s50, 114688
    v_mfma_f32_32x32x16_bf16 v[112:127], v[168:171], v[160:163], v[112:127]
    buffer_load_dwordx4 v12, s[8:11], s52 offen lds
    s_waitcnt lgkmcnt(3)
    v_mfma_f32_32x32x16_bf16 v[64:79], v[140:143], v[44:47], v[64:79]
    ds_read_b128 v[48:51], v16 offset:32768
    ds_read_b64_tr_b16 v[144:145], v24 offset:32768
    ds_read_b64_tr_b16 v[146:147], v24 offset:33792
    s_waitcnt lgkmcnt(5)
    v_mfma_f32_32x32x16_bf16 v[80:95], v[140:143], v[164:167], v[80:95]
    ds_read_b128 v[160:163], v20 offset:32768
    ds_read_b64_tr_b16 v[168:169], v25 offset:32768
    s_waitcnt lgkmcnt(5)
    s_add_u32 m0, s50, 99328
    v_mfma_f32_32x32x16_bf16 v[96:111], v[172:175], v[44:47], v[96:111]
    ds_read_b64_tr_b16 v[170:171], v25 offset:33792
    buffer_load_dwordx4 v9, s[4:7], s51 offen lds
    s_add_u32 m0, s50, 115712
    v_mfma_f32_32x32x16_bf16 v[112:127], v[172:175], v[164:167], v[112:127]
    buffer_load_dwordx4 v13, s[8:11], s52 offen lds
    s_waitcnt lgkmcnt(3)
    v_mfma_f32_32x32x16_bf16 v[64:79], v[144:147], v[48:51], v[64:79]
    ds_read_b128 v[52:55], v17 offset:32768
    ds_read_b64_tr_b16 v[148:149], v24 offset:36864
    ds_read_b64_tr_b16 v[150:151], v24 offset:37888
    s_waitcnt lgkmcnt(5)
    v_mfma_f32_32x32x16_bf16 v[80:95], v[144:147], v[160:163], v[80:95]
    ds_read_b128 v[164:167], v21 offset:32768
    ds_read_b64_tr_b16 v[172:173], v25 offset:36864
    s_waitcnt lgkmcnt(5)
    s_add_u32 m0, s50, 100352
    v_mfma_f32_32x32x16_bf16 v[96:111], v[168:171], v[48:51], v[96:111]
    ds_read_b64_tr_b16 v[174:175], v25 offset:37888
    buffer_load_dwordx4 v10, s[4:7], s51 offen lds
    s_add_u32 m0, s50, 116736
    v_mfma_f32_32x32x16_bf16 v[112:127], v[168:171], v[160:163], v[112:127]
    buffer_load_dwordx4 v14, s[8:11], s52 offen lds
    s_waitcnt lgkmcnt(3)
    v_mfma_f32_32x32x16_bf16 v[64:79], v[148:151], v[52:55], v[64:79]
    ds_read_b128 v[56:59], v18 offset:32768
    ds_read_b64_tr_b16 v[152:153], v24 offset:40960
    ds_read_b64_tr_b16 v[154:155], v24 offset:41984
    s_waitcnt lgkmcnt(5)
    v_mfma_f32_32x32x16_bf16 v[80:95], v[148:151], v[164:167], v[80:95]
    ds_read_b128 v[160:163], v22 offset:32768
    ds_read_b64_tr_b16 v[168:169], v25 offset:40960
    s_waitcnt lgkmcnt(5)
    s_add_u32 m0, s50, 101376
    v_mfma_f32_32x32x16_bf16 v[96:111], v[172:175], v[52:55], v[96:111]
    ds_read_b64_tr_b16 v[170:171], v25 offset:41984
    buffer_load_dwordx4 v11, s[4:7], s51 offen lds
    s_add_u32 m0, s50, 117760
    v_mfma_f32_32x32x16_bf16 v[112:127], v[172:175], v[164:167], v[112:127]
    buffer_load_dwordx4 v15, s[8:11], s52 offen lds
    s_waitcnt vmcnt(8)
    s_barrier
    s_lshl_b32 s66, s38, 5
    s_add_u32 s83, s66, s39
    s_lshr_b32 s53, s83, 4
    s_and_b32 s54, s83, 15
    s_lshr_b32 s55, s83, 3
    s_and_b32 s56, s83, 7
    s_and_b32 s57, s56, 1
    s_mul_i32 s66, s54, 7
    s_mul_i32 s67, s54, 6
    s_add_u32 s67, s67, 12
    s_cmp_lt_u32 s54, 12
    s_cselect_b32 s58, s66, s67
    s_cselect_b32 s66, 1, 0
    s_and_b32 s59, s66, s54
    s_mov_b32 s60, 0
    s_mov_b32 s61, s55
    s_mov_b32 s62, 1
    s_cmp_eq_u32 s3, 1
    s_cbranch_scc1 L_j1_2
    s_cmp_eq_u32 s3, 2
    s_cbranch_scc1 L_j2_3
    s_cmp_eq_u32 s3, 3
    s_cbranch_scc1 L_j3_4
    s_branch L_jd_5
L_j1_2:
    s_add_u32 s63, s55, 32
    s_cmp_lt_u32 s55, 22
    s_cselect_b32 s61, s63, s61
    s_cbranch_scc1 L_jd_5
    s_cmp_ge_u32 s53, 12
    s_cselect_b32 s62, 1, 0
    s_cbranch_scc0 L_jd_5
    s_mov_b32 s60, 2
    s_add_u32 s61, s53, 4
    s_branch L_jd_5
L_j2_3:
    s_cmp_lt_u32 s55, 20
    s_cselect_b32 s62, 1, 0
    s_cselect_b32 s60, 1, 0
    s_branch L_jd_5
L_j3_4:
    s_mov_b32 s60, 2
    s_mov_b32 s61, s53
L_jd_5:
    s_cmp_eq_u32 s60, 1
    s_cselect_b32 s72, s12, s20
    s_cselect_b32 s73, s13, s21
    s_cselect_b32 s74, s14, s22
    s_cselect_b32 s64, 20, 54
    s_mov_b32 s63, 27262976
    s_cselect_b32 s63, 23068672, s63
    s_cmp_eq_u32 s60, 2
    s_cselect_b32 s72, s16, s72
    s_cselect_b32 s73, s17, s73
    s_cselect_b32 s74, s18, s74
    s_mov_b32 s75, 0x20000
    s_cselect_b32 s63, 24117248, s63
    s_cselect_b32 s64, 20, s64
    s_cselect_b32 s66, s54, s56
    s_cselect_b32 s68, s59, s57
    s_cselect_b32 s80, 2, 0
    s_mov_b32 s65, 1280
    s_cselect_b32 s65, 3456, s65
    s_mov_b32 s67, 5120
    s_cselect_b32 s67, 7168, s67
    s_mov_b32 s78, 0x03ff03ff
    s_cselect_b32 s78, 0x3fff3fff, s78
    s_mov_b32 s79, 0x03ff03ff
    s_cselect_b32 s79, 0x3fff3fff, s79
    s_or_b32 s80, s80, s62
    s_mul_i32 s66, s66, s64
    s_add_u32 s66, s66, s61
    s_mul_i32 s66, s66, s67
    s_add_u32 s77, s66, s63
    s_mul_i32 s66, s61, s65
    s_lshl_b32 s66, s66, 5
    s_lshl_b32 s67, s58, 5
    s_mul_i32 s63, s56, 160
    s_cmp_eq_u32 s60, 2
    s_cselect_b32 s67, s67, s63
    s_add_u32 s76, s66, s67
    v_lshrrev_b32 v1, 4, v0
    v_and_b32 v2, 15, v0
    v_mul_u32_u24 v3, s65, v1
    v_lshl_add_u32 v221, v2, 4, v3
    v_bfe_u32 v2, v0, 2, 2
    v_and_b32 v3, 3, v0
    v_lshlrev_b32 v3, 3, v3
    v_lshl_add_u32 v3, v2, 8, v3
    s_lshl_b32 s66, s3, 13
    s_add_u32 s66, s66, 131072
    v_add_u32 v3, s66, v3
    v_and_b32 v4, 1, v1
    v_lshlrev_b32 v4, 5, v4
    v_lshl_add_u32 v4, v1, 10, v4
    v_lshlrev_b32 v5, 11, v1
    s_cmp_eq_u32 s60, 1
    s_cselect_b64 vcc, -1, 0
    s_mov_b32 s66, 4096
    s_cselect_b32 s66, 1056, s66
    v_cndmask_b32 v4, v4, v5, vcc
    v_add_u32 v3, v3, v4
    s_lshl_b32 s67, s68, 5
    v_add_u32 v222, s67, v3
    v_add_u32 v223, s66, v222
    s_cmp_eq_u32 s60, 2
    s_mov_b32 s67, 128
    s_cselect_b32 s67, 192, s67
    s_cmp_eq_u32 s68, 0
    s_cselect_b32 s67, s67, 0
    v_add_u32 v224, s67, v3
    v_add_u32 v225, s66, v224
    s_mul_i32 s60, s44, 15
    s_add_u32 s60, s60, s45
    s_lshl_b32 s60, s60, 6
    s_lshl_b32 s61, s83, 6
    v_mov_b32 v1, 81920
    v_mul_u32_u24 v2, 16384, v0
    v_cmp_eq_u32 vcc, 4, v0
    s_nop 1
    v_cndmask_b32 v2, v2, v1, vcc
    v_add_u32 v2, s61, v2
    v_mov_b32 v1, s60
    v_cmp_eq_u32 vcc, 0, v0
    s_nop 1
    v_cndmask_b32 v2, v2, v1, vcc
    s_mov_b64 exec, 0x1f
    buffer_load_dword v199, v2, s[24:27], 0 offen sc1
    s_mov_b64 exec, -1
    v_dot2c_f32_bf16 v26, s41, v32
    v_dot2c_f32_bf16 v28, v32, v32
    v_dot2c_f32_bf16 v30, s41, v128
    v_dot2c_f32_bf16 v27, s41, v33
    v_dot2c_f32_bf16 v29, v33, v33
    v_dot2c_f32_bf16 v31, s41, v129
    v_dot2c_f32_bf16 v26, s41, v34
    v_dot2c_f32_bf16 v28, v34, v34
    v_dot2c_f32_bf16 v30, s41, v130
    v_dot2c_f32_bf16 v27, s41, v35
    v_dot2c_f32_bf16 v29, v35, v35
    v_dot2c_f32_bf16 v31, s41, v131
    v_dot2c_f32_bf16 v26, s41, v36
    v_dot2c_f32_bf16 v28, v36, v36
    v_dot2c_f32_bf16 v30, s41, v132
    v_dot2c_f32_bf16 v27, s41, v37
    v_dot2c_f32_bf16 v29, v37, v37
    v_dot2c_f32_bf16 v31, s41, v133
    v_dot2c_f32_bf16 v26, s41, v38
    v_dot2c_f32_bf16 v28, v38, v38
    v_dot2c_f32_bf16 v30, s41, v134
    v_dot2c_f32_bf16 v27, s41, v39
    v_dot2c_f32_bf16 v29, v39, v39
    v_dot2c_f32_bf16 v31, s41, v135
    v_dot2c_f32_bf16 v26, s41, v40
    v_dot2c_f32_bf16 v28, v40, v40
    v_dot2c_f32_bf16 v30, s41, v136
    v_dot2c_f32_bf16 v27, s41, v41
    v_dot2c_f32_bf16 v29, v41, v41
    v_dot2c_f32_bf16 v31, s41, v137
    v_dot2c_f32_bf16 v26, s41, v42
    v_dot2c_f32_bf16 v28, v42, v42
    v_dot2c_f32_bf16 v30, s41, v138
    v_dot2c_f32_bf16 v27, s41, v43
    v_dot2c_f32_bf16 v29, v43, v43
    v_dot2c_f32_bf16 v31, s41, v139
    v_dot2c_f32_bf16 v26, s41, v44
    v_dot2c_f32_bf16 v28, v44, v44
    v_dot2c_f32_bf16 v30, s41, v140
    v_dot2c_f32_bf16 v27, s41, v45
    v_dot2c_f32_bf16 v29, v45, v45
    v_dot2c_f32_bf16 v31, s41, v141
    v_dot2c_f32_bf16 v26, s41, v46
    v_dot2c_f32_bf16 v28, v46, v46
    v_dot2c_f32_bf16 v30, s41, v142
    v_dot2c_f32_bf16 v27, s41, v47
    v_dot2c_f32_bf16 v29, v47, v47
    v_dot2c_f32_bf16 v31, s41, v143
    s_lshl_b32 s51, s46, 7
    s_add_u32 s51, s51, s48
    s_mul_i32 s52, s46, 245760
    s_add_u32 s52, s52, s49
    s_add_u32 s46, s46, 1
    s_cmp_eq_u32 s46, 10
    s_cselect_b32 s46, 0, s46
    s_waitcnt lgkmcnt(3)
    v_mfma_f32_32x32x16_bf16 v[64:79], v[152:155], v[56:59], v[64:79]
    ds_read_b128 v[60:63], v19 offset:32768
    ds_read_b64_tr_b16 v[156:157], v24 offset:45056
    ds_read_b64_tr_b16 v[158:159], v24 offset:46080
    s_waitcnt lgkmcnt(5)
    v_mfma_f32_32x32x16_bf16 v[80:95], v[152:155], v[160:163], v[80:95]
    ds_read_b128 v[164:167], v23 offset:32768
    ds_read_b64_tr_b16 v[172:173], v25 offset:45056
    s_waitcnt lgkmcnt(5)
    s_add_u32 m0, s50, 0
    v_mfma_f32_32x32x16_bf16 v[96:111], v[168:171], v[56:59], v[96:111]
    ds_read_b64_tr_b16 v[174:175], v25 offset:46080
    buffer_load_dwordx4 v8, s[4:7], s51 offen lds
    s_add_u32 m0, s50, 16384
    v_mfma_f32_32x32x16_bf16 v[112:127], v[168:171], v[160:163], v[112:127]
    buffer_load_dwordx4 v12, s[8:11], s52 offen lds
    s_waitcnt lgkmcnt(3)
    v_mfma_f32_32x32x16_bf16 v[64:79], v[156:159], v[60:63], v[64:79]
    ds_read_b128 v[32:35], v176 offset:0
    ds_read_b64_tr_b16 v[128:129], v184 offset:0
    ds_read_b64_tr_b16 v[130:131], v184 offset:1024
    s_waitcnt lgkmcnt(5)
    v_mfma_f32_32x32x16_bf16 v[80:95], v[156:159], v[164:167], v[80:95]
    ds_read_b128 v[160:163], v180 offset:0
    ds_read_b64_tr_b16 v[168:169], v185 offset:0
    s_waitcnt lgkmcnt(5)
    s_add_u32 m0, s50, 1024
    v_mfma_f32_32x32x16_bf16 v[96:111], v[172:175], v[60:63], v[96:111]
    ds_read_b64_tr_b16 v[170:171], v185 offset:1024
    buffer_load_dwordx4 v9, s[4:7], s51 offen lds
    s_add_u32 m0, s50, 17408
    v_mfma_f32_32x32x16_bf16 v[112:127], v[172:175], v[164:167], v[112:127]
    buffer_load_dwordx4 v13, s[8:11], s52 offen lds
    s_waitcnt lgkmcnt(3)
    v_mfma_f32_32x32x16_bf16 v[64:79], v[128:131], v[32:35], v[64:79]
    ds_read_b128 v[36:39], v177 offset:0
    ds_read_b64_tr_b16 v[132:133], v184 offset:4096
    ds_read_b64_tr_b16 v[134:135], v184 offset:5120
    s_waitcnt lgkmcnt(5)
    v_mfma_f32_32x32x16_bf16 v[80:95], v[128:131], v[160:163], v[80:95]
    ds_read_b128 v[164:167], v181 offset:0
    ds_read_b64_tr_b16 v[172:173], v185 offset:4096
    s_waitcnt lgkmcnt(5)
    s_add_u32 m0, s50, 2048
    v_mfma_f32_32x32x16_bf16 v[96:111], v[168:171], v[32:35], v[96:111]
    ds_read_b64_tr_b16 v[174:175], v185 offset:5120
    buffer_load_dwordx4 v10, s[4:7], s51 offen lds
    s_add_u32 m0, s50, 18432
    v_mfma_f32_32x32x16_bf16 v[112:127], v[168:171], v[160:163], v[112:127]
    buffer_load_dwordx4 v14, s[8:11], s52 offen lds
    s_waitcnt lgkmcnt(3)
    v_mfma_f32_32x32x16_bf16 v[64:79], v[132:135], v[36:39], v[64:79]
    ds_read_b128 v[40:43], v178 offset:0
    ds_read_b64_tr_b16 v[136:137], v184 offset:8192
    ds_read_b64_tr_b16 v[138:139], v184 offset:9216
    s_waitcnt lgkmcnt(5)
    v_mfma_f32_32x32x16_bf16 v[80:95], v[132:135], v[164:167], v[80:95]
    ds_read_b128 v[160:163], v182 offset:0
    ds_read_b64_tr_b16 v[168:169], v185 offset:8192
    s_waitcnt lgkmcnt(5)
    s_add_u32 m0, s50, 3072
    v_mfma_f32_32x32x16_bf16 v[96:111], v[172:175], v[36:39], v[96:111]
    ds_read_b64_tr_b16 v[170:171], v185 offset:9216
    buffer_load_dwordx4 v11, s[4:7], s51 offen lds
    s_add_u32 m0, s50, 19456
    v_mfma_f32_32x32x16_bf16 v[112:127], v[172:175], v[164:167], v[112:127]
    buffer_load_dwordx4 v15, s[8:11], s52 offen lds
    s_waitcnt vmcnt(9)
    s_barrier
    v_cmp_le_u32 vcc, 2, v0
    s_nop 1
    v_cndmask_b32 v1, 0, 1, vcc
    v_cmp_le_u32 vcc, 8, v0
    s_nop 1
    v_cndmask_b32 v2, 0, 1, vcc
    v_add_u32 v3, v1, v2
    v_mul_u32_u24 v4, 6, v2
    v_sub_u32 v4, v0, v4
    v_subrev_u32 v4, 2, v4
    v_lshrrev_b32 v4, 1, v4
    v_mul_u32_u24 v4, v4, v1
    v_and_b32 v4, 3, v4
    v_sub_u32 v5, s53, v4
    v_cmp_gt_i32 vcc, 0, v5
    v_mov_b32 v6, s53
    s_nop 0
    v_cndmask_b32 v5, v5, v6, vcc
    v_and_b32 v6, 1, v0
    v_lshlrev_b32 v6, 2, v6
    s_mul_i32 s66, s54, 5
    v_add_u32 v6, s66, v6
    v_lshrrev_b32 v6, 4, v6
    v_mul_u32_u24 v3, 5, v3
    v_add_u32 v6, v6, v3
    v_mul_u32_u24 v5, 15, v5
    v_add_u32 v5, v5, v6
    v_lshlrev_b32 v5, 6, v5
    v_add_u32 v192, 0, v5
    v_and_b32 v1, 31, v0
    v_lshl_add_u32 v2, v1, 3, s56
    s_lshl_b32 s66, s38, 5
    v_add_u32 v3, s66, v1
    v_cmp_gt_u32 vcc, 32, v0
    s_nop 1
    v_cndmask_b32 v2, v3, v2, vcc
    v_lshlrev_b32 v2, 6, v2
    v_add_u32 v193, 81920, v2
    s_mul_hi_u32 s66, s54, 0x55555556
    s_mul_i32 s67, s66, 3
    s_cmp_eq_u32 s67, s54
    s_cselect_b32 s60, s66, 5
    s_cmp_eq_u32 s60, 0
    s_cselect_b32 s60, 5, s60
    s_cmp_eq_u32 s54, 15
    s_cselect_b32 s60, 5, s60
    s_lshl_b32 s61, s60, 4
    s_sub_u32 s62, 80, s61
    s_lshl_b32 s63, s60, 11
    s_sub_u32 s63, s63, s61
    v_mul_u32_u24 v2, 205, v0
    v_lshrrev_b32 v2, 10, v2
    v_mul_u32_u24 v3, 5, v2
    v_sub_u32 v3, v0, v3
    v_cmp_gt_u32 vcc, s60, v3
    v_mov_b32 v5, s61
    v_mov_b32 v6, s62
    v_cndmask_b32 v195, v6, v5, vcc
    v_mov_b32 v5, s63
    v_cndmask_b32 v5, v5, 0, vcc
    v_lshl_add_u32 v5, v3, 4, v5
    v_mad_u32_u24 v194, v2, v195, v5
    v_mul_u32_u24 v2, 43, v0
    v_lshrrev_b32 v2, 8, v2
    v_mul_u32_u24 v3, 6, v2
    v_sub_u32 v3, v0, v3
    v_cmp_gt_u32 vcc, s60, v3
    v_mov_b32 v5, s61
    v_mov_b32 v6, s62
    v_cndmask_b32 v197, v6, v5, vcc
    v_mov_b32 v5, s63
    v_cndmask_b32 v5, v5, 0, vcc
    v_lshl_add_u32 v5, v3, 4, v5
    v_mad_u32_u24 v196, v2, v197, v5
    v_dot2c_f32_bf16 v26, s41, v48
    v_dot2c_f32_bf16 v28, v48, v48
    v_dot2c_f32_bf16 v30, s41, v144
    v_dot2c_f32_bf16 v27, s41, v49
    v_dot2c_f32_bf16 v29, v49, v49
    v_dot2c_f32_bf16 v31, s41, v145
    v_dot2c_f32_bf16 v26, s41, v50
    v_dot2c_f32_bf16 v28, v50, v50
    v_dot2c_f32_bf16 v30, s41, v146
    v_dot2c_f32_bf16 v27, s41, v51
    v_dot2c_f32_bf16 v29, v51, v51
    v_dot2c_f32_bf16 v31, s41, v147
    v_dot2c_f32_bf16 v26, s41, v52
    v_dot2c_f32_bf16 v28, v52, v52
    v_dot2c_f32_bf16 v30, s41, v148
    v_dot2c_f32_bf16 v27, s41, v53
    v_dot2c_f32_bf16 v29, v53, v53
    v_dot2c_f32_bf16 v31, s41, v149
    v_dot2c_f32_bf16 v26, s41, v54
    v_dot2c_f32_bf16 v28, v54, v54
    v_dot2c_f32_bf16 v30, s41, v150
    v_dot2c_f32_bf16 v27, s41, v55
    v_dot2c_f32_bf16 v29, v55, v55
    v_dot2c_f32_bf16 v31, s41, v151
    v_dot2c_f32_bf16 v26, s41, v56
    v_dot2c_f32_bf16 v28, v56, v56
    v_dot2c_f32_bf16 v30, s41, v152
    v_dot2c_f32_bf16 v27, s41, v57
    v_dot2c_f32_bf16 v29, v57, v57
    v_dot2c_f32_bf16 v31, s41, v153
    v_dot2c_f32_bf16 v26, s41, v58
    v_dot2c_f32_bf16 v28, v58, v58
    v_dot2c_f32_bf16 v30, s41, v154
    v_dot2c_f32_bf16 v27, s41, v59
    v_dot2c_f32_bf16 v29, v59, v59
    v_dot2c_f32_bf16 v31, s41, v155
    v_dot2c_f32_bf16 v26, s41, v60
    v_dot2c_f32_bf16 v28, v60, v60
    v_dot2c_f32_bf16 v30, s41, v156
    v_dot2c_f32_bf16 v27, s41, v61
    v_dot2c_f32_bf16 v29, v61, v61
    v_dot2c_f32_bf16 v31, s41, v157
    v_dot2c_f32_bf16 v26, s41, v62
    v_dot2c_f32_bf16 v28, v62, v62
    v_dot2c_f32_bf16 v30, s41, v158
    v_dot2c_f32_bf16 v27, s41, v63
    v_dot2c_f32_bf16 v29, v63, v63
    v_dot2c_f32_bf16 v31, s41, v159
    s_lshl_b32 s51, s46, 7
    s_add_u32 s51, s51, s48
    s_mul_i32 s52, s46, 245760
    s_add_u32 s52, s52, s49
    s_add_u32 s46, s46, 1
    s_cmp_eq_u32 s46, 10
    s_cselect_b32 s46, 0, s46
    s_waitcnt lgkmcnt(3)
    v_mfma_f32_32x32x16_bf16 v[64:79], v[136:139], v[40:43], v[64:79]
    ds_read_b128 v[44:47], v179 offset:0
    ds_read_b64_tr_b16 v[140:141], v184 offset:12288
    ds_read_b64_tr_b16 v[142:143], v184 offset:13312
    s_waitcnt lgkmcnt(5)
    v_mfma_f32_32x32x16_bf16 v[80:95], v[136:139], v[160:163], v[80:95]
    ds_read_b128 v[164:167], v183 offset:0
    ds_read_b64_tr_b16 v[172:173], v185 offset:12288
    s_waitcnt lgkmcnt(5)
    s_add_u32 m0, s50, 32768
    v_mfma_f32_32x32x16_bf16 v[96:111], v[168:171], v[40:43], v[96:111]
    ds_read_b64_tr_b16 v[174:175], v185 offset:13312
    buffer_load_dwordx4 v8, s[4:7], s51 offen lds
    s_add_u32 m0, s50, 49152
    v_mfma_f32_32x32x16_bf16 v[112:127], v[168:171], v[160:163], v[112:127]
    buffer_load_dwordx4 v12, s[8:11], s52 offen lds
    s_waitcnt lgkmcnt(3)
    v_mfma_f32_32x32x16_bf16 v[64:79], v[140:143], v[44:47], v[64:79]
    ds_read_b128 v[48:51], v176 offset:32768
    ds_read_b64_tr_b16 v[144:145], v184 offset:32768
    ds_read_b64_tr_b16 v[146:147], v184 offset:33792
    s_waitcnt lgkmcnt(5)
    v_mfma_f32_32x32x16_bf16 v[80:95], v[140:143], v[164:167], v[80:95]
    ds_read_b128 v[160:163], v180 offset:32768
    ds_read_b64_tr_b16 v[168:169], v185 offset:32768
    s_waitcnt lgkmcnt(5)
    s_add_u32 m0, s50, 33792
    v_mfma_f32_32x32x16_bf16 v[96:111], v[172:175], v[44:47], v[96:111]
    ds_read_b64_tr_b16 v[170:171], v185 offset:33792
    buffer_load_dwordx4 v9, s[4:7], s51 offen lds
    s_add_u32 m0, s50, 50176
    v_mfma_f32_32x32x16_bf16 v[112:127], v[172:175], v[164:167], v[112:127]
    buffer_load_dwordx4 v13, s[8:11], s52 offen lds
    s_waitcnt lgkmcnt(3)
    v_mfma_f32_32x32x16_bf16 v[64:79], v[144:147], v[48:51], v[64:79]
    ds_read_b128 v[52:55], v177 offset:32768
    ds_read_b64_tr_b16 v[148:149], v184 offset:36864
    ds_read_b64_tr_b16 v[150:151], v184 offset:37888
    s_waitcnt lgkmcnt(5)
    v_mfma_f32_32x32x16_bf16 v[80:95], v[144:147], v[160:163], v[80:95]
    ds_read_b128 v[164:167], v181 offset:32768
    ds_read_b64_tr_b16 v[172:173], v185 offset:36864
    s_waitcnt lgkmcnt(5)
    s_add_u32 m0, s50, 34816
    v_mfma_f32_32x32x16_bf16 v[96:111], v[168:171], v[48:51], v[96:111]
    ds_read_b64_tr_b16 v[174:175], v185 offset:37888
    buffer_load_dwordx4 v10, s[4:7], s51 offen lds
    s_add_u32 m0, s50, 51200
    v_mfma_f32_32x32x16_bf16 v[112:127], v[168:171], v[160:163], v[112:127]
    buffer_load_dwordx4 v14, s[8:11], s52 offen lds
    s_waitcnt lgkmcnt(3)
    v_mfma_f32_32x32x16_bf16 v[64:79], v[148:151], v[52:55], v[64:79]
    ds_read_b128 v[56:59], v178 offset:32768
    ds_read_b64_tr_b16 v[152:153], v184 offset:40960
    ds_read_b64_tr_b16 v[154:155], v184 offset:41984
    s_waitcnt lgkmcnt(5)
    v_mfma_f32_32x32x16_bf16 v[80:95], v[148:151], v[164:167], v[80:95]
    ds_read_b128 v[160:163], v182 offset:32768
    ds_read_b64_tr_b16 v[168:169], v185 offset:40960
    s_waitcnt lgkmcnt(5)
    s_add_u32 m0, s50, 35840
    v_mfma_f32_32x32x16_bf16 v[96:111], v[172:175], v[52:55], v[96:111]
    ds_read_b64_tr_b16 v[170:171], v185 offset:41984
    buffer_load_dwordx4 v11, s[4:7], s51 offen lds
    s_add_u32 m0, s50, 52224
    v_mfma_f32_32x32x16_bf16 v[112:127], v[172:175], v[164:167], v[112:127]
    buffer_load_dwordx4 v15, s[8:11], s52 offen lds
    s_waitcnt vmcnt(8)
    s_barrier
    v_dot2c_f32_bf16 v26, s41, v32
    v_dot2c_f32_bf16 v28, v32, v32
    v_dot2c_f32_bf16 v30, s41, v128
    v_dot2c_f32_bf16 v27, s41, v33
    v_dot2c_f32_bf16 v29, v33, v33
    v_dot2c_f32_bf16 v31, s41, v129
    v_dot2c_f32_bf16 v26, s41, v34
    v_dot2c_f32_bf16 v28, v34, v34
    v_dot2c_f32_bf16 v30, s41, v130
    v_dot2c_f32_bf16 v27, s41, v35
    v_dot2c_f32_bf16 v29, v35, v35
    v_dot2c_f32_bf16 v31, s41, v131
    v_dot2c_f32_bf16 v26, s41, v36
    v_dot2c_f32_bf16 v28, v36, v36
    v_dot2c_f32_bf16 v30, s41, v132
    v_dot2c_f32_bf16 v27, s41, v37
    v_dot2c_f32_bf16 v29, v37, v37
    v_dot2c_f32_bf16 v31, s41, v133
    v_dot2c_f32_bf16 v26, s41, v38
    v_dot2c_f32_bf16 v28, v38, v38
    v_dot2c_f32_bf16 v30, s41, v134
    v_dot2c_f32_bf16 v27, s41, v39
    v_dot2c_f32_bf16 v29, v39, v39
    v_dot2c_f32_bf16 v31, s41, v135
    v_dot2c_f32_bf16 v26, s41, v40
    v_dot2c_f32_bf16 v28, v40, v40
    v_dot2c_f32_bf16 v30, s41, v136
    v_dot2c_f32_bf16 v27, s41, v41
    v_dot2c_f32_bf16 v29, v41, v41
    v_dot2c_f32_bf16 v31, s41, v137
    v_dot2c_f32_bf16 v26, s41, v42
    v_dot2c_f32_bf16 v28, v42, v42
    v_dot2c_f32_bf16 v30, s41, v138
    v_dot2c_f32_bf16 v27, s41, v43
    v_dot2c_f32_bf16 v29, v43, v43
    v_dot2c_f32_bf16 v31, s41, v139
    v_dot2c_f32_bf16 v26, s41, v44
    v_dot2c_f32_bf16 v28, v44, v44
    v_dot2c_f32_bf16 v30, s41, v140
    v_dot2c_f32_bf16 v27, s41, v45
    v_dot2c_f32_bf16 v29, v45, v45
    v_dot2c_f32_bf16 v31, s41, v141
    v_dot2c_f32_bf16 v26, s41, v46
    v_dot2c_f32_bf16 v28, v46, v46
    v_dot2c_f32_bf16 v30, s41, v142
    v_dot2c_f32_bf16 v27, s41, v47
    v_dot2c_f32_bf16 v29, v47, v47
    v_dot2c_f32_bf16 v31, s41, v143
    s_lshl_b32 s51, s46, 7
    s_add_u32 s51, s51, s48
    s_mul_i32 s52, s46, 245760
    s_add_u32 s52, s52, s49
    s_add_u32 s46, s46, 1
    s_cmp_eq_u32 s46, 10
    s_cselect_b32 s46, 0, s46
    s_waitcnt lgkmcnt(3)
    v_mfma_f32_32x32x16_bf16 v[64:79], v[152:155], v[56:59], v[64:79]
    ds_read_b128 v[60:63], v179 offset:32768
    ds_read_b64_tr_b16 v[156:157], v184 offset:45056
    ds_read_b64_tr_b16 v[158:159], v184 offset:46080
    s_waitcnt lgkmcnt(5)
    v_mfma_f32_32x32x16_bf16 v[80:95], v[152:155], v[160:163], v[80:95]
    ds_read_b128 v[164:167], v183 offset:32768
    ds_read_b64_tr_b16 v[172:173], v185 offset:45056
    s_waitcnt lgkmcnt(5)
    s_add_u32 m0, s50, 65536
    v_mfma_f32_32x32x16_bf16 v[96:111], v[168:171], v[56:59], v[96:111]
    ds_read_b64_tr_b16 v[174:175], v185 offset:46080
    buffer_load_dwordx4 v8, s[4:7], s51 offen lds
    s_add_u32 m0, s50, 81920
    v_mfma_f32_32x32x16_bf16 v[112:127], v[168:171], v[160:163], v[112:127]
    buffer_load_dwordx4 v12, s[8:11], s52 offen lds
    s_waitcnt lgkmcnt(3)
    v_mfma_f32_32x32x16_bf16 v[64:79], v[156:159], v[60:63], v[64:79]
    ds_read_b128 v[32:35], v16 offset:0
    ds_read_b64_tr_b16 v[128:129], v24 offset:0
    ds_read_b64_tr_b16 v[130:131], v24 offset:1024
    s_waitcnt lgkmcnt(5)
    v_mfma_f32_32x32x16_bf16 v[80:95], v[156:159], v[164:167], v[80:95]
    ds_read_b128 v[160:163], v20 offset:0
    ds_read_b64_tr_b16 v[168:169], v25 offset:0
    s_waitcnt lgkmcnt(5)
    s_add_u32 m0, s50, 66560
    v_mfma_f32_32x32x16_bf16 v[96:111], v[172:175], v[60:63], v[96:111]
    ds_read_b64_tr_b16 v[170:171], v25 offset:1024
    buffer_load_dwordx4 v9, s[4:7], s51 offen lds
    s_add_u32 m0, s50, 82944
    v_mfma_f32_32x32x16_bf16 v[112:127], v[172:175], v[164:167], v[112:127]
    buffer_load_dwordx4 v13, s[8:11], s52 offen lds
    s_waitcnt lgkmcnt(3)
    v_mfma_f32_32x32x16_bf16 v[64:79], v[128:131], v[32:35], v[64:79]
    ds_read_b128 v[36:39], v17 offset:0
    ds_read_b64_tr_b16 v[132:133], v24 offset:4096
    ds_read_b64_tr_b16 v[134:135], v24 offset:5120
    s_waitcnt lgkmcnt(5)
    v_mfma_f32_32x32x16_bf16 v[80:95], v[128:131], v[160:163], v[80:95]
    ds_read_b128 v[164:167], v21 offset:0
    ds_read_b64_tr_b16 v[172:173], v25 offset:4096
    s_waitcnt lgkmcnt(5)
    s_add_u32 m0, s50, 67584
    v_mfma_f32_32x32x16_bf16 v[96:111], v[168:171], v[32:35], v[96:111]
    ds_read_b64_tr_b16 v[174:175], v25 offset:5120
    buffer_load_dwordx4 v10, s[4:7], s51 offen lds
    s_add_u32 m0, s50, 83968
    v_mfma_f32_32x32x16_bf16 v[112:127], v[168:171], v[160:163], v[112:127]
    buffer_load_dwordx4 v14, s[8:11], s52 offen lds
    s_waitcnt lgkmcnt(3)
    v_mfma_f32_32x32x16_bf16 v[64:79], v[132:135], v[36:39], v[64:79]
    ds_read_b128 v[40:43], v18 offset:0
    ds_read_b64_tr_b16 v[136:137], v24 offset:8192
    ds_read_b64_tr_b16 v[138:139], v24 offset:9216
    s_waitcnt lgkmcnt(5)
    v_mfma_f32_32x32x16_bf16 v[80:95], v[132:135], v[164:167], v[80:95]
    ds_read_b128 v[160:163], v22 offset:0
    ds_read_b64_tr_b16 v[168:169], v25 offset:8192
    s_waitcnt lgkmcnt(5)
    s_add_u32 m0, s50, 68608
    v_mfma_f32_32x32x16_bf16 v[96:111], v[172:175], v[36:39], v[96:111]
    ds_read_b64_tr_b16 v[170:171], v25 offset:9216
    buffer_load_dwordx4 v11, s[4:7], s51 offen lds
    s_add_u32 m0, s50, 84992
    v_mfma_f32_32x32x16_bf16 v[112:127], v[172:175], v[164:167], v[112:127]
    buffer_load_dwordx4 v15, s[8:11], s52 offen lds
    s_waitcnt vmcnt(8)
    s_barrier
    v_dot2c_f32_bf16 v26, s41, v48
    v_dot2c_f32_bf16 v28, v48, v48
    v_dot2c_f32_bf16 v30, s41, v144
    v_dot2c_f32_bf16 v27, s41, v49
    v_dot2c_f32_bf16 v29, v49, v49
    v_dot2c_f32_bf16 v31, s41, v145
    v_dot2c_f32_bf16 v26, s41, v50
    v_dot2c_f32_bf16 v28, v50, v50
    v_dot2c_f32_bf16 v30, s41, v146
    v_dot2c_f32_bf16 v27, s41, v51
    v_dot2c_f32_bf16 v29, v51, v51
    v_dot2c_f32_bf16 v31, s41, v147
    v_dot2c_f32_bf16 v26, s41, v52
    v_dot2c_f32_bf16 v28, v52, v52
    v_dot2c_f32_bf16 v30, s41, v148
    v_dot2c_f32_bf16 v27, s41, v53
    v_dot2c_f32_bf16 v29, v53, v53
    v_dot2c_f32_bf16 v31, s41, v149
    v_dot2c_f32_bf16 v26, s41, v54
    v_dot2c_f32_bf16 v28, v54, v54
    v_dot2c_f32_bf16 v30, s41, v150
    v_dot2c_f32_bf16 v27, s41, v55
    v_dot2c_f32_bf16 v29, v55, v55
    v_dot2c_f32_bf16 v31, s41, v151
    v_dot2c_f32_bf16 v26, s41, v56
    v_dot2c_f32_bf16 v28, v56, v56
    v_dot2c_f32_bf16 v30, s41, v152
    v_dot2c_f32_bf16 v27, s41, v57
    v_dot2c_f32_bf16 v29, v57, v57
    v_dot2c_f32_bf16 v31, s41, v153
    v_dot2c_f32_bf16 v26, s41, v58
    v_dot2c_f32_bf16 v28, v58, v58
    v_dot2c_f32_bf16 v30, s41, v154
    v_dot2c_f32_bf16 v27, s41, v59
    v_dot2c_f32_bf16 v29, v59, v59
    v_dot2c_f32_bf16 v31, s41, v155
    v_dot2c_f32_bf16 v26, s41, v60
    v_dot2c_f32_bf16 v28, v60, v60
    v_dot2c_f32_bf16 v30, s41, v156
    v_dot2c_f32_bf16 v27, s41, v61
    v_dot2c_f32_bf16 v29, v61, v61
    v_dot2c_f32_bf16 v31, s41, v157
    v_dot2c_f32_bf16 v26, s41, v62
    v_dot2c_f32_bf16 v28, v62, v62
    v_dot2c_f32_bf16 v30, s41, v158
    v_dot2c_f32_bf16 v27, s41, v63
    v_dot2c_f32_bf16 v29, v63, v63
    v_dot2c_f32_bf16 v31, s41, v159
    s_lshl_b32 s51, s46, 7
    s_add_u32 s51, s51, s48
    s_mul_i32 s52, s46, 245760
    s_add_u32 s52, s52, s49
    s_add_u32 s46, s46, 1
    s_cmp_eq_u32 s46, 10
    s_cselect_b32 s46, 0, s46
    s_waitcnt lgkmcnt(3)
    v_mfma_f32_32x32x16_bf16 v[64:79], v[136:139], v[40:43], v[64:79]
    ds_read_b128 v[44:47], v19 offset:0
    ds_read_b64_tr_b16 v[140:141], v24 offset:12288
    ds_read_b64_tr_b16 v[142:143], v24 offset:13312
    s_waitcnt lgkmcnt(5)
    v_mfma_f32_32x32x16_bf16 v[80:95], v[136:139], v[160:163], v[80:95]
    ds_read_b128 v[164:167], v23 offset:0
    ds_read_b64_tr_b16 v[172:173], v25 offset:12288
    s_waitcnt lgkmcnt(5)
    s_add_u32 m0, s50, 98304
    v_mfma_f32_32x32x16_bf16 v[96:111], v[168:171], v[40:43], v[96:111]
    ds_read_b64_tr_b16 v[174:175], v25 offset:13312
    buffer_load_dwordx4 v8, s[4:7], s51 offen lds
    s_add_u32 m0, s50, 114688
    v_mfma_f32_32x32x16_bf16 v[112:127], v[168:171], v[160:163], v[112:127]
    buffer_load_dwordx4 v12, s[8:11], s52 offen lds
    s_waitcnt lgkmcnt(3)
    v_mfma_f32_32x32x16_bf16 v[64:79], v[140:143], v[44:47], v[64:79]
    ds_read_b128 v[48:51], v16 offset:32768
    ds_read_b64_tr_b16 v[144:145], v24 offset:32768
    ds_read_b64_tr_b16 v[146:147], v24 offset:33792
    s_waitcnt lgkmcnt(5)
    v_mfma_f32_32x32x16_bf16 v[80:95], v[140:143], v[164:167], v[80:95]
    ds_read_b128 v[160:163], v20 offset:32768
    ds_read_b64_tr_b16 v[168:169], v25 offset:32768
    s_waitcnt lgkmcnt(5)
    s_add_u32 m0, s50, 99328
    v_mfma_f32_32x32x16_bf16 v[96:111], v[172:175], v[44:47], v[96:111]
    ds_read_b64_tr_b16 v[170:171], v25 offset:33792
    buffer_load_dwordx4 v9, s[4:7], s51 offen lds
    s_add_u32 m0, s50, 115712
    v_mfma_f32_32x32x16_bf16 v[112:127], v[172:175], v[164:167], v[112:127]
    buffer_load_dwordx4 v13, s[8:11], s52 offen lds
    s_waitcnt lgkmcnt(3)
    v_mfma_f32_32x32x16_bf16 v[64:79], v[144:147], v[48:51], v[64:79]
    ds_read_b128 v[52:55], v17 offset:32768
    ds_read_b64_tr_b16 v[148:149], v24 offset:36864
    ds_read_b64_tr_b16 v[150:151], v24 offset:37888
    s_waitcnt lgkmcnt(5)
    v_mfma_f32_32x32x16_bf16 v[80:95], v[144:147], v[160:163], v[80:95]
    ds_read_b128 v[164:167], v21 offset:32768
    ds_read_b64_tr_b16 v[172:173], v25 offset:36864
    s_waitcnt lgkmcnt(5)
    s_add_u32 m0, s50, 100352
    v_mfma_f32_32x32x16_bf16 v[96:111], v[168:171], v[48:51], v[96:111]
    ds_read_b64_tr_b16 v[174:175], v25 offset:37888
    buffer_load_dwordx4 v10, s[4:7], s51 offen lds
    s_add_u32 m0, s50, 116736
    v_mfma_f32_32x32x16_bf16 v[112:127], v[168:171], v[160:163], v[112:127]
    buffer_load_dwordx4 v14, s[8:11], s52 offen lds
    s_waitcnt lgkmcnt(3)
    v_mfma_f32_32x32x16_bf16 v[64:79], v[148:151], v[52:55], v[64:79]
    ds_read_b128 v[56:59], v18 offset:32768
    ds_read_b64_tr_b16 v[152:153], v24 offset:40960
    ds_read_b64_tr_b16 v[154:155], v24 offset:41984
    s_waitcnt lgkmcnt(5)
    v_mfma_f32_32x32x16_bf16 v[80:95], v[148:151], v[164:167], v[80:95]
    ds_read_b128 v[160:163], v22 offset:32768
    ds_read_b64_tr_b16 v[168:169], v25 offset:40960
    s_waitcnt lgkmcnt(5)
    s_add_u32 m0, s50, 101376
    v_mfma_f32_32x32x16_bf16 v[96:111], v[172:175], v[52:55], v[96:111]
    ds_read_b64_tr_b16 v[170:171], v25 offset:41984
    buffer_load_dwordx4 v11, s[4:7], s51 offen lds
    s_add_u32 m0, s50, 117760
    v_mfma_f32_32x32x16_bf16 v[112:127], v[172:175], v[164:167], v[112:127]
    buffer_load_dwordx4 v15, s[8:11], s52 offen lds
    s_waitcnt vmcnt(8)
    s_barrier
    v_dot2c_f32_bf16 v26, s41, v32
    v_dot2c_f32_bf16 v28, v32, v32
    v_dot2c_f32_bf16 v30, s41, v128
    v_dot2c_f32_bf16 v27, s41, v33
    v_dot2c_f32_bf16 v29, v33, v33
    v_dot2c_f32_bf16 v31, s41, v129
    v_dot2c_f32_bf16 v26, s41, v34
    v_dot2c_f32_bf16 v28, v34, v34
    v_dot2c_f32_bf16 v30, s41, v130
    v_dot2c_f32_bf16 v27, s41, v35
    v_dot2c_f32_bf16 v29, v35, v35
    v_dot2c_f32_bf16 v31, s41, v131
    v_dot2c_f32_bf16 v26, s41, v36
    v_dot2c_f32_bf16 v28, v36, v36
    v_dot2c_f32_bf16 v30, s41, v132
    v_dot2c_f32_bf16 v27, s41, v37
    v_dot2c_f32_bf16 v29, v37, v37
    v_dot2c_f32_bf16 v31, s41, v133
    v_dot2c_f32_bf16 v26, s41, v38
    v_dot2c_f32_bf16 v28, v38, v38
    v_dot2c_f32_bf16 v30, s41, v134
    v_dot2c_f32_bf16 v27, s41, v39
    v_dot2c_f32_bf16 v29, v39, v39
    v_dot2c_f32_bf16 v31, s41, v135
    v_dot2c_f32_bf16 v26, s41, v40
    v_dot2c_f32_bf16 v28, v40, v40
    v_dot2c_f32_bf16 v30, s41, v136
    v_dot2c_f32_bf16 v27, s41, v41
    v_dot2c_f32_bf16 v29, v41, v41
    v_dot2c_f32_bf16 v31, s41, v137
    v_dot2c_f32_bf16 v26, s41, v42
    v_dot2c_f32_bf16 v28, v42, v42
    v_dot2c_f32_bf16 v30, s41, v138
    v_dot2c_f32_bf16 v27, s41, v43
    v_dot2c_f32_bf16 v29, v43, v43
    v_dot2c_f32_bf16 v31, s41, v139
    v_dot2c_f32_bf16 v26, s41, v44
    v_dot2c_f32_bf16 v28, v44, v44
    v_dot2c_f32_bf16 v30, s41, v140
    v_dot2c_f32_bf16 v27, s41, v45
    v_dot2c_f32_bf16 v29, v45, v45
    v_dot2c_f32_bf16 v31, s41, v141
    v_dot2c_f32_bf16 v26, s41, v46
    v_dot2c_f32_bf16 v28, v46, v46
    v_dot2c_f32_bf16 v30, s41, v142
    v_dot2c_f32_bf16 v27, s41, v47
    v_dot2c_f32_bf16 v29, v47, v47
    v_dot2c_f32_bf16 v31, s41, v143
    s_lshl_b32 s51, s46, 7
    s_add_u32 s51, s51, s48
    s_mul_i32 s52, s46, 245760
    s_add_u32 s52, s52, s49
    s_add_u32 s46, s46, 1
    s_cmp_eq_u32 s46, 10
    s_cselect_b32 s46, 0, s46
    s_waitcnt lgkmcnt(3)
    v_mfma_f32_32x32x16_bf16 v[64:79], v[152:155], v[56:59], v[64:79]
    ds_read_b128 v[60:63], v19 offset:32768
    ds_read_b64_tr_b16 v[156:157], v24 offset:45056
    ds_read_b64_tr_b16 v[158:159], v24 offset:46080
    s_waitcnt lgkmcnt(5)
    v_mfma_f32_32x32x16_bf16 v[80:95], v[152:155], v[160:163], v[80:95]
    ds_read_b128 v[164:167], v23 offset:32768
    ds_read_b64_tr_b16 v[172:173], v25 offset:45056
    s_waitcnt lgkmcnt(5)
    s_add_u32 m0, s50, 0
    v_mfma_f32_32x32x16_bf16 v[96:111], v[168:171], v[56:59], v[96:111]
    ds_read_b64_tr_b16 v[174:175], v25 offset:46080
    buffer_load_dwordx4 v8, s[4:7], s51 offen lds
    s_add_u32 m0, s50, 16384
    v_mfma_f32_32x32x16_bf16 v[112:127], v[168:171], v[160:163], v[112:127]
    buffer_load_dwordx4 v12, s[8:11], s52 offen lds
    s_waitcnt lgkmcnt(3)
    v_mfma_f32_32x32x16_bf16 v[64:79], v[156:159], v[60:63], v[64:79]
    ds_read_b128 v[32:35], v176 offset:0
    ds_read_b64_tr_b16 v[128:129], v184 offset:0
    ds_read_b64_tr_b16 v[130:131], v184 offset:1024
    s_waitcnt lgkmcnt(5)
    v_mfma_f32_32x32x16_bf16 v[80:95], v[156:159], v[164:167], v[80:95]
    ds_read_b128 v[160:163], v180 offset:0
    ds_read_b64_tr_b16 v[168:169], v185 offset:0
    s_waitcnt lgkmcnt(5)
    s_add_u32 m0, s50, 1024
    v_mfma_f32_32x32x16_bf16 v[96:111], v[172:175], v[60:63], v[96:111]
    ds_read_b64_tr_b16 v[170:171], v185 offset:1024
    buffer_load_dwordx4 v9, s[4:7], s51 offen lds
    s_add_u32 m0, s50, 17408
    v_mfma_f32_32x32x16_bf16 v[112:127], v[172:175], v[164:167], v[112:127]
    buffer_load_dwordx4 v13, s[8:11], s52 offen lds
    s_waitcnt lgkmcnt(3)
    v_mfma_f32_32x32x16_bf16 v[64:79], v[128:131], v[32:35], v[64:79]
    ds_read_b128 v[36:39], v177 offset:0
    ds_read_b64_tr_b16 v[132:133], v184 offset:4096
    ds_read_b64_tr_b16 v[134:135], v184 offset:5120
    s_waitcnt lgkmcnt(5)
    v_mfma_f32_32x32x16_bf16 v[80:95], v[128:131], v[160:163], v[80:95]
    ds_read_b128 v[164:167], v181 offset:0
    ds_read_b64_tr_b16 v[172:173], v185 offset:4096
    s_waitcnt lgkmcnt(5)
    s_add_u32 m0, s50, 2048
    v_mfma_f32_32x32x16_bf16 v[96:111], v[168:171], v[32:35], v[96:111]
    ds_read_b64_tr_b16 v[174:175], v185 offset:5120
    buffer_load_dwordx4 v10, s[4:7], s51 offen lds
    s_add_u32 m0, s50, 18432
    v_mfma_f32_32x32x16_bf16 v[112:127], v[168:171], v[160:163], v[112:127]
    buffer_load_dwordx4 v14, s[8:11], s52 offen lds
    s_waitcnt lgkmcnt(3)
    v_mfma_f32_32x32x16_bf16 v[64:79], v[132:135], v[36:39], v[64:79]
    ds_read_b128 v[40:43], v178 offset:0
    ds_read_b64_tr_b16 v[136:137], v184 offset:8192
    ds_read_b64_tr_b16 v[138:139], v184 offset:9216
    s_waitcnt lgkmcnt(5)
    v_mfma_f32_32x32x16_bf16 v[80:95], v[132:135], v[164:167], v[80:95]
    ds_read_b128 v[160:163], v182 offset:0
    ds_read_b64_tr_b16 v[168:169], v185 offset:8192
    s_waitcnt lgkmcnt(5)
    s_add_u32 m0, s50, 3072
    v_mfma_f32_32x32x16_bf16 v[96:111], v[172:175], v[36:39], v[96:111]
    ds_read_b64_tr_b16 v[170:171], v185 offset:9216
    buffer_load_dwordx4 v11, s[4:7], s51 offen lds
    s_add_u32 m0, s50, 19456
    v_mfma_f32_32x32x16_bf16 v[112:127], v[172:175], v[164:167], v[112:127]
    buffer_load_dwordx4 v15, s[8:11], s52 offen lds
    s_waitcnt vmcnt(8)
    s_barrier
    v_dot2c_f32_bf16 v26, s41, v48
    v_dot2c_f32_bf16 v28, v48, v48
    v_dot2c_f32_bf16 v30, s41, v144
    v_dot2c_f32_bf16 v27, s41, v49
    v_dot2c_f32_bf16 v29, v49, v49
    v_dot2c_f32_bf16 v31, s41, v145
    v_dot2c_f32_bf16 v26, s41, v50
    v_dot2c_f32_bf16 v28, v50, v50
    v_dot2c_f32_bf16 v30, s41, v146
    v_dot2c_f32_bf16 v27, s41, v51
    v_dot2c_f32_bf16 v29, v51, v51
    v_dot2c_f32_bf16 v31, s41, v147
    v_dot2c_f32_bf16 v26, s41, v52
    v_dot2c_f32_bf16 v28, v52, v52
    v_dot2c_f32_bf16 v30, s41, v148
    v_dot2c_f32_bf16 v27, s41, v53
    v_dot2c_f32_bf16 v29, v53, v53
    v_dot2c_f32_bf16 v31, s41, v149
    v_dot2c_f32_bf16 v26, s41, v54
    v_dot2c_f32_bf16 v28, v54, v54
    v_dot2c_f32_bf16 v30, s41, v150
    v_dot2c_f32_bf16 v27, s41, v55
    v_dot2c_f32_bf16 v29, v55, v55
    v_dot2c_f32_bf16 v31, s41, v151
    v_dot2c_f32_bf16 v26, s41, v56
    v_dot2c_f32_bf16 v28, v56, v56
    v_dot2c_f32_bf16 v30, s41, v152
    v_dot2c_f32_bf16 v27, s41, v57
    v_dot2c_f32_bf16 v29, v57, v57
    v_dot2c_f32_bf16 v31, s41, v153
    v_dot2c_f32_bf16 v26, s41, v58
    v_dot2c_f32_bf16 v28, v58, v58
    v_dot2c_f32_bf16 v30, s41, v154
    v_dot2c_f32_bf16 v27, s41, v59
    v_dot2c_f32_bf16 v29, v59, v59
    v_dot2c_f32_bf16 v31, s41, v155
    v_dot2c_f32_bf16 v26, s41, v60
    v_dot2c_f32_bf16 v28, v60, v60
    v_dot2c_f32_bf16 v30, s41, v156
    v_dot2c_f32_bf16 v27, s41, v61
    v_dot2c_f32_bf16 v29, v61, v61
    v_dot2c_f32_bf16 v31, s41, v157
    v_dot2c_f32_bf16 v26, s41, v62
    v_dot2c_f32_bf16 v28, v62, v62
    v_dot2c_f32_bf16 v30, s41, v158
    v_dot2c_f32_bf16 v27, s41, v63
    v_dot2c_f32_bf16 v29, v63, v63
    v_dot2c_f32_bf16 v31, s41, v159
    s_lshl_b32 s51, s46, 7
    s_add_u32 s51, s51, s48
    s_mul_i32 s52, s46, 245760
    s_add_u32 s52, s52, s49
    s_add_u32 s46, s46, 1
    s_cmp_eq_u32 s46, 10
    s_cselect_b32 s46, 0, s46
    s_waitcnt lgkmcnt(3)
    v_mfma_f32_32x32x16_bf16 v[64:79], v[136:139], v[40:43], v[64:79]
    ds_read_b128 v[44:47], v179 offset:0
    ds_read_b64_tr_b16 v[140:141], v184 offset:12288
    ds_read_b64_tr_b16 v[142:143], v184 offset:13312
    s_waitcnt lgkmcnt(5)
    v_mfma_f32_32x32x16_bf16 v[80:95], v[136:139], v[160:163], v[80:95]
    ds_read_b128 v[164:167], v183 offset:0
    ds_read_b64_tr_b16 v[172:173], v185 offset:12288
    s_waitcnt lgkmcnt(5)
    s_add_u32 m0, s50, 32768
    v_mfma_f32_32x32x16_bf16 v[96:111], v[168:171], v[40:43], v[96:111]
    ds_read_b64_tr_b16 v[174:175], v185 offset:13312
    buffer_load_dwordx4 v8, s[4:7], s51 offen lds
    s_add_u32 m0, s50, 49152
    v_mfma_f32_32x32x16_bf16 v[112:127], v[168:171], v[160:163], v[112:127]
    buffer_load_dwordx4 v12, s[8:11], s52 offen lds
    s_waitcnt lgkmcnt(3)
    v_mfma_f32_32x32x16_bf16 v[64:79], v[140:143], v[44:47], v[64:79]
    ds_read_b128 v[48:51], v176 offset:32768
    ds_read_b64_tr_b16 v[144:145], v184 offset:32768
    ds_read_b64_tr_b16 v[146:147], v184 offset:33792
    s_waitcnt lgkmcnt(5)
    v_mfma_f32_32x32x16_bf16 v[80:95], v[140:143], v[164:167], v[80:95]
    ds_read_b128 v[160:163], v180 offset:32768
    ds_read_b64_tr_b16 v[168:169], v185 offset:32768
    s_waitcnt lgkmcnt(5)
    s_add_u32 m0, s50, 33792
    v_mfma_f32_32x32x16_bf16 v[96:111], v[172:175], v[44:47], v[96:111]
    ds_read_b64_tr_b16 v[170:171], v185 offset:33792
    buffer_load_dwordx4 v9, s[4:7], s51 offen lds
    s_add_u32 m0, s50, 50176
    v_mfma_f32_32x32x16_bf16 v[112:127], v[172:175], v[164:167], v[112:127]
    buffer_load_dwordx4 v13, s[8:11], s52 offen lds
    s_waitcnt lgkmcnt(3)
    v_mfma_f32_32x32x16_bf16 v[64:79], v[144:147], v[48:51], v[64:79]
    ds_read_b128 v[52:55], v177 offset:32768
    ds_read_b64_tr_b16 v[148:149], v184 offset:36864
    ds_read_b64_tr_b16 v[150:151], v184 offset:37888
    s_waitcnt lgkmcnt(5)
    v_mfma_f32_32x32x16_bf16 v[80:95], v[144:147], v[160:163], v[80:95]
    ds_read_b128 v[164:167], v181 offset:32768
    ds_read_b64_tr_b16 v[172:173], v185 offset:36864
    s_waitcnt lgkmcnt(5)
    s_add_u32 m0, s50, 34816
    v_mfma_f32_32x32x16_bf16 v[96:111], v[168:171], v[48:51], v[96:111]
    ds_read_b64_tr_b16 v[174:175], v185 offset:37888
    buffer_load_dwordx4 v10, s[4:7], s51 offen lds
    s_add_u32 m0, s50, 51200
    v_mfma_f32_32x32x16_bf16 v[112:127], v[168:171], v[160:163], v[112:127]
    buffer_load_dwordx4 v14, s[8:11], s52 offen lds
    s_waitcnt lgkmcnt(3)
    v_mfma_f32_32x32x16_bf16 v[64:79], v[148:151], v[52:55], v[64:79]
    ds_read_b128 v[56:59], v178 offset:32768
    ds_read_b64_tr_b16 v[152:153], v184 offset:40960
    ds_read_b64_tr_b16 v[154:155], v184 offset:41984
    s_waitcnt lgkmcnt(5)
    v_mfma_f32_32x32x16_bf16 v[80:95], v[148:151], v[164:167], v[80:95]
    ds_read_b128 v[160:163], v182 offset:32768
    ds_read_b64_tr_b16 v[168:169], v185 offset:40960
    s_waitcnt lgkmcnt(5)
    s_add_u32 m0, s50, 35840
    v_mfma_f32_32x32x16_bf16 v[96:111], v[172:175], v[52:55], v[96:111]
    ds_read_b64_tr_b16 v[170:171], v185 offset:41984
    buffer_load_dwordx4 v11, s[4:7], s51 offen lds
    s_add_u32 m0, s50, 52224
    v_mfma_f32_32x32x16_bf16 v[112:127], v[172:175], v[164:167], v[112:127]
    buffer_load_dwordx4 v15, s[8:11], s52 offen lds
    s_waitcnt vmcnt(8)
    s_barrier
    s_lshl_b32 s60, s3, 13
    s_add_u32 s60, s60, 131072
    s_bitcmp1_b32 s80, 1
    s_mov_b32 s61, 5120
    s_cselect_b32 s61, 13824, s61
    s_mov_b32 s62, s76
    s_mov_b64 exec, s[78:79]
    s_add_u32 m0, s60, 0
    s_nop 0
    buffer_load_dwordx4 v221, s[72:75], s62 offen lds
    s_add_u32 s62, s62, s61
    s_add_u32 m0, s60, 1056
    s_nop 0
    buffer_load_dwordx4 v221, s[72:75], s62 offen lds
    s_add_u32 s62, s62, s61
    s_add_u32 m0, s60, 2048
    s_nop 0
    buffer_load_dwordx4 v221, s[72:75], s62 offen lds
    s_add_u32 s62, s62, s61
    s_add_u32 m0, s60, 3104
    s_nop 0
    buffer_load_dwordx4 v221, s[72:75], s62 offen lds
    s_add_u32 s62, s62, s61
    s_add_u32 m0, s60, 4096
    s_nop 0
    buffer_load_dwordx4 v221, s[72:75], s62 offen lds
    s_add_u32 s62, s62, s61
    s_add_u32 m0, s60, 5152
    s_nop 0
    buffer_load_dwordx4 v221, s[72:75], s62 offen lds
    s_add_u32 s62, s62, s61
    s_add_u32 m0, s60, 6144
    s_nop 0
    buffer_load_dwordx4 v221, s[72:75], s62 offen lds
    s_add_u32 s62, s62, s61
    s_add_u32 m0, s60, 7200
    s_nop 0
    buffer_load_dwordx4 v221, s[72:75], s62 offen lds
    s_add_u32 s62, s62, s61
    s_mov_b64 exec, -1
    v_dot2c_f32_bf16 v26, s41, v32
    v_dot2c_f32_bf16 v28, v32, v32
    v_dot2c_f32_bf16 v30, s41, v128
    v_dot2c_f32_bf16 v27, s41, v33
    v_dot2c_f32_bf16 v29, v33, v33
    v_dot2c_f32_bf16 v31, s41, v129
    v_dot2c_f32_bf16 v26, s41, v34
    v_dot2c_f32_bf16 v28, v34, v34
    v_dot2c_f32_bf16 v30, s41, v130
    v_dot2c_f32_bf16 v27, s41, v35
    v_dot2c_f32_bf16 v29, v35, v35
    v_dot2c_f32_bf16 v31, s41, v131
    v_dot2c_f32_bf16 v26, s41, v36
    v_dot2c_f32_bf16 v28, v36, v36
    v_dot2c_f32_bf16 v30, s41, v132
    v_dot2c_f32_bf16 v27, s41, v37
    v_dot2c_f32_bf16 v29, v37, v37
    v_dot2c_f32_bf16 v31, s41, v133
    v_dot2c_f32_bf16 v26, s41, v38
    v_dot2c_f32_bf16 v28, v38, v38
    v_dot2c_f32_bf16 v30, s41, v134
    v_dot2c_f32_bf16 v27, s41, v39
    v_dot2c_f32_bf16 v29, v39, v39
    v_dot2c_f32_bf16 v31, s41, v135
    v_dot2c_f32_bf16 v26, s41, v40
    v_dot2c_f32_bf16 v28, v40, v40
    v_dot2c_f32_bf16 v30, s41, v136
    v_dot2c_f32_bf16 v27, s41, v41
    v_dot2c_f32_bf16 v29, v41, v41
    v_dot2c_f32_bf16 v31, s41, v137
    v_dot2c_f32_bf16 v26, s41, v42
    v_dot2c_f32_bf16 v28, v42, v42
    v_dot2c_f32_bf16 v30, s41, v138
    v_dot2c_f32_bf16 v27, s41, v43
    v_dot2c_f32_bf16 v29, v43, v43
    v_dot2c_f32_bf16 v31, s41, v139
    v_dot2c_f32_bf16 v26, s41, v44
    v_dot2c_f32_bf16 v28, v44, v44
    v_dot2c_f32_bf16 v30, s41, v140
    v_dot2c_f32_bf16 v27, s41, v45
    v_dot2c_f32_bf16 v29, v45, v45
    v_dot2c_f32_bf16 v31, s41, v141
    v_dot2c_f32_bf16 v26, s41, v46
    v_dot2c_f32_bf16 v28, v46, v46
    v_dot2c_f32_bf16 v30, s41, v142
    v_dot2c_f32_bf16 v27, s41, v47
    v_dot2c_f32_bf16 v29, v47, v47
    v_dot2c_f32_bf16 v31, s41, v143
    s_waitcnt lgkmcnt(3)
    v_mfma_f32_32x32x16_bf16 v[64:79], v[152:155], v[56:59], v[64:79]
    ds_read_b128 v[60:63], v179 offset:32768
    ds_read_b64_tr_b16 v[156:157], v184 offset:45056
    ds_read_b64_tr_b16 v[158:159], v184 offset:46080
    s_waitcnt lgkmcnt(5)
    v_mfma_f32_32x32x16_bf16 v[80:95], v[152:155], v[160:163], v[80:95]
    ds_read_b128 v[164:167], v183 offset:32768
    ds_read_b64_tr_b16 v[172:173], v185 offset:45056
    s_waitcnt lgkmcnt(5)
    v_mfma_f32_32x32x16_bf16 v[96:111], v[168:171], v[56:59], v[96:111]
    ds_read_b64_tr_b16 v[174:175], v185 offset:46080
    v_mfma_f32_32x32x16_bf16 v[112:127], v[168:171], v[160:163], v[112:127]
    s_waitcnt lgkmcnt(3)
    v_mfma_f32_32x32x16_bf16 v[64:79], v[156:159], v[60:63], v[64:79]
    ds_read_b128 v[32:35], v16 offset:0
    ds_read_b64_tr_b16 v[128:129], v24 offset:0
    ds_read_b64_tr_b16 v[130:131], v24 offset:1024
    s_waitcnt lgkmcnt(5)
    v_mfma_f32_32x32x16_bf16 v[80:95], v[156:159], v[164:167], v[80:95]
    ds_read_b128 v[160:163], v20 offset:0
    ds_read_b64_tr_b16 v[168:169], v25 offset:0
    s_waitcnt lgkmcnt(5)
    v_mfma_f32_32x32x16_bf16 v[96:111], v[172:175], v[60:63], v[96:111]
    ds_read_b64_tr_b16 v[170:171], v25 offset:1024
    v_mfma_f32_32x32x16_bf16 v[112:127], v[172:175], v[164:167], v[112:127]
    s_waitcnt lgkmcnt(3)
    v_mfma_f32_32x32x16_bf16 v[64:79], v[128:131], v[32:35], v[64:79]
    ds_read_b128 v[36:39], v17 offset:0
    ds_read_b64_tr_b16 v[132:133], v24 offset:4096
    ds_read_b64_tr_b16 v[134:135], v24 offset:5120
    s_waitcnt lgkmcnt(5)
    v_mfma_f32_32x32x16_bf16 v[80:95], v[128:131], v[160:163], v[80:95]
    ds_read_b128 v[164:167], v21 offset:0
    ds_read_b64_tr_b16 v[172:173], v25 offset:4096
    s_waitcnt lgkmcnt(5)
    v_mfma_f32_32x32x16_bf16 v[96:111], v[168:171], v[32:35], v[96:111]
    ds_read_b64_tr_b16 v[174:175], v25 offset:5120
    v_mfma_f32_32x32x16_bf16 v[112:127], v[168:171], v[160:163], v[112:127]
    s_waitcnt lgkmcnt(3)
    v_mfma_f32_32x32x16_bf16 v[64:79], v[132:135], v[36:39], v[64:79]
    ds_read_b128 v[40:43], v18 offset:0
    ds_read_b64_tr_b16 v[136:137], v24 offset:8192
    ds_read_b64_tr_b16 v[138:139], v24 offset:9216
    s_waitcnt lgkmcnt(5)
    v_mfma_f32_32x32x16_bf16 v[80:95], v[132:135], v[164:167], v[80:95]
    ds_read_b128 v[160:163], v22 offset:0
    ds_read_b64_tr_b16 v[168:169], v25 offset:8192
    s_waitcnt lgkmcnt(5)
    v_mfma_f32_32x32x16_bf16 v[96:111], v[172:175], v[36:39], v[96:111]
    ds_read_b64_tr_b16 v[170:171], v25 offset:9216
    v_mfma_f32_32x32x16_bf16 v[112:127], v[172:175], v[164:167], v[112:127]
    s_waitcnt vmcnt(8)
    s_barrier
    v_dot2c_f32_bf16 v26, s41, v48
    v_dot2c_f32_bf16 v28, v48, v48
    v_dot2c_f32_bf16 v30, s41, v144
    v_dot2c_f32_bf16 v27, s41, v49
    v_dot2c_f32_bf16 v29, v49, v49
    v_dot2c_f32_bf16 v31, s41, v145
    v_dot2c_f32_bf16 v26, s41, v50
    v_dot2c_f32_bf16 v28, v50, v50
    v_dot2c_f32_bf16 v30, s41, v146
    v_dot2c_f32_bf16 v27, s41, v51
    v_dot2c_f32_bf16 v29, v51, v51
    v_dot2c_f32_bf16 v31, s41, v147
    v_dot2c_f32_bf16 v26, s41, v52
    v_dot2c_f32_bf16 v28, v52, v52
    v_dot2c_f32_bf16 v30, s41, v148
    v_dot2c_f32_bf16 v27, s41, v53
    v_dot2c_f32_bf16 v29, v53, v53
    v_dot2c_f32_bf16 v31, s41, v149
    v_dot2c_f32_bf16 v26, s41, v54
    v_dot2c_f32_bf16 v28, v54, v54
    v_dot2c_f32_bf16 v30, s41, v150
    v_dot2c_f32_bf16 v27, s41, v55
    v_dot2c_f32_bf16 v29, v55, v55
    v_dot2c_f32_bf16 v31, s41, v151
    v_dot2c_f32_bf16 v26, s41, v56
    v_dot2c_f32_bf16 v28, v56, v56
    v_dot2c_f32_bf16 v30, s41, v152
    v_dot2c_f32_bf16 v27, s41, v57
    v_dot2c_f32_bf16 v29, v57, v57
    v_dot2c_f32_bf16 v31, s41, v153
    v_dot2c_f32_bf16 v26, s41, v58
    v_dot2c_f32_bf16 v28, v58, v58
    v_dot2c_f32_bf16 v30, s41, v154
    v_dot2c_f32_bf16 v27, s41, v59
    v_dot2c_f32_bf16 v29, v59, v59
    v_dot2c_f32_bf16 v31, s41, v155
    v_dot2c_f32_bf16 v26, s41, v60
    v_dot2c_f32_bf16 v28, v60, v60
    v_dot2c_f32_bf16 v30, s41, v156
    v_dot2c_f32_bf16 v27, s41, v61
    v_dot2c_f32_bf16 v29, v61, v61
    v_dot2c_f32_bf16 v31, s41, v157
    v_dot2c_f32_bf16 v26, s41, v62
    v_dot2c_f32_bf16 v28, v62, v62
    v_dot2c_f32_bf16 v30, s41, v158
    v_dot2c_f32_bf16 v27, s41, v63
    v_dot2c_f32_bf16 v29, v63, v63
    v_dot2c_f32_bf16 v31, s41, v159
    s_waitcnt lgkmcnt(3)
    v_mfma_f32_32x32x16_bf16 v[64:79], v[136:139], v[40:43], v[64:79]
    ds_read_b128 v[44:47], v19 offset:0
    ds_read_b64_tr_b16 v[140:141], v24 offset:12288
    ds_read_b64_tr_b16 v[142:143], v24 offset:13312
    s_waitcnt lgkmcnt(5)
    v_mfma_f32_32x32x16_bf16 v[80:95], v[136:139], v[160:163], v[80:95]
    ds_read_b128 v[164:167], v23 offset:0
    ds_read_b64_tr_b16 v[172:173], v25 offset:12288
    s_waitcnt lgkmcnt(5)
    v_mfma_f32_32x32x16_bf16 v[96:111], v[168:171], v[40:43], v[96:111]
    ds_read_b64_tr_b16 v[174:175], v25 offset:13312
    v_mfma_f32_32x32x16_bf16 v[112:127], v[168:171], v[160:163], v[112:127]
    s_waitcnt lgkmcnt(3)
    v_mfma_f32_32x32x16_bf16 v[64:79], v[140:143], v[44:47], v[64:79]
    ds_read_b128 v[48:51], v16 offset:32768
    ds_read_b64_tr_b16 v[144:145], v24 offset:32768
    ds_read_b64_tr_b16 v[146:147], v24 offset:33792
    s_waitcnt lgkmcnt(5)
    v_mfma_f32_32x32x16_bf16 v[80:95], v[140:143], v[164:167], v[80:95]
    ds_read_b128 v[160:163], v20 offset:32768
    ds_read_b64_tr_b16 v[168:169], v25 offset:32768
    s_waitcnt lgkmcnt(5)
    v_mfma_f32_32x32x16_bf16 v[96:111], v[172:175], v[44:47], v[96:111]
    ds_read_b64_tr_b16 v[170:171], v25 offset:33792
    v_mfma_f32_32x32x16_bf16 v[112:127], v[172:175], v[164:167], v[112:127]
    s_waitcnt lgkmcnt(3)
    v_mfma_f32_32x32x16_bf16 v[64:79], v[144:147], v[48:51], v[64:79]
    ds_read_b128 v[52:55], v17 offset:32768
    ds_read_b64_tr_b16 v[148:149], v24 offset:36864
    ds_read_b64_tr_b16 v[150:151], v24 offset:37888
    s_waitcnt lgkmcnt(5)
    v_mfma_f32_32x32x16_bf16 v[80:95], v[144:147], v[160:163], v[80:95]
    ds_read_b128 v[164:167], v21 offset:32768
    ds_read_b64_tr_b16 v[172:173], v25 offset:36864
    s_waitcnt lgkmcnt(5)
    v_mfma_f32_32x32x16_bf16 v[96:111], v[168:171], v[48:51], v[96:111]
    ds_read_b64_tr_b16 v[174:175], v25 offset:37888
    v_mfma_f32_32x32x16_bf16 v[112:127], v[168:171], v[160:163], v[112:127]
    s_waitcnt lgkmcnt(3)
    v_mfma_f32_32x32x16_bf16 v[64:79], v[148:151], v[52:55], v[64:79]
    ds_read_b128 v[56:59], v18 offset:32768
    ds_read_b64_tr_b16 v[152:153], v24 offset:40960
    ds_read_b64_tr_b16 v[154:155], v24 offset:41984
    s_waitcnt lgkmcnt(5)
    v_mfma_f32_32x32x16_bf16 v[80:95], v[148:151], v[164:167], v[80:95]
    ds_read_b128 v[160:163], v22 offset:32768
    ds_read_b64_tr_b16 v[168:169], v25 offset:40960
    s_waitcnt lgkmcnt(5)
    v_mfma_f32_32x32x16_bf16 v[96:111], v[172:175], v[52:55], v[96:111]
    ds_read_b64_tr_b16 v[170:171], v25 offset:41984
    v_mfma_f32_32x32x16_bf16 v[112:127], v[172:175], v[164:167], v[112:127]
    v_dot2c_f32_bf16 v26, s41, v32
    v_dot2c_f32_bf16 v28, v32, v32
    v_dot2c_f32_bf16 v30, s41, v128
    v_dot2c_f32_bf16 v27, s41, v33
    v_dot2c_f32_bf16 v29, v33, v33
    v_dot2c_f32_bf16 v31, s41, v129
    v_dot2c_f32_bf16 v26, s41, v34
    v_dot2c_f32_bf16 v28, v34, v34
    v_dot2c_f32_bf16 v30, s41, v130
    v_dot2c_f32_bf16 v27, s41, v35
    v_dot2c_f32_bf16 v29, v35, v35
    v_dot2c_f32_bf16 v31, s41, v131
    v_dot2c_f32_bf16 v26, s41, v36
    v_dot2c_f32_bf16 v28, v36, v36
    v_dot2c_f32_bf16 v30, s41, v132
    v_dot2c_f32_bf16 v27, s41, v37
    v_dot2c_f32_bf16 v29, v37, v37
    v_dot2c_f32_bf16 v31, s41, v133
    v_dot2c_f32_bf16 v26, s41, v38
    v_dot2c_f32_bf16 v28, v38, v38
    v_dot2c_f32_bf16 v30, s41, v134
    v_dot2c_f32_bf16 v27, s41, v39
    v_dot2c_f32_bf16 v29, v39, v39
    v_dot2c_f32_bf16 v31, s41, v135
    v_dot2c_f32_bf16 v26, s41, v40
    v_dot2c_f32_bf16 v28, v40, v40
    v_dot2c_f32_bf16 v30, s41, v136
    v_dot2c_f32_bf16 v27, s41, v41
    v_dot2c_f32_bf16 v29, v41, v41
    v_dot2c_f32_bf16 v31, s41, v137
    v_dot2c_f32_bf16 v26, s41, v42
    v_dot2c_f32_bf16 v28, v42, v42
    v_dot2c_f32_bf16 v30, s41, v138
    v_dot2c_f32_bf16 v27, s41, v43
    v_dot2c_f32_bf16 v29, v43, v43
    v_dot2c_f32_bf16 v31, s41, v139
    v_dot2c_f32_bf16 v26, s41, v44
    v_dot2c_f32_bf16 v28, v44, v44
    v_dot2c_f32_bf16 v30, s41, v140
    v_dot2c_f32_bf16 v27, s41, v45
    v_dot2c_f32_bf16 v29, v45, v45
    v_dot2c_f32_bf16 v31, s41, v141
    v_dot2c_f32_bf16 v26, s41, v46
    v_dot2c_f32_bf16 v28, v46, v46
    v_dot2c_f32_bf16 v30, s41, v142
    v_dot2c_f32_bf16 v27, s41, v47
    v_dot2c_f32_bf16 v29, v47, v47
    v_dot2c_f32_bf16 v31, s41, v143
    s_waitcnt lgkmcnt(3)
    v_mfma_f32_32x32x16_bf16 v[64:79], v[152:155], v[56:59], v[64:79]
    ds_read_b128 v[60:63], v19 offset:32768
    ds_read_b64_tr_b16 v[156:157], v24 offset:45056
    ds_read_b64_tr_b16 v[158:159], v24 offset:46080
    s_waitcnt lgkmcnt(5)
    v_mfma_f32_32x32x16_bf16 v[80:95], v[152:155], v[160:163], v[80:95]
    ds_read_b128 v[164:167], v23 offset:32768
    ds_read_b64_tr_b16 v[172:173], v25 offset:45056
    s_waitcnt lgkmcnt(5)
    v_mfma_f32_32x32x16_bf16 v[96:111], v[168:171], v[56:59], v[96:111]
    ds_read_b64_tr_b16 v[174:175], v25 offset:46080
    v_mfma_f32_32x32x16_bf16 v[112:127], v[168:171], v[160:163], v[112:127]
    s_waitcnt lgkmcnt(3)
    v_mfma_f32_32x32x16_bf16 v[64:79], v[156:159], v[60:63], v[64:79]
    s_waitcnt lgkmcnt(2)
    v_mfma_f32_32x32x16_bf16 v[80:95], v[156:159], v[164:167], v[80:95]
    s_waitcnt lgkmcnt(0)
    v_mfma_f32_32x32x16_bf16 v[96:111], v[172:175], v[60:63], v[96:111]
    v_mfma_f32_32x32x16_bf16 v[112:127], v[172:175], v[164:167], v[112:127]
    v_mov_b32 v1, 0
    global_load_dword v198, v1, s[36:37] sc1
    v_dot2c_f32_bf16 v26, s41, v48
    v_dot2c_f32_bf16 v28, v48, v48
    v_dot2c_f32_bf16 v30, s41, v144
    v_dot2c_f32_bf16 v27, s41, v49
    v_dot2c_f32_bf16 v29, v49, v49
    v_dot2c_f32_bf16 v31, s41, v145
    v_dot2c_f32_bf16 v26, s41, v50
    v_dot2c_f32_bf16 v28, v50, v50
    v_dot2c_f32_bf16 v30, s41, v146
    v_dot2c_f32_bf16 v27, s41, v51
    v_dot2c_f32_bf16 v29, v51, v51
    v_dot2c_f32_bf16 v31, s41, v147
    v_dot2c_f32_bf16 v26, s41, v52
    v_dot2c_f32_bf16 v28, v52, v52
    v_dot2c_f32_bf16 v30, s41, v148
    v_dot2c_f32_bf16 v27, s41, v53
    v_dot2c_f32_bf16 v29, v53, v53
    v_dot2c_f32_bf16 v31, s41, v149
    v_dot2c_f32_bf16 v26, s41, v54
    v_dot2c_f32_bf16 v28, v54, v54
    v_dot2c_f32_bf16 v30, s41, v150
    v_dot2c_f32_bf16 v27, s41, v55
    v_dot2c_f32_bf16 v29, v55, v55
    v_dot2c_f32_bf16 v31, s41, v151
    v_dot2c_f32_bf16 v26, s41, v56
    v_dot2c_f32_bf16 v28, v56, v56
    v_dot2c_f32_bf16 v30, s41, v152
    v_dot2c_f32_bf16 v27, s41, v57
    v_dot2c_f32_bf16 v29, v57, v57
    v_dot2c_f32_bf16 v31, s41, v153
    v_dot2c_f32_bf16 v26, s41, v58
    v_dot2c_f32_bf16 v28, v58, v58
    v_dot2c_f32_bf16 v30, s41, v154
    v_dot2c_f32_bf16 v27, s41, v59
    v_dot2c_f32_bf16 v29, v59, v59
    v_dot2c_f32_bf16 v31, s41, v155
    v_dot2c_f32_bf16 v26, s41, v60
    v_dot2c_f32_bf16 v28, v60, v60
    v_dot2c_f32_bf16 v30, s41, v156
    v_dot2c_f32_bf16 v27, s41, v61
    v_dot2c_f32_bf16 v29, v61, v61
    v_dot2c_f32_bf16 v31, s41, v157
    v_dot2c_f32_bf16 v26, s41, v62
    v_dot2c_f32_bf16 v28, v62, v62
    v_dot2c_f32_bf16 v30, s41, v158
    v_dot2c_f32_bf16 v27, s41, v63
    v_dot2c_f32_bf16 v29, v63, v63
    v_dot2c_f32_bf16 v31, s41, v159
    s_nop 0
    v_add_f32 v26, v26, v27
    v_add_f32 v28, v28, v29
    v_add_f32 v30, v30, v31
    v_mov_b32 v27, v26
    v_mov_b32 v29, v28
    v_mov_b32 v31, v30
    v_permlane32_swap_b32 v26, v27
    v_permlane32_swap_b32 v28, v29
    v_permlane32_swap_b32 v30, v31
    v_add_f32 v30, v30, v31
    v_add_f32 v26, v26, v27
    v_add_f32 v28, v28, v29
    s_and_b32 s66, s3, 1
    s_lshr_b32 s67, s3, 1
    s_lshl_b32 s68, s67, 1
    s_add_u32 s68, s68, s66
    s_lshl_b32 s68, s68, 7
    s_add_u32 s68, s68, 65536
    v_and_b32 v1, 31, v0
    v_lshl_add_u32 v2, v1, 2, s68
    ds_write_b32 v2, v30
    v_mul_f32 v26, 0x3acccccd, v26
    v_mul_f32 v28, 0x3acccccd, v28
    v_fma_f32 v28, -v26, v26, v28
    v_max_f32 v28, 0, v28
    v_add_f32 v28, 0x3727c5ac, v28
    v_rsq_f32 v28, v28
    s_cmp_lt_u32 s45, 5
    s_cselect_b32 s69, 0x3ea52b5c, 1.0
    v_mul_f32 v4, s69, v28
    v_mul_f32 v6, v26, v4
    v_sub_f32 v6, 0, v6
    v_mov_b32 v5, v6
    s_lshl_b32 s68, s66, 6
    s_lshl_b32 s69, s67, 5
    s_add_u32 s68, s68, s69
    v_add_u32 v2, s68, v1
    v_lshlrev_b32 v3, 3, v2
    v_add_u32 v3, 66048, v3
    ds_write_b64 v3, v[4:5]
    v_xor_b32 v3, 0x100, v3
    v_lshrrev_b32 v7, 5, v0
    v_mul_u32_u24 v2, 272, v2
    v_lshl_add_u32 v2, v7, 3, v2
    v_lshlrev_b32 v7, 4, v7
    s_xor_b32 s68, s66, 0
    s_lshl_b32 s69, s67, 1
    s_add_u32 s68, s68, s69
    s_lshl_b32 s69, s68, 7
    s_add_u32 s69, s69, 65536
    v_add_u32 v10, s69, v7
    s_lshl_b32 s68, s68, 6
    v_add_u32 v12, s68, v2
    s_mul_i32 s69, s67, -17408
    s_add_u32 s69, s69, 8704
    v_add_u32 v13, s69, v12
    s_xor_b32 s68, s66, 1
    s_lshl_b32 s69, s67, 1
    s_add_u32 s68, s68, s69
    s_lshl_b32 s69, s68, 7
    s_add_u32 s69, s69, 65536
    v_add_u32 v11, s69, v7
    s_lshl_b32 s68, s68, 6
    v_add_u32 v14, s68, v2
    s_mul_i32 s69, s67, -17408
    s_add_u32 s69, s69, 8704
    v_add_u32 v15, s69, v14
    s_waitcnt lgkmcnt(0)
    s_barrier
    ds_read_b64 v[8:9], v3
    ds_read_b128 v[128:131], v10 offset:0
    ds_read_b128 v[132:135], v10 offset:32
    ds_read_b128 v[136:139], v10 offset:64
    ds_read_b128 v[140:143], v10 offset:96
    ds_read_b128 v[144:147], v11 offset:0
    ds_read_b128 v[148:151], v11 offset:32
    ds_read_b128 v[152:155], v11 offset:64
    ds_read_b128 v[156:159], v11 offset:96
    s_waitcnt lgkmcnt(8)
    v_mov_b32 v16, v9
    s_waitcnt lgkmcnt(7)
    v_pk_mul_f32 v[160:161], v[128:129], v[6:7] op_sel_hi:[1,0]
    v_pk_mul_f32 v[162:163], v[130:131], v[6:7] op_sel_hi:[1,0]
    v_pk_mul_f32 v[164:165], v[128:129], v[16:17] op_sel_hi:[1,0]
    v_pk_mul_f32 v[166:167], v[130:131], v[16:17] op_sel_hi:[1,0]
    v_pk_fma_f32 v[160:161], v[64:65], v[4:5], v[160:161] op_sel_hi:[1,0,1]
    v_pk_fma_f32 v[162:163], v[66:67], v[4:5], v[162:163] op_sel_hi:[1,0,1]
    v_pk_fma_f32 v[164:165], v[80:81], v[8:9], v[164:165] op_sel_hi:[1,0,1]
    v_pk_fma_f32 v[166:167], v[82:83], v[8:9], v[166:167] op_sel_hi:[1,0,1]
    v_cvt_pk_bf16_f32 v64, v160, v161
    v_cvt_pk_bf16_f32 v65, v162, v163
    v_cvt_pk_bf16_f32 v80, v164, v165
    v_cvt_pk_bf16_f32 v81, v166, v167
    ds_write_b64 v12, v[64:65] offset:0
    ds_write_b64 v13, v[80:81] offset:0
    s_waitcnt lgkmcnt(8)
    v_pk_mul_f32 v[160:161], v[132:133], v[6:7] op_sel_hi:[1,0]
    v_pk_mul_f32 v[162:163], v[134:135], v[6:7] op_sel_hi:[1,0]
    v_pk_mul_f32 v[164:165], v[132:133], v[16:17] op_sel_hi:[1,0]
    v_pk_mul_f32 v[166:167], v[134:135], v[16:17] op_sel_hi:[1,0]
    v_pk_fma_f32 v[160:161], v[68:69], v[4:5], v[160:161] op_sel_hi:[1,0,1]
    v_pk_fma_f32 v[162:163], v[70:71], v[4:5], v[162:163] op_sel_hi:[1,0,1]
    v_pk_fma_f32 v[164:165], v[84:85], v[8:9], v[164:165] op_sel_hi:[1,0,1]
    v_pk_fma_f32 v[166:167], v[86:87], v[8:9], v[166:167] op_sel_hi:[1,0,1]
    v_cvt_pk_bf16_f32 v68, v160, v161
    v_cvt_pk_bf16_f32 v69, v162, v163
    v_cvt_pk_bf16_f32 v84, v164, v165
    v_cvt_pk_bf16_f32 v85, v166, v167
    ds_write_b64 v12, v[68:69] offset:16
    ds_write_b64 v13, v[84:85] offset:16
    s_waitcnt lgkmcnt(9)
    v_pk_mul_f32 v[160:161], v[136:137], v[6:7] op_sel_hi:[1,0]
    v_pk_mul_f32 v[162:163], v[138:139], v[6:7] op_sel_hi:[1,0]
    v_pk_mul_f32 v[164:165], v[136:137], v[16:17] op_sel_hi:[1,0]
    v_pk_mul_f32 v[166:167], v[138:139], v[16:17] op_sel_hi:[1,0]
    v_pk_fma_f32 v[160:161], v[72:73], v[4:5], v[160:161] op_sel_hi:[1,0,1]
    v_pk_fma_f32 v[162:163], v[74:75], v[4:5], v[162:163] op_sel_hi:[1,0,1]
    v_pk_fma_f32 v[164:165], v[88:89], v[8:9], v[164:165] op_sel_hi:[1,0,1]
    v_pk_fma_f32 v[166:167], v[90:91], v[8:9], v[166:167] op_sel_hi:[1,0,1]
    v_cvt_pk_bf16_f32 v72, v160, v161
    v_cvt_pk_bf16_f32 v73, v162, v163
    v_cvt_pk_bf16_f32 v88, v164, v165
    v_cvt_pk_bf16_f32 v89, v166, v167
    ds_write_b64 v12, v[72:73] offset:32
    ds_write_b64 v13, v[88:89] offset:32
    s_waitcnt lgkmcnt(10)
    v_pk_mul_f32 v[160:161], v[140:141], v[6:7] op_sel_hi:[1,0]
    v_pk_mul_f32 v[162:163], v[142:143], v[6:7] op_sel_hi:[1,0]
    v_pk_mul_f32 v[164:165], v[140:141], v[16:17] op_sel_hi:[1,0]
    v_pk_mul_f32 v[166:167], v[142:143], v[16:17] op_sel_hi:[1,0]
    v_pk_fma_f32 v[160:161], v[76:77], v[4:5], v[160:161] op_sel_hi:[1,0,1]
    v_pk_fma_f32 v[162:163], v[78:79], v[4:5], v[162:163] op_sel_hi:[1,0,1]
    v_pk_fma_f32 v[164:165], v[92:93], v[8:9], v[164:165] op_sel_hi:[1,0,1]
    v_pk_fma_f32 v[166:167], v[94:95], v[8:9], v[166:167] op_sel_hi:[1,0,1]
    v_cvt_pk_bf16_f32 v76, v160, v161
    v_cvt_pk_bf16_f32 v77, v162, v163
    v_cvt_pk_bf16_f32 v92, v164, v165
    v_cvt_pk_bf16_f32 v93, v166, v167
    ds_write_b64 v12, v[76:77] offset:48
    ds_write_b64 v13, v[92:93] offset:48
    s_waitcnt lgkmcnt(11)
    v_pk_mul_f32 v[160:161], v[144:145], v[6:7] op_sel_hi:[1,0]
    v_pk_mul_f32 v[162:163], v[146:147], v[6:7] op_sel_hi:[1,0]
    v_pk_mul_f32 v[164:165], v[144:145], v[16:17] op_sel_hi:[1,0]
    v_pk_mul_f32 v[166:167], v[146:147], v[16:17] op_sel_hi:[1,0]
    v_pk_fma_f32 v[160:161], v[96:97], v[4:5], v[160:161] op_sel_hi:[1,0,1]
    v_pk_fma_f32 v[162:163], v[98:99], v[4:5], v[162:163] op_sel_hi:[1,0,1]
    v_pk_fma_f32 v[164:165], v[112:113], v[8:9], v[164:165] op_sel_hi:[1,0,1]
    v_pk_fma_f32 v[166:167], v[114:115], v[8:9], v[166:167] op_sel_hi:[1,0,1]
    v_cvt_pk_bf16_f32 v96, v160, v161
    v_cvt_pk_bf16_f32 v97, v162, v163
    v_cvt_pk_bf16_f32 v112, v164, v165
    v_cvt_pk_bf16_f32 v113, v166, v167
    ds_write_b64 v14, v[96:97] offset:0
    ds_write_b64 v15, v[112:113] offset:0
    s_waitcnt lgkmcnt(12)
    v_pk_mul_f32 v[160:161], v[148:149], v[6:7] op_sel_hi:[1,0]
    v_pk_mul_f32 v[162:163], v[150:151], v[6:7] op_sel_hi:[1,0]
    v_pk_mul_f32 v[164:165], v[148:149], v[16:17] op_sel_hi:[1,0]
    v_pk_mul_f32 v[166:167], v[150:151], v[16:17] op_sel_hi:[1,0]
    v_pk_fma_f32 v[160:161], v[100:101], v[4:5], v[160:161] op_sel_hi:[1,0,1]
    v_pk_fma_f32 v[162:163], v[102:103], v[4:5], v[162:163] op_sel_hi:[1,0,1]
    v_pk_fma_f32 v[164:165], v[116:117], v[8:9], v[164:165] op_sel_hi:[1,0,1]
    v_pk_fma_f32 v[166:167], v[118:119], v[8:9], v[166:167] op_sel_hi:[1,0,1]
    v_cvt_pk_bf16_f32 v100, v160, v161
    v_cvt_pk_bf16_f32 v101, v162, v163
    v_cvt_pk_bf16_f32 v116, v164, v165
    v_cvt_pk_bf16_f32 v117, v166, v167
    ds_write_b64 v14, v[100:101] offset:16
    ds_write_b64 v15, v[116:117] offset:16
    s_waitcnt lgkmcnt(13)
    v_pk_mul_f32 v[160:161], v[152:153], v[6:7] op_sel_hi:[1,0]
    v_pk_mul_f32 v[162:163], v[154:155], v[6:7] op_sel_hi:[1,0]
    v_pk_mul_f32 v[164:165], v[152:153], v[16:17] op_sel_hi:[1,0]
    v_pk_mul_f32 v[166:167], v[154:155], v[16:17] op_sel_hi:[1,0]
    v_pk_fma_f32 v[160:161], v[104:105], v[4:5], v[160:161] op_sel_hi:[1,0,1]
    v_pk_fma_f32 v[162:163], v[106:107], v[4:5], v[162:163] op_sel_hi:[1,0,1]
    v_pk_fma_f32 v[164:165], v[120:121], v[8:9], v[164:165] op_sel_hi:[1,0,1]
    v_pk_fma_f32 v[166:167], v[122:123], v[8:9], v[166:167] op_sel_hi:[1,0,1]
    v_cvt_pk_bf16_f32 v104, v160, v161
    v_cvt_pk_bf16_f32 v105, v162, v163
    v_cvt_pk_bf16_f32 v120, v164, v165
    v_cvt_pk_bf16_f32 v121, v166, v167
    ds_write_b64 v14, v[104:105] offset:32
    ds_write_b64 v15, v[120:121] offset:32
    s_waitcnt lgkmcnt(14)
    v_pk_mul_f32 v[160:161], v[156:157], v[6:7] op_sel_hi:[1,0]
    v_pk_mul_f32 v[162:163], v[158:159], v[6:7] op_sel_hi:[1,0]
    v_pk_mul_f32 v[164:165], v[156:157], v[16:17] op_sel_hi:[1,0]
    v_pk_mul_f32 v[166:167], v[158:159], v[16:17] op_sel_hi:[1,0]
    v_pk_fma_f32 v[160:161], v[108:109], v[4:5], v[160:161] op_sel_hi:[1,0,1]
    v_pk_fma_f32 v[162:163], v[110:111], v[4:5], v[162:163] op_sel_hi:[1,0,1]
    v_pk_fma_f32 v[164:165], v[124:125], v[8:9], v[164:165] op_sel_hi:[1,0,1]
    v_pk_fma_f32 v[166:167], v[126:127], v[8:9], v[166:167] op_sel_hi:[1,0,1]
    v_cvt_pk_bf16_f32 v108, v160, v161
    v_cvt_pk_bf16_f32 v109, v162, v163
    v_cvt_pk_bf16_f32 v124, v164, v165
    v_cvt_pk_bf16_f32 v125, v166, v167
    ds_write_b64 v14, v[108:109] offset:48
    s_waitcnt lgkmcnt(14)
    ds_write_b64 v15, v[124:125] offset:48
    s_mul_hi_u32 s66, s45, 0x33333334
    s_mul_i32 s67, s66, 5
    s_sub_u32 s67, s45, s67
    s_mul_i32 s67, s67, 30720
    s_mov_b32 s68, 163840
    s_cmp_eq_u32 s66, 1
    s_cselect_b32 s68, 0, s68
    s_cmp_eq_u32 s66, 2
    s_cselect_b32 s68, 327680, s68
    s_add_u32 s67, s67, s68
    s_mul_i32 s66, s44, 606208
    s_add_u32 s66, s66, s67
    s_add_u32 s66, s66, 131072
    s_waitcnt lgkmcnt(0)
    s_barrier
    ds_read_b128 v[128:131], v226
    ds_read_b128 v[132:135], v227
    ds_read_b128 v[136:139], v228
    ds_read_b128 v[140:143], v229
    ds_read_b128 v[144:147], v230
    ds_read_b128 v[148:151], v231
    ds_read_b128 v[152:155], v232
    ds_read_b128 v[156:159], v233
    s_waitcnt lgkmcnt(7)
    buffer_store_dwordx4 v[128:131], v234, s[24:27], s66 offen sc1
    s_waitcnt lgkmcnt(6)
    buffer_store_dwordx4 v[132:135], v235, s[24:27], s66 offen sc1
    s_waitcnt lgkmcnt(5)
    buffer_store_dwordx4 v[136:139], v236, s[24:27], s66 offen sc1
    s_waitcnt lgkmcnt(4)
    buffer_store_dwordx4 v[140:143], v237, s[24:27], s66 offen sc1
    s_waitcnt lgkmcnt(3)
    buffer_store_dwordx4 v[144:147], v238, s[24:27], s66 offen sc1
    s_waitcnt lgkmcnt(2)
    buffer_store_dwordx4 v[148:151], v239, s[24:27], s66 offen sc1
    s_waitcnt lgkmcnt(1)
    buffer_store_dwordx4 v[152:155], v240, s[24:27], s66 offen sc1
    s_waitcnt lgkmcnt(0)
    buffer_store_dwordx4 v[156:159], v241, s[24:27], s66 offen sc1
    s_waitcnt vmcnt(8)
    s_bitcmp1_b32 s80, 0
    s_cbranch_scc0 L_rpd_7
    ds_read_b64_tr_b16 a[0:1], v222 offset:0
    ds_read_b64_tr_b16 a[2:3], v223 offset:0
    ds_read_b64_tr_b16 a[4:5], v222 offset:32
    ds_read_b64_tr_b16 a[6:7], v223 offset:32
    ds_read_b64_tr_b16 a[8:9], v222 offset:64
    ds_read_b64_tr_b16 a[10:11], v223 offset:64
    ds_read_b64_tr_b16 a[12:13], v222 offset:96
    ds_read_b64_tr_b16 a[14:15], v223 offset:96
    s_bitcmp1_b32 s80, 1
    s_cbranch_scc1 L_rp7_8
    ds_read_b64_tr_b16 a[16:17], v224 offset:0
    ds_read_b64_tr_b16 a[18:19], v225 offset:0
    s_waitcnt lgkmcnt(0)
    s_add_u32 s60, s77, 0
    buffer_store_dwordx4 a[0:3], v220, s[24:27], s60 offen sc1
    s_add_u32 s60, s77, 1024
    buffer_store_dwordx4 a[4:7], v220, s[24:27], s60 offen sc1
    s_add_u32 s60, s77, 2048
    buffer_store_dwordx4 a[8:11], v220, s[24:27], s60 offen sc1
    s_add_u32 s60, s77, 3072
    buffer_store_dwordx4 a[12:15], v220, s[24:27], s60 offen sc1
    s_add_u32 s60, s77, 4096
    buffer_store_dwordx4 a[16:19], v220, s[24:27], s60 offen sc1
    s_branch L_rpd_7
L_rp7_8:
    ds_read_b64_tr_b16 a[16:17], v222 offset:128
    ds_read_b64_tr_b16 a[18:19], v223 offset:128
    ds_read_b64_tr_b16 a[20:21], v222 offset:160
    ds_read_b64_tr_b16 a[22:23], v223 offset:160
    ds_read_b64_tr_b16 a[24:25], v224 offset:0
    ds_read_b64_tr_b16 a[26:27], v225 offset:0
    s_waitcnt lgkmcnt(0)
    s_add_u32 s60, s77, 0
    buffer_store_dwordx4 a[0:3], v220, s[24:27], s60 offen sc1
    s_add_u32 s60, s77, 1024
    buffer_store_dwordx4 a[4:7], v220, s[24:27], s60 offen sc1
    s_add_u32 s60, s77, 2048
    buffer_store_dwordx4 a[8:11], v220, s[24:27], s60 offen sc1
    s_add_u32 s60, s77, 3072
    buffer_store_dwordx4 a[12:15], v220, s[24:27], s60 offen sc1
    s_add_u32 s60, s77, 4096
    buffer_store_dwordx4 a[16:19], v220, s[24:27], s60 offen sc1
    s_add_u32 s60, s77, 5120
    buffer_store_dwordx4 a[20:23], v220, s[24:27], s60 offen sc1
    s_add_u32 s60, s77, 6144
    buffer_store_dwordx4 a[24:27], v220, s[24:27], s60 offen sc1
L_rpd_7:
    s_mul_i32 s69, s44, 15
    s_add_u32 s69, s69, s45
    s_cmp_eq_u32 s80, 1
    s_cbranch_scc1 L_w5_11
    s_cmp_eq_u32 s80, 3
    s_cbranch_scc1 L_w7_12
    s_waitcnt vmcnt(0)
    s_branch L_wj_13
L_w5_11:
    s_waitcnt vmcnt(5)
    s_branch L_wj_13
L_w7_12:
    s_waitcnt vmcnt(7)
L_wj_13:
    v_readfirstlane_b32 s40, v198
    s_nop 0
    s_cmp_eq_u32 s40, 0
    s_cbranch_scc1 L_rare_14
L_back_15:
    s_barrier
    s_cmp_eq_u32 s3, 0
    s_cbranch_scc0 L_e1_10
    s_lshl_b32 s42, s69, 6
    s_add_u32 s42, s42, 0
    v_mov_b32 v1, 0
    v_mov_b32 v2, s40
    s_mov_b64 exec, 1
    buffer_store_dword v2, v1, s[24:27], s42 offen sc1
    s_mov_b64 exec, -1
L_e1_10:
    s_branch L_p1done
L_idle1:
    s_waitcnt lgkmcnt(0)
    s_mov_b32 s4, s44
    s_mov_b32 s5, s45
    s_mov_b32 s8, s46
    s_mov_b32 s9, s47
    s_mov_b32 s12, s48
    s_mov_b32 s13, s49
    s_mov_b32 s16, s52
    s_mov_b32 s17, s53
    s_mov_b32 s32, s54
    s_mov_b32 s33, s55
    s_mov_b32 s20, s56
    s_mov_b32 s21, s57
    s_mov_b32 s34, s58
    s_mov_b32 s35, s59
    s_mov_b32 s28, s60
    s_mov_b32 s29, s61
    s_mov_b32 s36, s62
    s_mov_b32 s37, s63
    s_mov_b32 s24, s64
    s_mov_b32 s25, s65
    s_lshl_b32 s60, s39, 2
    s_add_u32 s60, s60, s3
    s_cmp_ge_u32 s60, 55
    s_cbranch_scc1 L_sw_18
    s_lshl_b32 s61, s60, 7
    s_mov_b32 s62, s32
    s_mov_b32 s63, s33
    s_sub_u32 s64, s60, 27
    s_lshl_b32 s65, s64, 7
    s_cmp_ge_u32 s60, 27
    s_cselect_b32 s61, s65, s61
    s_cselect_b32 s62, s34, s62
    s_cselect_b32 s63, s35, s63
    s_sub_u32 s64, s60, 37
    s_lshl_b32 s65, s64, 21
    s_cmp_ge_u32 s60, 37
    s_cselect_b32 s61, s65, s61
    s_cselect_b32 s62, s28, s62
    s_cselect_b32 s63, s29, s63
    s_sub_u32 s64, s60, 39
    s_lshl_b32 s65, s64, 21
    s_add_u32 s65, s65, 0
    s_cmp_ge_u32 s60, 39
    s_cselect_b32 s61, s65, s61
    s_cselect_b32 s62, s24, s62
    s_cselect_b32 s63, s25, s63
    s_add_u32 s62, s62, s61
    s_addc_u32 s63, s63, 0
    s_load_dword s43, s[62:63], 0
L_sw_18:
    s_lshl_b32 s66, s38, 5
    s_add_u32 s83, s66, s39
    s_lshr_b32 s53, s83, 4
    s_and_b32 s54, s83, 15
    s_lshr_b32 s55, s83, 3
    s_and_b32 s56, s83, 7
    s_and_b32 s57, s56, 1
    s_mul_i32 s66, s54, 7
    s_mul_i32 s67, s54, 6
    s_add_u32 s67, s67, 12
    s_cmp_lt_u32 s54, 12
    s_cselect_b32 s58, s66, s67
    s_cselect_b32 s66, 1, 0
    s_and_b32 s59, s66, s54
    s_mov_b32 s60, 0
    s_mov_b32 s61, s55
    s_mov_b32 s62, 1
    s_cmp_eq_u32 s3, 1
    s_cbranch_scc1 L_j1_19
    s_cmp_eq_u32 s3, 2
    s_cbranch_scc1 L_j2_20
    s_cmp_eq_u32 s3, 3
    s_cbranch_scc1 L_j3_21
    s_branch L_jd_22
L_j1_19:
    s_add_u32 s63, s55, 32
    s_cmp_lt_u32 s55, 22
    s_cselect_b32 s61, s63, s61
    s_cbranch_scc1 L_jd_22
    s_cmp_ge_u32 s53, 12
    s_cselect_b32 s62, 1, 0
    s_cbranch_scc0 L_jd_22
    s_mov_b32 s60, 2
    s_add_u32 s61, s53, 4
    s_branch L_jd_22
L_j2_20:
    s_cmp_lt_u32 s55, 20
    s_cselect_b32 s62, 1, 0
    s_cselect_b32 s60, 1, 0
    s_branch L_jd_22
L_j3_21:
    s_mov_b32 s60, 2
    s_mov_b32 s61, s53
L_jd_22:
    s_cmp_eq_u32 s60, 1
    s_cselect_b32 s72, s12, s20
    s_cselect_b32 s73, s13, s21
    s_cselect_b32 s74, s14, s22
    s_cselect_b32 s64, 20, 54
    s_mov_b32 s63, 27262976
    s_cselect_b32 s63, 23068672, s63
    s_cmp_eq_u32 s60, 2
    s_cselect_b32 s72, s16, s72
    s_cselect_b32 s73, s17, s73
    s_cselect_b32 s74, s18, s74
    s_mov_b32 s75, 0x20000
    s_cselect_b32 s63, 24117248, s63
    s_cselect_b32 s64, 20, s64
    s_cselect_b32 s66, s54, s56
    s_cselect_b32 s68, s59, s57
    s_cselect_b32 s80, 2, 0
    s_mov_b32 s65, 1280
    s_cselect_b32 s65, 3456, s65
    s_mov_b32 s67, 5120
    s_cselect_b32 s67, 7168, s67
    s_mov_b32 s78, 0x03ff03ff
    s_cselect_b32 s78, 0x3fff3fff, s78
    s_mov_b32 s79, 0x03ff03ff
    s_cselect_b32 s79, 0x3fff3fff, s79
    s_or_b32 s80, s80, s62
    s_mul_i32 s66, s66, s64
    s_add_u32 s66, s66, s61
    s_mul_i32 s66, s66, s67
    s_add_u32 s77, s66, s63
    s_mul_i32 s66, s61, s65
    s_lshl_b32 s66, s66, 5
    s_lshl_b32 s67, s58, 5
    s_mul_i32 s63, s56, 160
    s_cmp_eq_u32 s60, 2
    s_cselect_b32 s67, s67, s63
    s_add_u32 s76, s66, s67
    v_lshrrev_b32 v1, 4, v0
    v_and_b32 v2, 15, v0
    v_mul_u32_u24 v3, s65, v1
    v_lshl_add_u32 v221, v2, 4, v3
    v_bfe_u32 v2, v0, 2, 2
    v_and_b32 v3, 3, v0
    v_lshlrev_b32 v3, 3, v3
    v_lshl_add_u32 v3, v2, 8, v3
    s_lshl_b32 s66, s3, 13
    s_add_u32 s66, s66, 131072
    v_add_u32 v3, s66, v3
    v_and_b32 v4, 1, v1
    v_lshlrev_b32 v4, 5, v4
    v_lshl_add_u32 v4, v1, 10, v4
    v_lshlrev_b32 v5, 11, v1
    s_cmp_eq_u32 s60, 1
    s_cselect_b64 vcc, -1, 0
    s_mov_b32 s66, 4096
    s_cselect_b32 s66, 1056, s66
    v_cndmask_b32 v4, v4, v5, vcc
    v_add_u32 v3, v3, v4
    s_lshl_b32 s67, s68, 5
    v_add_u32 v222, s67, v3
    v_add_u32 v223, s66, v222
    s_cmp_eq_u32 s60, 2
    s_mov_b32 s67, 128
    s_cselect_b32 s67, 192, s67
    s_cmp_eq_u32 s68, 0
    s_cselect_b32 s67, s67, 0
    v_add_u32 v224, s67, v3
    v_add_u32 v225, s66, v224
    s_mov_b32 s44, 0
    s_mov_b32 s45, 0
    s_mul_i32 s60, s44, 15
    s_add_u32 s60, s60, s45
    s_lshl_b32 s60, s60, 6
    s_lshl_b32 s61, s83, 6
    v_mov_b32 v1, 81920
    v_mul_u32_u24 v2, 16384, v0
    v_cmp_eq_u32 vcc, 4, v0
    s_nop 1
    v_cndmask_b32 v2, v2, v1, vcc
    v_add_u32 v2, s61, v2
    v_mov_b32 v1, s60
    v_cmp_eq_u32 vcc, 0, v0
    s_nop 1
    v_cndmask_b32 v2, v2, v1, vcc
    s_mov_b64 exec, 0x1f
    buffer_load_dword v199, v2, s[24:27], 0 offen sc1
    s_mov_b64 exec, -1
    v_cmp_le_u32 vcc, 2, v0
    s_nop 1
    v_cndmask_b32 v1, 0, 1, vcc
    v_cmp_le_u32 vcc, 8, v0
    s_nop 1
    v_cndmask_b32 v2, 0, 1, vcc
    v_add_u32 v3, v1, v2
    v_mul_u32_u24 v4, 6, v2
    v_sub_u32 v4, v0, v4
    v_subrev_u32 v4, 2, v4
    v_lshrrev_b32 v4, 1, v4
    v_mul_u32_u24 v4, v4, v1
    v_and_b32 v4, 3, v4
    v_sub_u32 v5, s53, v4
    v_cmp_gt_i32 vcc, 0, v5
    v_mov_b32 v6, s53
    s_nop 0
    v_cndmask_b32 v5, v5, v6, vcc
    v_and_b32 v6, 1, v0
    v_lshlrev_b32 v6, 2, v6
    s_mul_i32 s66, s54, 5
    v_add_u32 v6, s66, v6
    v_lshrrev_b32 v6, 4, v6
    v_mul_u32_u24 v3, 5, v3
    v_add_u32 v6, v6, v3
    v_mul_u32_u24 v5, 15, v5
    v_add_u32 v5, v5, v6
    v_lshlrev_b32 v5, 6, v5
    v_add_u32 v192, 0, v5
    v_and_b32 v1, 31, v0
    v_lshl_add_u32 v2, v1, 3, s56
    s_lshl_b32 s66, s38, 5
    v_add_u32 v3, s66, v1
    v_cmp_gt_u32 vcc, 32, v0
    s_nop 1
    v_cndmask_b32 v2, v3, v2, vcc
    v_lshlrev_b32 v2, 6, v2
    v_add_u32 v193, 81920, v2
    s_mul_hi_u32 s66, s54, 0x55555556
    s_mul_i32 s67, s66, 3
    s_cmp_eq_u32 s67, s54
    s_cselect_b32 s60, s66, 5
    s_cmp_eq_u32 s60, 0
    s_cselect_b32 s60, 5, s60
    s_cmp_eq_u32 s54, 15
    s_cselect_b32 s60, 5, s60
    s_lshl_b32 s61, s60, 4
    s_sub_u32 s62, 80, s61
    s_lshl_b32 s63, s60, 11
    s_sub_u32 s63, s63, s61
    v_mul_u32_u24 v2, 205, v0
    v_lshrrev_b32 v2, 10, v2
    v_mul_u32_u24 v3, 5, v2
    v_sub_u32 v3, v0, v3
    v_cmp_gt_u32 vcc, s60, v3
    v_mov_b32 v5, s61
    v_mov_b32 v6, s62
    v_cndmask_b32 v195, v6, v5, vcc
    v_mov_b32 v5, s63
    v_cndmask_b32 v5, v5, 0, vcc
    v_lshl_add_u32 v5, v3, 4, v5
    v_mad_u32_u24 v194, v2, v195, v5
    v_mul_u32_u24 v2, 43, v0
    v_lshrrev_b32 v2, 8, v2
    v_mul_u32_u24 v3, 6, v2
    v_sub_u32 v3, v0, v3
    v_cmp_gt_u32 vcc, s60, v3
    v_mov_b32 v5, s61
    v_mov_b32 v6, s62
    v_cndmask_b32 v197, v6, v5, vcc
    v_mov_b32 v5, s63
    v_cndmask_b32 v5, v5, 0, vcc
    v_lshl_add_u32 v5, v3, 4, v5
    v_mad_u32_u24 v196, v2, v197, v5
    s_cmp_eq_u32 s2, 57
    s_cbranch_scc0 L_nn_24
    s_cmp_eq_u32 s3, 0
    s_cbranch_scc0 L_nn_24
    s_memrealtime s[66:67]
    s_waitcnt lgkmcnt(0)
    s_or_b32 s66, s66, 1
    v_mov_b32 v1, 0
    v_mov_b32 v2, s66
    s_mov_b64 exec, 1
    global_store_dword v1, v2, s[36:37] sc1
    s_mov_b64 exec, -1
L_nn_24:
    s_lshl_b32 s60, s3, 13
    s_add_u32 s60, s60, 131072
    s_bitcmp1_b32 s80, 1
    s_mov_b32 s61, 5120
    s_cselect_b32 s61, 13824, s61
    s_mov_b32 s62, s76
    s_mov_b64 exec, s[78:79]
    s_add_u32 m0, s60, 0
    s_nop 0
    buffer_load_dwordx4 v221, s[72:75], s62 offen lds
    s_add_u32 s62, s62, s61
    s_add_u32 m0, s60, 1056
    s_nop 0
    buffer_load_dwordx4 v221, s[72:75], s62 offen lds
    s_add_u32 s62, s62, s61
    s_add_u32 m0, s60, 2048
    s_nop 0
    buffer_load_dwordx4 v221, s[72:75], s62 offen lds
    s_add_u32 s62, s62, s61
    s_add_u32 m0, s60, 3104
    s_nop 0
    buffer_load_dwordx4 v221, s[72:75], s62 offen lds
    s_add_u32 s62, s62, s61
    s_add_u32 m0, s60, 4096
    s_nop 0
    buffer_load_dwordx4 v221, s[72:75], s62 offen lds
    s_add_u32 s62, s62, s61
    s_add_u32 m0, s60, 5152
    s_nop 0
    buffer_load_dwordx4 v221, s[72:75], s62 offen lds
    s_add_u32 s62, s62, s61
    s_add_u32 m0, s60, 6144
    s_nop 0
    buffer_load_dwordx4 v221, s[72:75], s62 offen lds
    s_add_u32 s62, s62, s61
    s_add_u32 m0, s60, 7200
    s_nop 0
    buffer_load_dwordx4 v221, s[72:75], s62 offen lds
    s_add_u32 s62, s62, s61
    s_mov_b64 exec, -1
    s_lshr_b32 s44, s38, 1
    s_lshl_b32 s44, s44, 2
    s_lshr_b32 s66, s39, 3
    s_add_u32 s44, s44, s66
    s_mul_i32 s66, s44, 7
    s_mul_i32 s67, s44, 6
    s_add_u32 s67, s67, 12
    s_cmp_lt_u32 s44, 12
    s_cselect_b32 s45, s66, s67
    v_and_b32 v1, 15, v0
    v_min_u32 v1, 13, v1
    v_lshrrev_b32 v2, 4, v0
    s_lshl_b32 s66, s3, 2
    v_add_u32 v2, s66, v2
    v_mul_u32_u24 v2, 3456, v2
    v_lshl_add_u32 v2, v1, 4, v2
    s_lshl_b32 s46, s45, 5
    v_mov_b32 v8, 0
    v_mov_b32 v9, 0
    v_mov_b32 v10, 0
    v_mov_b32 v11, 0
    v_mov_b32 v12, 0
    v_mov_b32 v13, 0
    v_mov_b32 v14, 0
    v_mov_b32 v15, 0
    s_add_u32 s47, s46, 0
    buffer_load_dwordx4 v[32:35], v2, s[16:19], s47 offen
    s_add_u32 s47, s46, 55296
    buffer_load_dwordx4 v[36:39], v2, s[16:19], s47 offen
    s_add_u32 s47, s46, 110592
    buffer_load_dwordx4 v[40:43], v2, s[16:19], s47 offen
    s_add_u32 s47, s46, 165888
    buffer_load_dwordx4 v[44:47], v2, s[16:19], s47 offen
    s_add_u32 s47, s46, 221184
    buffer_load_dwordx4 v[48:51], v2, s[16:19], s47 offen
    s_add_u32 s47, s46, 276480
    buffer_load_dwordx4 v[52:55], v2, s[16:19], s47 offen
    s_add_u32 s47, s46, 331776
    buffer_load_dwordx4 v[56:59], v2, s[16:19], s47 offen
    s_add_u32 s47, s46, 387072
    buffer_load_dwordx4 v[60:63], v2, s[16:19], s47 offen
    s_add_u32 s47, s46, 442368
    buffer_load_dwordx4 v[64:67], v2, s[16:19], s47 offen
    s_add_u32 s47, s46, 497664
    buffer_load_dwordx4 v[68:71], v2, s[16:19], s47 offen
    s_waitcnt vmcnt(9)
    v_lshlrev_b32 v4, 16, v32
    v_and_b32 v5, 0xffff0000, v32
    v_pk_add_f32 v[8:9], v[8:9], v[4:5]
    v_lshlrev_b32 v4, 16, v33
    v_and_b32 v5, 0xffff0000, v33
    v_pk_add_f32 v[10:11], v[10:11], v[4:5]
    v_lshlrev_b32 v4, 16, v34
    v_and_b32 v5, 0xffff0000, v34
    v_pk_add_f32 v[12:13], v[12:13], v[4:5]
    v_lshlrev_b32 v4, 16, v35
    v_and_b32 v5, 0xffff0000, v35
    v_pk_add_f32 v[14:15], v[14:15], v[4:5]
    s_waitcnt vmcnt(8)
    v_lshlrev_b32 v4, 16, v36
    v_and_b32 v5, 0xffff0000, v36
    v_pk_add_f32 v[8:9], v[8:9], v[4:5]
    v_lshlrev_b32 v4, 16, v37
    v_and_b32 v5, 0xffff0000, v37
    v_pk_add_f32 v[10:11], v[10:11], v[4:5]
    v_lshlrev_b32 v4, 16, v38
    v_and_b32 v5, 0xffff0000, v38
    v_pk_add_f32 v[12:13], v[12:13], v[4:5]
    v_lshlrev_b32 v4, 16, v39
    v_and_b32 v5, 0xffff0000, v39
    v_pk_add_f32 v[14:15], v[14:15], v[4:5]
    s_waitcnt vmcnt(7)
    v_lshlrev_b32 v4, 16, v40
    v_and_b32 v5, 0xffff0000, v40
    v_pk_add_f32 v[8:9], v[8:9], v[4:5]
    v_lshlrev_b32 v4, 16, v41
    v_and_b32 v5, 0xffff0000, v41
    v_pk_add_f32 v[10:11], v[10:11], v[4:5]
    v_lshlrev_b32 v4, 16, v42
    v_and_b32 v5, 0xffff0000, v42
    v_pk_add_f32 v[12:13], v[12:13], v[4:5]
    v_lshlrev_b32 v4, 16, v43
    v_and_b32 v5, 0xffff0000, v43
    v_pk_add_f32 v[14:15], v[14:15], v[4:5]
    s_waitcnt vmcnt(6)
    v_lshlrev_b32 v4, 16, v44
    v_and_b32 v5, 0xffff0000, v44
    v_pk_add_f32 v[8:9], v[8:9], v[4:5]
    v_lshlrev_b32 v4, 16, v45
    v_and_b32 v5, 0xffff0000, v45
    v_pk_add_f32 v[10:11], v[10:11], v[4:5]
    v_lshlrev_b32 v4, 16, v46
    v_and_b32 v5, 0xffff0000, v46
    v_pk_add_f32 v[12:13], v[12:13], v[4:5]
    v_lshlrev_b32 v4, 16, v47
    v_and_b32 v5, 0xffff0000, v47
    v_pk_add_f32 v[14:15], v[14:15], v[4:5]
    s_waitcnt vmcnt(5)
    v_lshlrev_b32 v4, 16, v48
    v_and_b32 v5, 0xffff0000, v48
    v_pk_add_f32 v[8:9], v[8:9], v[4:5]
    v_lshlrev_b32 v4, 16, v49
    v_and_b32 v5, 0xffff0000, v49
    v_pk_add_f32 v[10:11], v[10:11], v[4:5]
    v_lshlrev_b32 v4, 16, v50
    v_and_b32 v5, 0xffff0000, v50
    v_pk_add_f32 v[12:13], v[12:13], v[4:5]
    v_lshlrev_b32 v4, 16, v51
    v_and_b32 v5, 0xffff0000, v51
    v_pk_add_f32 v[14:15], v[14:15], v[4:5]
    s_waitcnt vmcnt(4)
    v_lshlrev_b32 v4, 16, v52
    v_and_b32 v5, 0xffff0000, v52
    v_pk_add_f32 v[8:9], v[8:9], v[4:5]
    v_lshlrev_b32 v4, 16, v53
    v_and_b32 v5, 0xffff0000, v53
    v_pk_add_f32 v[10:11], v[10:11], v[4:5]
    v_lshlrev_b32 v4, 16, v54
    v_and_b32 v5, 0xffff0000, v54
    v_pk_add_f32 v[12:13], v[12:13], v[4:5]
    v_lshlrev_b32 v4, 16, v55
    v_and_b32 v5, 0xffff0000, v55
    v_pk_add_f32 v[14:15], v[14:15], v[4:5]
    s_waitcnt vmcnt(3)
    v_lshlrev_b32 v4, 16, v56
    v_and_b32 v5, 0xffff0000, v56
    v_pk_add_f32 v[8:9], v[8:9], v[4:5]
    v_lshlrev_b32 v4, 16, v57
    v_and_b32 v5, 0xffff0000, v57
    v_pk_add_f32 v[10:11], v[10:11], v[4:5]
    v_lshlrev_b32 v4, 16, v58
    v_and_b32 v5, 0xffff0000, v58
    v_pk_add_f32 v[12:13], v[12:13], v[4:5]
    v_lshlrev_b32 v4, 16, v59
    v_and_b32 v5, 0xffff0000, v59
    v_pk_add_f32 v[14:15], v[14:15], v[4:5]
    s_waitcnt vmcnt(2)
    v_lshlrev_b32 v4, 16, v60
    v_and_b32 v5, 0xffff0000, v60
    v_pk_add_f32 v[8:9], v[8:9], v[4:5]
    v_lshlrev_b32 v4, 16, v61
    v_and_b32 v5, 0xffff0000, v61
    v_pk_add_f32 v[10:11], v[10:11], v[4:5]
    v_lshlrev_b32 v4, 16, v62
    v_and_b32 v5, 0xffff0000, v62
    v_pk_add_f32 v[12:13], v[12:13], v[4:5]
    v_lshlrev_b32 v4, 16, v63
    v_and_b32 v5, 0xffff0000, v63
    v_pk_add_f32 v[14:15], v[14:15], v[4:5]
    s_waitcnt vmcnt(1)
    v_lshlrev_b32 v4, 16, v64
    v_and_b32 v5, 0xffff0000, v64
    v_pk_add_f32 v[8:9], v[8:9], v[4:5]
    v_lshlrev_b32 v4, 16, v65
    v_and_b32 v5, 0xffff0000, v65
    v_pk_add_f32 v[10:11], v[10:11], v[4:5]
    v_lshlrev_b32 v4, 16, v66
    v_and_b32 v5, 0xffff0000, v66
    v_pk_add_f32 v[12:13], v[12:13], v[4:5]
    v_lshlrev_b32 v4, 16, v67
    v_and_b32 v5, 0xffff0000, v67
    v_pk_add_f32 v[14:15], v[14:15], v[4:5]
    s_waitcnt vmcnt(0)
    v_lshlrev_b32 v4, 16, v68
    v_and_b32 v5, 0xffff0000, v68
    v_pk_add_f32 v[8:9], v[8:9], v[4:5]
    v_lshlrev_b32 v4, 16, v69
    v_and_b32 v5, 0xffff0000, v69
    v_pk_add_f32 v[10:11], v[10:11], v[4:5]
    v_lshlrev_b32 v4, 16, v70
    v_and_b32 v5, 0xffff0000, v70
    v_pk_add_f32 v[12:13], v[12:13], v[4:5]
    v_lshlrev_b32 v4, 16, v71
    v_and_b32 v5, 0xffff0000, v71
    v_pk_add_f32 v[14:15], v[14:15], v[4:5]
    s_add_u32 s47, s46, 552960
    buffer_load_dwordx4 v[32:35], v2, s[16:19], s47 offen
    s_add_u32 s47, s46, 608256
    buffer_load_dwordx4 v[36:39], v2, s[16:19], s47 offen
    s_add_u32 s47, s46, 663552
    buffer_load_dwordx4 v[40:43], v2, s[16:19], s47 offen
    s_add_u32 s47, s46, 718848
    buffer_load_dwordx4 v[44:47], v2, s[16:19], s47 offen
    s_add_u32 s47, s46, 774144
    buffer_load_dwordx4 v[48:51], v2, s[16:19], s47 offen
    s_add_u32 s47, s46, 829440
    buffer_load_dwordx4 v[52:55], v2, s[16:19], s47 offen
    s_add_u32 s47, s46, 884736
    buffer_load_dwordx4 v[56:59], v2, s[16:19], s47 offen
    s_add_u32 s47, s46, 940032
    buffer_load_dwordx4 v[60:63], v2, s[16:19], s47 offen
    s_add_u32 s47, s46, 995328
    buffer_load_dwordx4 v[64:67], v2, s[16:19], s47 offen
    s_add_u32 s47, s46, 1050624
    buffer_load_dwordx4 v[68:71], v2, s[16:19], s47 offen
    s_waitcnt vmcnt(9)
    v_lshlrev_b32 v4, 16, v32
    v_and_b32 v5, 0xffff0000, v32
    v_pk_add_f32 v[8:9], v[8:9], v[4:5]
    v_lshlrev_b32 v4, 16, v33
    v_and_b32 v5, 0xffff0000, v33
    v_pk_add_f32 v[10:11], v[10:11], v[4:5]
    v_lshlrev_b32 v4, 16, v34
    v_and_b32 v5, 0xffff0000, v34
    v_pk_add_f32 v[12:13], v[12:13], v[4:5]
    v_lshlrev_b32 v4, 16, v35
    v_and_b32 v5, 0xffff0000, v35
    v_pk_add_f32 v[14:15], v[14:15], v[4:5]
    s_waitcnt vmcnt(8)
    v_lshlrev_b32 v4, 16, v36
    v_and_b32 v5, 0xffff0000, v36
    v_pk_add_f32 v[8:9], v[8:9], v[4:5]
    v_lshlrev_b32 v4, 16, v37
    v_and_b32 v5, 0xffff0000, v37
    v_pk_add_f32 v[10:11], v[10:11], v[4:5]
    v_lshlrev_b32 v4, 16, v38
    v_and_b32 v5, 0xffff0000, v38
    v_pk_add_f32 v[12:13], v[12:13], v[4:5]
    v_lshlrev_b32 v4, 16, v39
    v_and_b32 v5, 0xffff0000, v39
    v_pk_add_f32 v[14:15], v[14:15], v[4:5]
    s_waitcnt vmcnt(7)
    v_lshlrev_b32 v4, 16, v40
    v_and_b32 v5, 0xffff0000, v40
    v_pk_add_f32 v[8:9], v[8:9], v[4:5]
    v_lshlrev_b32 v4, 16, v41
    v_and_b32 v5, 0xffff0000, v41
    v_pk_add_f32 v[10:11], v[10:11], v[4:5]
    v_lshlrev_b32 v4, 16, v42
    v_and_b32 v5, 0xffff0000, v42
    v_pk_add_f32 v[12:13], v[12:13], v[4:5]
    v_lshlrev_b32 v4, 16, v43
    v_and_b32 v5, 0xffff0000, v43
    v_pk_add_f32 v[14:15], v[14:15], v[4:5]
    s_waitcnt vmcnt(6)
    v_lshlrev_b32 v4, 16, v44
    v_and_b32 v5, 0xffff0000, v44
    v_pk_add_f32 v[8:9], v[8:9], v[4:5]
    v_lshlrev_b32 v4, 16, v45
    v_and_b32 v5, 0xffff0000, v45
    v_pk_add_f32 v[10:11], v[10:11], v[4:5]
    v_lshlrev_b32 v4, 16, v46
    v_and_b32 v5, 0xffff0000, v46
    v_pk_add_f32 v[12:13], v[12:13], v[4:5]
    v_lshlrev_b32 v4, 16, v47
    v_and_b32 v5, 0xffff0000, v47
    v_pk_add_f32 v[14:15], v[14:15], v[4:5]
    s_waitcnt vmcnt(5)
    v_lshlrev_b32 v4, 16, v48
    v_and_b32 v5, 0xffff0000, v48
    v_pk_add_f32 v[8:9], v[8:9], v[4:5]
    v_lshlrev_b32 v4, 16, v49
    v_and_b32 v5, 0xffff0000, v49
    v_pk_add_f32 v[10:11], v[10:11], v[4:5]
    v_lshlrev_b32 v4, 16, v50
    v_and_b32 v5, 0xffff0000, v50
    v_pk_add_f32 v[12:13], v[12:13], v[4:5]
    v_lshlrev_b32 v4, 16, v51
    v_and_b32 v5, 0xffff0000, v51
    v_pk_add_f32 v[14:15], v[14:15], v[4:5]
    s_waitcnt vmcnt(4)
    v_lshlrev_b32 v4, 16, v52
    v_and_b32 v5, 0xffff0000, v52
    v_pk_add_f32 v[8:9], v[8:9], v[4:5]
    v_lshlrev_b32 v4, 16, v53
    v_and_b32 v5, 0xffff0000, v53
    v_pk_add_f32 v[10:11], v[10:11], v[4:5]
    v_lshlrev_b32 v4, 16, v54
    v_and_b32 v5, 0xffff0000, v54
    v_pk_add_f32 v[12:13], v[12:13], v[4:5]
    v_lshlrev_b32 v4, 16, v55
    v_and_b32 v5, 0xffff0000, v55
    v_pk_add_f32 v[14:15], v[14:15], v[4:5]
    s_waitcnt vmcnt(3)
    v_lshlrev_b32 v4, 16, v56
    v_and_b32 v5, 0xffff0000, v56
    v_pk_add_f32 v[8:9], v[8:9], v[4:5]
    v_lshlrev_b32 v4, 16, v57
    v_and_b32 v5, 0xffff0000, v57
    v_pk_add_f32 v[10:11], v[10:11], v[4:5]
    v_lshlrev_b32 v4, 16, v58
    v_and_b32 v5, 0xffff0000, v58
    v_pk_add_f32 v[12:13], v[12:13], v[4:5]
    v_lshlrev_b32 v4, 16, v59
    v_and_b32 v5, 0xffff0000, v59
    v_pk_add_f32 v[14:15], v[14:15], v[4:5]
    s_waitcnt vmcnt(2)
    v_lshlrev_b32 v4, 16, v60
    v_and_b32 v5, 0xffff0000, v60
    v_pk_add_f32 v[8:9], v[8:9], v[4:5]
    v_lshlrev_b32 v4, 16, v61
    v_and_b32 v5, 0xffff0000, v61
    v_pk_add_f32 v[10:11], v[10:11], v[4:5]
    v_lshlrev_b32 v4, 16, v62
    v_and_b32 v5, 0xffff0000, v62
    v_pk_add_f32 v[12:13], v[12:13], v[4:5]
    v_lshlrev_b32 v4, 16, v63
    v_and_b32 v5, 0xffff0000, v63
    v_pk_add_f32 v[14:15], v[14:15], v[4:5]
    s_waitcnt vmcnt(1)
    v_lshlrev_b32 v4, 16, v64
    v_and_b32 v5, 0xffff0000, v64
    v_pk_add_f32 v[8:9], v[8:9], v[4:5]
    v_lshlrev_b32 v4, 16, v65
    v_and_b32 v5, 0xffff0000, v65
    v_pk_add_f32 v[10:11], v[10:11], v[4:5]
    v_lshlrev_b32 v4, 16, v66
    v_and_b32 v5, 0xffff0000, v66
    v_pk_add_f32 v[12:13], v[12:13], v[4:5]
    v_lshlrev_b32 v4, 16, v67
    v_and_b32 v5, 0xffff0000, v67
    v_pk_add_f32 v[14:15], v[14:15], v[4:5]
    s_waitcnt vmcnt(0)
    v_lshlrev_b32 v4, 16, v68
    v_and_b32 v5, 0xffff0000, v68
    v_pk_add_f32 v[8:9], v[8:9], v[4:5]
    v_lshlrev_b32 v4, 16, v69
    v_and_b32 v5, 0xffff0000, v69
    v_pk_add_f32 v[10:11], v[10:11], v[4:5]
    v_lshlrev_b32 v4, 16, v70
    v_and_b32 v5, 0xffff0000, v70
    v_pk_add_f32 v[12:13], v[12:13], v[4:5]
    v_lshlrev_b32 v4, 16, v71
    v_and_b32 v5, 0xffff0000, v71
    v_pk_add_f32 v[14:15], v[14:15], v[4:5]
    s_add_u32 s47, s46, 1105920
    buffer_load_dwordx4 v[32:35], v2, s[16:19], s47 offen
    s_add_u32 s47, s46, 1161216
    buffer_load_dwordx4 v[36:39], v2, s[16:19], s47 offen
    s_add_u32 s47, s46, 1216512
    buffer_load_dwordx4 v[40:43], v2, s[16:19], s47 offen
    s_add_u32 s47, s46, 1271808
    buffer_load_dwordx4 v[44:47], v2, s[16:19], s47 offen
    s_add_u32 s47, s46, 1327104
    buffer_load_dwordx4 v[48:51], v2, s[16:19], s47 offen
    s_add_u32 s47, s46, 1382400
    buffer_load_dwordx4 v[52:55], v2, s[16:19], s47 offen
    s_add_u32 s47, s46, 1437696
    buffer_load_dwordx4 v[56:59], v2, s[16:19], s47 offen
    s_add_u32 s47, s46, 1492992
    buffer_load_dwordx4 v[60:63], v2, s[16:19], s47 offen
    s_add_u32 s47, s46, 1548288
    buffer_load_dwordx4 v[64:67], v2, s[16:19], s47 offen
    s_add_u32 s47, s46, 1603584
    buffer_load_dwordx4 v[68:71], v2, s[16:19], s47 offen
    s_waitcnt vmcnt(9)
    v_lshlrev_b32 v4, 16, v32
    v_and_b32 v5, 0xffff0000, v32
    v_pk_add_f32 v[8:9], v[8:9], v[4:5]
    v_lshlrev_b32 v4, 16, v33
    v_and_b32 v5, 0xffff0000, v33
    v_pk_add_f32 v[10:11], v[10:11], v[4:5]
    v_lshlrev_b32 v4, 16, v34
    v_and_b32 v5, 0xffff0000, v34
    v_pk_add_f32 v[12:13], v[12:13], v[4:5]
    v_lshlrev_b32 v4, 16, v35
    v_and_b32 v5, 0xffff0000, v35
    v_pk_add_f32 v[14:15], v[14:15], v[4:5]
    s_waitcnt vmcnt(8)
    v_lshlrev_b32 v4, 16, v36
    v_and_b32 v5, 0xffff0000, v36
    v_pk_add_f32 v[8:9], v[8:9], v[4:5]
    v_lshlrev_b32 v4, 16, v37
    v_and_b32 v5, 0xffff0000, v37
    v_pk_add_f32 v[10:11], v[10:11], v[4:5]
    v_lshlrev_b32 v4, 16, v38
    v_and_b32 v5, 0xffff0000, v38
    v_pk_add_f32 v[12:13], v[12:13], v[4:5]
    v_lshlrev_b32 v4, 16, v39
    v_and_b32 v5, 0xffff0000, v39
    v_pk_add_f32 v[14:15], v[14:15], v[4:5]
    s_waitcnt vmcnt(7)
    v_lshlrev_b32 v4, 16, v40
    v_and_b32 v5, 0xffff0000, v40
    v_pk_add_f32 v[8:9], v[8:9], v[4:5]
    v_lshlrev_b32 v4, 16, v41
    v_and_b32 v5, 0xffff0000, v41
    v_pk_add_f32 v[10:11], v[10:11], v[4:5]
    v_lshlrev_b32 v4, 16, v42
    v_and_b32 v5, 0xffff0000, v42
    v_pk_add_f32 v[12:13], v[12:13], v[4:5]
    v_lshlrev_b32 v4, 16, v43
    v_and_b32 v5, 0xffff0000, v43
    v_pk_add_f32 v[14:15], v[14:15], v[4:5]
    s_waitcnt vmcnt(6)
    v_lshlrev_b32 v4, 16, v44
    v_and_b32 v5, 0xffff0000, v44
    v_pk_add_f32 v[8:9], v[8:9], v[4:5]
    v_lshlrev_b32 v4, 16, v45
    v_and_b32 v5, 0xffff0000, v45
    v_pk_add_f32 v[10:11], v[10:11], v[4:5]
    v_lshlrev_b32 v4, 16, v46
    v_and_b32 v5, 0xffff0000, v46
    v_pk_add_f32 v[12:13], v[12:13], v[4:5]
    v_lshlrev_b32 v4, 16, v47
    v_and_b32 v5, 0xffff0000, v47
    v_pk_add_f32 v[14:15], v[14:15], v[4:5]
    s_waitcnt vmcnt(5)
    v_lshlrev_b32 v4, 16, v48
    v_and_b32 v5, 0xffff0000, v48
    v_pk_add_f32 v[8:9], v[8:9], v[4:5]
    v_lshlrev_b32 v4, 16, v49
    v_and_b32 v5, 0xffff0000, v49
    v_pk_add_f32 v[10:11], v[10:11], v[4:5]
    v_lshlrev_b32 v4, 16, v50
    v_and_b32 v5, 0xffff0000, v50
    v_pk_add_f32 v[12:13], v[12:13], v[4:5]
    v_lshlrev_b32 v4, 16, v51
    v_and_b32 v5, 0xffff0000, v51
    v_pk_add_f32 v[14:15], v[14:15], v[4:5]
    s_waitcnt vmcnt(4)
    v_lshlrev_b32 v4, 16, v52
    v_and_b32 v5, 0xffff0000, v52
    v_pk_add_f32 v[8:9], v[8:9], v[4:5]
    v_lshlrev_b32 v4, 16, v53
    v_and_b32 v5, 0xffff0000, v53
    v_pk_add_f32 v[10:11], v[10:11], v[4:5]
    v_lshlrev_b32 v4, 16, v54
    v_and_b32 v5, 0xffff0000, v54
    v_pk_add_f32 v[12:13], v[12:13], v[4:5]
    v_lshlrev_b32 v4, 16, v55
    v_and_b32 v5, 0xffff0000, v55
    v_pk_add_f32 v[14:15], v[14:15], v[4:5]
    s_waitcnt vmcnt(3)
    v_lshlrev_b32 v4, 16, v56
    v_and_b32 v5, 0xffff0000, v56
    v_pk_add_f32 v[8:9], v[8:9], v[4:5]
    v_lshlrev_b32 v4, 16, v57
    v_and_b32 v5, 0xffff0000, v57
    v_pk_add_f32 v[10:11], v[10:11], v[4:5]
    v_lshlrev_b32 v4, 16, v58
    v_and_b32 v5, 0xffff0000, v58
    v_pk_add_f32 v[12:13], v[12:13], v[4:5]
    v_lshlrev_b32 v4, 16, v59
    v_and_b32 v5, 0xffff0000, v59
    v_pk_add_f32 v[14:15], v[14:15], v[4:5]
    s_waitcnt vmcnt(2)
    v_lshlrev_b32 v4, 16, v60
    v_and_b32 v5, 0xffff0000, v60
    v_pk_add_f32 v[8:9], v[8:9], v[4:5]
    v_lshlrev_b32 v4, 16, v61
    v_and_b32 v5, 0xffff0000, v61
    v_pk_add_f32 v[10:11], v[10:11], v[4:5]
    v_lshlrev_b32 v4, 16, v62
    v_and_b32 v5, 0xffff0000, v62
    v_pk_add_f32 v[12:13], v[12:13], v[4:5]
    v_lshlrev_b32 v4, 16, v63
    v_and_b32 v5, 0xffff0000, v63
    v_pk_add_f32 v[14:15], v[14:15], v[4:5]
    s_waitcnt vmcnt(1)
    v_lshlrev_b32 v4, 16, v64
    v_and_b32 v5, 0xffff0000, v64
    v_pk_add_f32 v[8:9], v[8:9], v[4:5]
    v_lshlrev_b32 v4, 16, v65
    v_and_b32 v5, 0xffff0000, v65
    v_pk_add_f32 v[10:11], v[10:11], v[4:5]
    v_lshlrev_b32 v4, 16, v66
    v_and_b32 v5, 0xffff0000, v66
    v_pk_add_f32 v[12:13], v[12:13], v[4:5]
    v_lshlrev_b32 v4, 16, v67
    v_and_b32 v5, 0xffff0000, v67
    v_pk_add_f32 v[14:15], v[14:15], v[4:5]
    s_waitcnt vmcnt(0)
    v_lshlrev_b32 v4, 16, v68
    v_and_b32 v5, 0xffff0000, v68
    v_pk_add_f32 v[8:9], v[8:9], v[4:5]
    v_lshlrev_b32 v4, 16, v69
    v_and_b32 v5, 0xffff0000, v69
    v_pk_add_f32 v[10:11], v[10:11], v[4:5]
    v_lshlrev_b32 v4, 16, v70
    v_and_b32 v5, 0xffff0000, v70
    v_pk_add_f32 v[12:13], v[12:13], v[4:5]
    v_lshlrev_b32 v4, 16, v71
    v_and_b32 v5, 0xffff0000, v71
    v_pk_add_f32 v[14:15], v[14:15], v[4:5]
    s_add_u32 s47, s46, 1658880
    buffer_load_dwordx4 v[32:35], v2, s[16:19], s47 offen
    s_add_u32 s47, s46, 1714176
    buffer_load_dwordx4 v[36:39], v2, s[16:19], s47 offen
    s_add_u32 s47, s46, 1769472
    buffer_load_dwordx4 v[40:43], v2, s[16:19], s47 offen
    s_add_u32 s47, s46, 1824768
    buffer_load_dwordx4 v[44:47], v2, s[16:19], s47 offen
    s_add_u32 s47, s46, 1880064
    buffer_load_dwordx4 v[48:51], v2, s[16:19], s47 offen
    s_add_u32 s47, s46, 1935360
    buffer_load_dwordx4 v[52:55], v2, s[16:19], s47 offen
    s_add_u32 s47, s46, 1990656
    buffer_load_dwordx4 v[56:59], v2, s[16:19], s47 offen
    s_add_u32 s47, s46, 2045952
    buffer_load_dwordx4 v[60:63], v2, s[16:19], s47 offen
    s_add_u32 s47, s46, 2101248
    buffer_load_dwordx4 v[64:67], v2, s[16:19], s47 offen
    s_add_u32 s47, s46, 2156544
    buffer_load_dwordx4 v[68:71], v2, s[16:19], s47 offen
    s_waitcnt vmcnt(9)
    v_lshlrev_b32 v4, 16, v32
    v_and_b32 v5, 0xffff0000, v32
    v_pk_add_f32 v[8:9], v[8:9], v[4:5]
    v_lshlrev_b32 v4, 16, v33
    v_and_b32 v5, 0xffff0000, v33
    v_pk_add_f32 v[10:11], v[10:11], v[4:5]
    v_lshlrev_b32 v4, 16, v34
    v_and_b32 v5, 0xffff0000, v34
    v_pk_add_f32 v[12:13], v[12:13], v[4:5]
    v_lshlrev_b32 v4, 16, v35
    v_and_b32 v5, 0xffff0000, v35
    v_pk_add_f32 v[14:15], v[14:15], v[4:5]
    s_waitcnt vmcnt(8)
    v_lshlrev_b32 v4, 16, v36
    v_and_b32 v5, 0xffff0000, v36
    v_pk_add_f32 v[8:9], v[8:9], v[4:5]
    v_lshlrev_b32 v4, 16, v37
    v_and_b32 v5, 0xffff0000, v37
    v_pk_add_f32 v[10:11], v[10:11], v[4:5]
    v_lshlrev_b32 v4, 16, v38
    v_and_b32 v5, 0xffff0000, v38
    v_pk_add_f32 v[12:13], v[12:13], v[4:5]
    v_lshlrev_b32 v4, 16, v39
    v_and_b32 v5, 0xffff0000, v39
    v_pk_add_f32 v[14:15], v[14:15], v[4:5]
    s_waitcnt vmcnt(7)
    v_lshlrev_b32 v4, 16, v40
    v_and_b32 v5, 0xffff0000, v40
    v_pk_add_f32 v[8:9], v[8:9], v[4:5]
    v_lshlrev_b32 v4, 16, v41
    v_and_b32 v5, 0xffff0000, v41
    v_pk_add_f32 v[10:11], v[10:11], v[4:5]
    v_lshlrev_b32 v4, 16, v42
    v_and_b32 v5, 0xffff0000, v42
    v_pk_add_f32 v[12:13], v[12:13], v[4:5]
    v_lshlrev_b32 v4, 16, v43
    v_and_b32 v5, 0xffff0000, v43
    v_pk_add_f32 v[14:15], v[14:15], v[4:5]
    s_waitcnt vmcnt(6)
    v_lshlrev_b32 v4, 16, v44
    v_and_b32 v5, 0xffff0000, v44
    v_pk_add_f32 v[8:9], v[8:9], v[4:5]
    v_lshlrev_b32 v4, 16, v45
    v_and_b32 v5, 0xffff0000, v45
    v_pk_add_f32 v[10:11], v[10:11], v[4:5]
    v_lshlrev_b32 v4, 16, v46
    v_and_b32 v5, 0xffff0000, v46
    v_pk_add_f32 v[12:13], v[12:13], v[4:5]
    v_lshlrev_b32 v4, 16, v47
    v_and_b32 v5, 0xffff0000, v47
    v_pk_add_f32 v[14:15], v[14:15], v[4:5]
    s_waitcnt vmcnt(5)
    v_lshlrev_b32 v4, 16, v48
    v_and_b32 v5, 0xffff0000, v48
    v_pk_add_f32 v[8:9], v[8:9], v[4:5]
    v_lshlrev_b32 v4, 16, v49
    v_and_b32 v5, 0xffff0000, v49
    v_pk_add_f32 v[10:11], v[10:11], v[4:5]
    v_lshlrev_b32 v4, 16, v50
    v_and_b32 v5, 0xffff0000, v50
    v_pk_add_f32 v[12:13], v[12:13], v[4:5]
    v_lshlrev_b32 v4, 16, v51
    v_and_b32 v5, 0xffff0000, v51
    v_pk_add_f32 v[14:15], v[14:15], v[4:5]
    s_waitcnt vmcnt(4)
    v_lshlrev_b32 v4, 16, v52
    v_and_b32 v5, 0xffff0000, v52
    v_pk_add_f32 v[8:9], v[8:9], v[4:5]
    v_lshlrev_b32 v4, 16, v53
    v_and_b32 v5, 0xffff0000, v53
    v_pk_add_f32 v[10:11], v[10:11], v[4:5]
    v_lshlrev_b32 v4, 16, v54
    v_and_b32 v5, 0xffff0000, v54
    v_pk_add_f32 v[12:13], v[12:13], v[4:5]
    v_lshlrev_b32 v4, 16, v55
    v_and_b32 v5, 0xffff0000, v55
    v_pk_add_f32 v[14:15], v[14:15], v[4:5]
    s_waitcnt vmcnt(3)
    v_lshlrev_b32 v4, 16, v56
    v_and_b32 v5, 0xffff0000, v56
    v_pk_add_f32 v[8:9], v[8:9], v[4:5]
    v_lshlrev_b32 v4, 16, v57
    v_and_b32 v5, 0xffff0000, v57
    v_pk_add_f32 v[10:11], v[10:11], v[4:5]
    v_lshlrev_b32 v4, 16, v58
    v_and_b32 v5, 0xffff0000, v58
    v_pk_add_f32 v[12:13], v[12:13], v[4:5]
    v_lshlrev_b32 v4, 16, v59
    v_and_b32 v5, 0xffff0000, v59
    v_pk_add_f32 v[14:15], v[14:15], v[4:5]
    s_waitcnt vmcnt(2)
    v_lshlrev_b32 v4, 16, v60
    v_and_b32 v5, 0xffff0000, v60
    v_pk_add_f32 v[8:9], v[8:9], v[4:5]
    v_lshlrev_b32 v4, 16, v61
    v_and_b32 v5, 0xffff0000, v61
    v_pk_add_f32 v[10:11], v[10:11], v[4:5]
    v_lshlrev_b32 v4, 16, v62
    v_and_b32 v5, 0xffff0000, v62
    v_pk_add_f32 v[12:13], v[12:13], v[4:5]
    v_lshlrev_b32 v4, 16, v63
    v_and_b32 v5, 0xffff0000, v63
    v_pk_add_f32 v[14:15], v[14:15], v[4:5]
    s_waitcnt vmcnt(1)
    v_lshlrev_b32 v4, 16, v64
    v_and_b32 v5, 0xffff0000, v64
    v_pk_add_f32 v[8:9], v[8:9], v[4:5]
    v_lshlrev_b32 v4, 16, v65
    v_and_b32 v5, 0xffff0000, v65
    v_pk_add_f32 v[10:11], v[10:11], v[4:5]
    v_lshlrev_b32 v4, 16, v66
    v_and_b32 v5, 0xffff0000, v66
    v_pk_add_f32 v[12:13], v[12:13], v[4:5]
    v_lshlrev_b32 v4, 16, v67
    v_and_b32 v5, 0xffff0000, v67
    v_pk_add_f32 v[14:15], v[14:15], v[4:5]
    s_waitcnt vmcnt(0)
    v_lshlrev_b32 v4, 16, v68
    v_and_b32 v5, 0xffff0000, v68
    v_pk_add_f32 v[8:9], v[8:9], v[4:5]
    v_lshlrev_b32 v4, 16, v69
    v_and_b32 v5, 0xffff0000, v69
    v_pk_add_f32 v[10:11], v[10:11], v[4:5]
    v_lshlrev_b32 v4, 16, v70
    v_and_b32 v5, 0xffff0000, v70
    v_pk_add_f32 v[12:13], v[12:13], v[4:5]
    v_lshlrev_b32 v4, 16, v71
    v_and_b32 v5, 0xffff0000, v71
    v_pk_add_f32 v[14:15], v[14:15], v[4:5]
    v_mov_b32 v4, v8
    s_nop 1
    v_permlane16_swap_b32 v8, v4
    v_add_f32 v8, v8, v4
    v_mov_b32 v4, v8
    s_nop 1
    v_permlane32_swap_b32 v8, v4
    v_add_f32 v8, v8, v4
    v_mov_b32 v4, v9
    s_nop 1
    v_permlane16_swap_b32 v9, v4
    v_add_f32 v9, v9, v4
    v_mov_b32 v4, v9
    s_nop 1
    v_permlane32_swap_b32 v9, v4
    v_add_f32 v9, v9, v4
    v_mov_b32 v4, v10
    s_nop 1
    v_permlane16_swap_b32 v10, v4
    v_add_f32 v10, v10, v4
    v_mov_b32 v4, v10
    s_nop 1
    v_permlane32_swap_b32 v10, v4
    v_add_f32 v10, v10, v4
    v_mov_b32 v4, v11
    s_nop 1
    v_permlane16_swap_b32 v11, v4
    v_add_f32 v11, v11, v4
    v_mov_b32 v4, v11
    s_nop 1
    v_permlane32_swap_b32 v11, v4
    v_add_f32 v11, v11, v4
    v_mov_b32 v4, v12
    s_nop 1
    v_permlane16_swap_b32 v12, v4
    v_add_f32 v12, v12, v4
    v_mov_b32 v4, v12
    s_nop 1
    v_permlane32_swap_b32 v12, v4
    v_add_f32 v12, v12, v4
    v_mov_b32 v4, v13
    s_nop 1
    v_permlane16_swap_b32 v13, v4
    v_add_f32 v13, v13, v4
    v_mov_b32 v4, v13
    s_nop 1
    v_permlane32_swap_b32 v13, v4
    v_add_f32 v13, v13, v4
    v_mov_b32 v4, v14
    s_nop 1
    v_permlane16_swap_b32 v14, v4
    v_add_f32 v14, v14, v4
    v_mov_b32 v4, v14
    s_nop 1
    v_permlane32_swap_b32 v14, v4
    v_add_f32 v14, v14, v4
    v_mov_b32 v4, v15
    s_nop 1
    v_permlane16_swap_b32 v15, v4
    v_add_f32 v15, v15, v4
    v_mov_b32 v4, v15
    s_nop 1
    v_permlane32_swap_b32 v15, v4
    v_add_f32 v15, v15, v4
    v_and_b32 v1, 15, v0
    v_lshlrev_b32 v1, 5, v1
    s_lshl_b32 s66, s3, 9
    v_add_u32 v1, s66, v1
    s_mov_b64 exec, 0xffff
    ds_write_b128 v1, v[8:11]
    ds_write_b128 v1, v[12:15] offset:16
    s_mov_b64 exec, -1
    s_waitcnt lgkmcnt(0)
    s_barrier
    s_lshl_b32 s66, s3, 8
    v_lshl_add_u32 v1, v0, 2, s66
    ds_read_b32 v4, v1
    ds_read_b32 v5, v1 offset:512
    ds_read_b32 v6, v1 offset:1024
    ds_read_b32 v7, v1 offset:1536
    s_lshl_b32 s66, s45, 6
    s_add_u32 s66, s66, 14942208
    s_waitcnt lgkmcnt(0)
    v_add_f32 v4, v4, v5
    v_add_f32 v6, v6, v7
    v_add_f32 v4, v4, v6
    s_lshl_b32 s67, s3, 6
    v_add_u32 v2, s67, v0
    v_cmp_gt_u32 vcc, 112, v2
    s_nop 0
    s_and_saveexec_b64 s[68:69], vcc
    s_cbranch_execz L_cs_skip
    v_lshlrev_b32 v2, 2, v2
    buffer_store_dword v4, v2, s[24:27], s66 offen sc1
L_cs_skip:
    s_mov_b64 exec, s[68:69]
    v_mov_b32 v1, 0
    global_load_dword v198, v1, s[36:37] sc1
    s_waitcnt vmcnt(0)
    s_bitcmp1_b32 s80, 0
    s_cbranch_scc0 L_rpd_25
    ds_read_b64_tr_b16 a[0:1], v222 offset:0
    ds_read_b64_tr_b16 a[2:3], v223 offset:0
    ds_read_b64_tr_b16 a[4:5], v222 offset:32
    ds_read_b64_tr_b16 a[6:7], v223 offset:32
    ds_read_b64_tr_b16 a[8:9], v222 offset:64
    ds_read_b64_tr_b16 a[10:11], v223 offset:64
    ds_read_b64_tr_b16 a[12:13], v222 offset:96
    ds_read_b64_tr_b16 a[14:15], v223 offset:96
    s_bitcmp1_b32 s80, 1
    s_cbranch_scc1 L_rp7_26
    ds_read_b64_tr_b16 a[16:17], v224 offset:0
    ds_read_b64_tr_b16 a[18:19], v225 offset:0
    s_waitcnt lgkmcnt(0)
    s_add_u32 s60, s77, 0
    buffer_store_dwordx4 a[0:3], v220, s[24:27], s60 offen sc1
    s_add_u32 s60, s77, 1024
    buffer_store_dwordx4 a[4:7], v220, s[24:27], s60 offen sc1
    s_add_u32 s60, s77, 2048
    buffer_store_dwordx4 a[8:11], v220, s[24:27], s60 offen sc1
    s_add_u32 s60, s77, 3072
    buffer_store_dwordx4 a[12:15], v220, s[24:27], s60 offen sc1
    s_add_u32 s60, s77, 4096
    buffer_store_dwordx4 a[16:19], v220, s[24:27], s60 offen sc1
    s_branch L_rpd_25
L_rp7_26:
    ds_read_b64_tr_b16 a[16:17], v222 offset:128
    ds_read_b64_tr_b16 a[18:19], v223 offset:128
    ds_read_b64_tr_b16 a[20:21], v222 offset:160
    ds_read_b64_tr_b16 a[22:23], v223 offset:160
    ds_read_b64_tr_b16 a[24:25], v224 offset:0
    ds_read_b64_tr_b16 a[26:27], v225 offset:0
    s_waitcnt lgkmcnt(0)
    s_add_u32 s60, s77, 0
    buffer_store_dwordx4 a[0:3], v220, s[24:27], s60 offen sc1
    s_add_u32 s60, s77, 1024
    buffer_store_dwordx4 a[4:7], v220, s[24:27], s60 offen sc1
    s_add_u32 s60, s77, 2048
    buffer_store_dwordx4 a[8:11], v220, s[24:27], s60 offen sc1
    s_add_u32 s60, s77, 3072
    buffer_store_dwordx4 a[12:15], v220, s[24:27], s60 offen sc1
    s_add_u32 s60, s77, 4096
    buffer_store_dwordx4 a[16:19], v220, s[24:27], s60 offen sc1
    s_add_u32 s60, s77, 5120
    buffer_store_dwordx4 a[20:23], v220, s[24:27], s60 offen sc1
    s_add_u32 s60, s77, 6144
    buffer_store_dwordx4 a[24:27], v220, s[24:27], s60 offen sc1
L_rpd_25:
    s_cmp_eq_u32 s80, 1
    s_cbranch_scc1 L_w5_29
    s_cmp_eq_u32 s80, 3
    s_cbranch_scc1 L_w7_30
    s_waitcnt vmcnt(0)
    s_branch L_wj_31
L_w5_29:
    s_waitcnt vmcnt(5)
    s_branch L_wj_31
L_w7_30:
    s_waitcnt vmcnt(7)
L_wj_31:
    v_readfirstlane_b32 s40, v198
    s_nop 0
    s_cmp_eq_u32 s40, 0
    s_cbranch_scc1 L_rare_32
L_back_33:
    s_barrier
    s_cmp_eq_u32 s3, 0
    s_cbranch_scc0 L_e1_28
    s_lshl_b32 s42, s44, 6
    s_add_u32 s42, s42, 65536
    v_mov_b32 v1, 0
    v_mov_b32 v2, s40
    s_mov_b64 exec, 1
    buffer_store_dword v2, v1, s[24:27], s42 offen sc1
    s_mov_b64 exec, -1
L_e1_28:
L_p1done:
    s_and_b32 s66, s3, 1
    s_lshr_b32 s67, s3, 1
    s_lshl_b32 s66, s66, 5
    s_lshl_b32 s67, s67, 4
    s_add_u32 s66, s66, s67
    s_lshl_b32 s67, s55, 6
    s_add_u32 s66, s66, s67
    v_and_b32 v1, 15, v0
    v_add_u32 v1, s66, v1
    v_mul_u32_u24 v1, 1280, v1
    v_lshrrev_b32 v2, 4, v0
    v_lshl_add_u32 v1, v2, 3, v1
    s_mul_i32 s66, s56, 160
    s_lshl_b32 s67, s57, 5
    s_add_u32 s67, s67, s66
    v_add_u32 v2, s67, v1
    s_cmp_eq_u32 s57, 0
    s_cselect_b32 s67, 128, 0
    s_add_u32 s67, s67, s66
    v_add_u32 v3, s67, v1
    buffer_load_dwordx2 v[210:211], v2, s[4:7], 0 offen offset:0
    buffer_load_dwordx2 v[212:213], v2, s[4:7], 0 offen offset:32
    buffer_load_dwordx2 v[214:215], v2, s[4:7], 0 offen offset:64
    buffer_load_dwordx2 v[216:217], v2, s[4:7], 0 offen offset:96
    buffer_load_dwordx2 v[218:219], v3, s[4:7], 0 offen
    v_lshrrev_b32 v1, 4, v0
    v_lshlrev_b32 v6, 3, v1
    s_mul_i32 s66, s56, 160
    s_lshl_b32 s67, s57, 5
    s_add_u32 s67, s67, s66
    v_add_u32 v2, s67, v6
    s_cmp_eq_u32 s57, 0
    s_cselect_b32 s67, 128, 0
    s_add_u32 s67, s67, s66
    v_add_u32 v3, s67, v6
    s_add_u32 s66, s58, s59
    s_lshl_b32 s66, s66, 5
    v_add_u32 v4, s66, v6
    s_cmp_lt_u32 s54, 12
    s_cselect_b32 s66, 6, 5
    s_cmp_eq_u32 s59, 0
    s_cselect_b32 s66, s66, 0
    s_add_u32 s66, s66, s58
    s_lshl_b32 s66, s66, 5
    v_add_u32 v5, s66, v6
    global_load_dwordx2 a[216:217], v2, s[34:35] offset:0
    global_load_dwordx2 a[218:219], v2, s[34:35] offset:32
    global_load_dwordx2 a[220:221], v2, s[34:35] offset:64
    global_load_dwordx2 a[222:223], v2, s[34:35] offset:96
    global_load_dwordx2 a[224:225], v3, s[34:35]
    global_load_dwordx2 a[226:227], v4, s[32:33] offset:0
    global_load_dwordx2 a[228:229], v4, s[32:33] offset:32
    global_load_dwordx2 a[230:231], v4, s[32:33] offset:64
    global_load_dwordx2 a[232:233], v4, s[32:33] offset:96
    global_load_dwordx2 a[234:235], v4, s[32:33] offset:128
    global_load_dwordx2 a[236:237], v4, s[32:33] offset:160
    global_load_dwordx2 a[238:239], v5, s[32:33]
    s_waitcnt vmcnt(17)
    s_barrier
    s_cmp_eq_u32 s3, 0
    s_cbranch_scc0 L_rph_36
    s_lshl_b32 s42, s83, 6
    s_add_u32 s42, s42, 81920
    v_mov_b32 v1, 0
    v_mov_b32 v2, s40
    v_mov_b32 v3, s71
    s_mov_b64 exec, 1
    buffer_store_dwordx2 v[2:3], v1, s[24:27], s42 offen sc1
    s_mov_b64 exec, -1
L_rph_36:
    s_cmp_eq_u32 s3, 0
    s_cbranch_scc0 L_polldone_39
    s_mov_b32 s42, 0
    s_mov_b64 exec, 0x3fff
L_poll_37:
    buffer_load_dword v2, v192, s[24:27], 0 offen sc1
    s_add_u32 s42, s42, 1
    s_waitcnt vmcnt(0)
    v_cmp_ne_u32 vcc, s40, v2
    s_cmp_gt_u32 s42, 0x40000
    s_cbranch_scc1 L_got_38
    s_nop 1
    s_cbranch_vccnz L_poll_37
L_got_38:
    s_mov_b64 exec, -1
L_polldone_39:
    s_barrier
    s_mul_i32 s60, s53, 606208
    s_mul_i32 s61, s54, 10240
    s_add_u32 s60, s60, s61
    s_add_u32 s60, s60, 131072
    s_lshl_b32 s63, s3, 3
    s_mul_i32 s65, s63, 96
    s_mul_i32 s64, s63, 80
    s_lshl_b32 s68, s3, 5
    s_mul_i32 s69, s3, 2560
    s_mov_b32 exec_lo, -1
    s_mov_b32 exec_hi, 0xff
    s_add_u32 s61, s60, 163840
    s_add_u32 s66, s68, 0
    v_mad_u32_u24 v1, v195, s66, v194
    s_add_u32 m0, s69, 0
    s_nop 0
    buffer_load_dwordx4 v1, s[24:27], s61 offen sc1 lds
    s_add_u32 s66, s68, 8
    v_mad_u32_u24 v1, v195, s66, v194
    s_add_u32 m0, s69, 640
    s_nop 0
    buffer_load_dwordx4 v1, s[24:27], s61 offen sc1 lds
    s_add_u32 s66, s68, 16
    v_mad_u32_u24 v1, v195, s66, v194
    s_add_u32 m0, s69, 1280
    s_nop 0
    buffer_load_dwordx4 v1, s[24:27], s61 offen sc1 lds
    s_add_u32 s66, s68, 24
    v_mad_u32_u24 v1, v195, s66, v194
    s_add_u32 m0, s69, 1920
    s_nop 0
    buffer_load_dwordx4 v1, s[24:27], s61 offen sc1 lds
    s_cmp_ge_u32 s53, 2
    s_cbranch_scc0 L_blk_40
    s_add_u32 s66, s63, 0
    s_add_u32 s61, s60, 4293754880
    s_add_u32 s62, s60, 4294082560
    s_mov_b32 exec_lo, -1
    s_mov_b32 exec_hi, 0xff
    v_mad_u32_u24 v1, v195, s66, v194
    s_add_u32 m0, s64, 10240
    s_nop 0
    buffer_load_dwordx4 v1, s[24:27], s61 offen sc1 lds
    s_mov_b32 exec_lo, 0xdf7df7df
    s_mov_b32 exec_hi, 0x7df7
    v_mad_u32_u24 v1, v197, s66, v196
    s_add_u32 m0, s65, 40960
    s_nop 0
    buffer_load_dwordx4 v1, s[24:27], s62 offen sc1 lds
    s_add_u32 s66, s63, 32
    s_add_u32 s61, s60, 4293754880
    s_add_u32 s62, s60, 4294082560
    s_mov_b32 exec_lo, -1
    s_mov_b32 exec_hi, 0xff
    v_mad_u32_u24 v1, v195, s66, v194
    s_add_u32 m0, s64, 12800
    s_nop 0
    buffer_load_dwordx4 v1, s[24:27], s61 offen sc1 lds
    s_mov_b32 exec_lo, 0xdf7df7df
    s_mov_b32 exec_hi, 0x7df7
    v_mad_u32_u24 v1, v197, s66, v196
    s_add_u32 m0, s65, 44032
    s_nop 0
    buffer_load_dwordx4 v1, s[24:27], s62 offen sc1 lds
    s_add_u32 s66, s63, 64
    s_add_u32 s61, s60, 4293754880
    s_add_u32 s62, s60, 4294082560
    s_mov_b32 exec_lo, -1
    s_mov_b32 exec_hi, 0xff
    v_mad_u32_u24 v1, v195, s66, v194
    s_add_u32 m0, s64, 15360
    s_nop 0
    buffer_load_dwordx4 v1, s[24:27], s61 offen sc1 lds
    s_mov_b32 exec_lo, 0xdf7df7df
    s_mov_b32 exec_hi, 0x7df7
    v_mad_u32_u24 v1, v197, s66, v196
    s_add_u32 m0, s65, 47104
    s_nop 0
    buffer_load_dwordx4 v1, s[24:27], s62 offen sc1 lds
    s_add_u32 s66, s63, 96
    s_add_u32 s61, s60, 4293754880
    s_add_u32 s62, s60, 4294082560
    s_mov_b32 exec_lo, -1
    s_mov_b32 exec_hi, 0xff
    v_mad_u32_u24 v1, v195, s66, v194
    s_add_u32 m0, s64, 17920
    s_nop 0
    buffer_load_dwordx4 v1, s[24:27], s61 offen sc1 lds
    s_mov_b32 exec_lo, 0xdf7df7df
    s_mov_b32 exec_hi, 0x7df7
    v_mad_u32_u24 v1, v197, s66, v196
    s_add_u32 m0, s65, 50176
    s_nop 0
    buffer_load_dwordx4 v1, s[24:27], s62 offen sc1 lds
L_blk_40:
    s_cmp_ge_u32 s53, 1
    s_cbranch_scc0 L_blk_41
    s_add_u32 s66, s63, 0
    s_add_u32 s61, s60, 4294361088
    s_add_u32 s62, s60, 4294688768
    s_mov_b32 exec_lo, -1
    s_mov_b32 exec_hi, 0xff
    v_mad_u32_u24 v1, v195, s66, v194
    s_add_u32 m0, s64, 20480
    s_nop 0
    buffer_load_dwordx4 v1, s[24:27], s61 offen sc1 lds
    s_mov_b32 exec_lo, 0xdf7df7df
    s_mov_b32 exec_hi, 0x7df7
    v_mad_u32_u24 v1, v197, s66, v196
    s_add_u32 m0, s65, 53248
    s_nop 0
    buffer_load_dwordx4 v1, s[24:27], s62 offen sc1 lds
L_blk_41:
    s_mov_b64 exec, -1
    buffer_load_dwordx2 v[174:175], v193, s[24:27], 0 offen sc1
    v_and_b32 v1, 31, v0
    v_lshrrev_b32 v2, 5, v0
    v_lshlrev_b32 v3, 2, v2
    v_sub_u32 v3, v1, v3
    v_mov_b32 v4, 0xf149f2ca
    v_subrev_u32 v40, 0, v3
    v_subrev_u32 v41, 1, v3
    v_subrev_u32 v42, 2, v3
    v_subrev_u32 v43, 3, v3
    v_subrev_u32 v44, 8, v3
    v_subrev_u32 v45, 9, v3
    v_subrev_u32 v46, 10, v3
    v_subrev_u32 v47, 11, v3
    v_subrev_u32 v48, 16, v3
    v_subrev_u32 v49, 17, v3
    v_subrev_u32 v50, 18, v3
    v_subrev_u32 v51, 19, v3
    v_subrev_u32 v52, 24, v3
    v_subrev_u32 v53, 25, v3
    v_subrev_u32 v54, 26, v3
    v_subrev_u32 v55, 27, v3
    v_ashrrev_i32 v40, 31, v40
    v_ashrrev_i32 v41, 31, v41
    v_ashrrev_i32 v42, 31, v42
    v_ashrrev_i32 v43, 31, v43
    v_ashrrev_i32 v44, 31, v44
    v_ashrrev_i32 v45, 31, v45
    v_ashrrev_i32 v46, 31, v46
    v_ashrrev_i32 v47, 31, v47
    v_ashrrev_i32 v48, 31, v48
    v_ashrrev_i32 v49, 31, v49
    v_ashrrev_i32 v50, 31, v50
    v_ashrrev_i32 v51, 31, v51
    v_ashrrev_i32 v52, 31, v52
    v_ashrrev_i32 v53, 31, v53
    v_ashrrev_i32 v54, 31, v54
    v_ashrrev_i32 v55, 31, v55
    v_and_b32 v24, v4, v40
    v_bfi_b32 v40, v40, 0, v4
    v_and_b32 v25, v4, v41
    v_bfi_b32 v41, v41, 0, v4
    v_and_b32 v26, v4, v42
    v_bfi_b32 v42, v42, 0, v4
    v_and_b32 v27, v4, v43
    v_bfi_b32 v43, v43, 0, v4
    v_and_b32 v28, v4, v44
    v_bfi_b32 v44, v44, 0, v4
    v_and_b32 v29, v4, v45
    v_bfi_b32 v45, v45, 0, v4
    v_and_b32 v30, v4, v46
    v_bfi_b32 v46, v46, 0, v4
    v_and_b32 v31, v4, v47
    v_bfi_b32 v47, v47, 0, v4
    v_and_b32 v32, v4, v48
    v_bfi_b32 v48, v48, 0, v4
    v_and_b32 v33, v4, v49
    v_bfi_b32 v49, v49, 0, v4
    v_and_b32 v34, v4, v50
    v_bfi_b32 v50, v50, 0, v4
    v_and_b32 v35, v4, v51
    v_bfi_b32 v51, v51, 0, v4
    v_and_b32 v36, v4, v52
    v_bfi_b32 v52, v52, 0, v4
    v_and_b32 v37, v4, v53
    v_bfi_b32 v53, v53, 0, v4
    v_and_b32 v38, v4, v54
    v_bfi_b32 v54, v54, 0, v4
    v_and_b32 v39, v4, v55
    v_bfi_b32 v55, v55, 0, v4
    s_lshl_b32 s66, s3, 5
    v_add_u32 v3, s66, v1
    v_mul_u32_u24 v3, 80, v3
    v_add_u32 v170, 10272, v3
    v_lshl_add_u32 v3, v2, 4, v3
    v_add_u32 v169, 10240, v3
    v_bfe_u32 v3, v0, 4, 1
    v_bfe_u32 v4, v0, 2, 2
    v_and_b32 v5, 3, v0
    v_lshl_add_u32 v4, v2, 2, v4
    v_add_u32 v4, s66, v4
    v_mul_u32_u24 v4, 96, v4
    v_add_u32 v4, 40960, v4
    v_lshlrev_b32 v6, 3, v5
    v_mov_b32 v1, 80
    v_mov_b32 v2, 32
    v_cmp_eq_u32 vcc, 0, v5
    s_nop 1
    v_cndmask_b32 v2, v1, v2, vcc
    v_add_u32 v171, 0, v6
    v_cmp_eq_u32 vcc, 1, v3
    s_nop 1
    v_cndmask_b32 v171, v171, v2, vcc
    v_add_u32 v171, v171, v4
    v_mov_b32 v2, 72
    v_cmp_eq_u32 vcc, 0, v5
    s_nop 1
    v_cndmask_b32 v2, v1, v2, vcc
    v_add_u32 v172, 40, v6
    v_cmp_eq_u32 vcc, 1, v3
    s_nop 1
    v_cndmask_b32 v172, v172, v2, vcc
    v_add_u32 v172, v172, v4
    s_mul_i32 s66, s3, 96
    v_add_u32 v1, s66, v0
    s_lshl_b32 s67, s53, 7
    s_sub_u32 s67, 256, s67
    v_mov_b32 v5, 0
    v_mov_b32 v6, 0x3f80
    v_cmp_le_i32 vcc, s67, v1
    s_nop 1
    v_cndmask_b32 v4, 0, v6, vcc
    v_mul_u32_u24 v2, 96, v1
    v_add_u32 v2, 41040, v2
    ds_write_b64 v2, v[4:5]
    v_add_u32 v1, 64, v1
    v_cmp_le_i32 vcc, s67, v1
    s_nop 1
    v_cndmask_b32 v4, 0, v6, vcc
    s_mov_b64 exec, 0xffffffff
    ds_write_b64 v2, v[4:5] offset:6144
    s_mov_b64 exec, -1
    s_cmp_lt_u32 s53, 2
    s_cbranch_scc1 L_rare_42
L_back_43:
    s_mul_i32 s60, s53, 606208
    s_mul_i32 s61, s54, 10240
    s_add_u32 s60, s60, s61
    s_add_u32 s60, s60, 131072
    s_lshl_b32 s63, s3, 3
    s_mul_i32 s65, s63, 96
    s_mul_i32 s64, s63, 80
    s_lshl_b32 s68, s3, 5
    s_mul_i32 s69, s3, 2560
    s_cmp_ge_u32 s53, 1
    s_cbranch_scc0 L_blk_44
    s_add_u32 s66, s63, 32
    s_add_u32 s61, s60, 4294361088
    s_add_u32 s62, s60, 4294688768
    s_mov_b32 exec_lo, -1
    s_mov_b32 exec_hi, 0xff
    v_mad_u32_u24 v1, v195, s66, v194
    s_add_u32 m0, s64, 23040
    s_nop 0
    buffer_load_dwordx4 v1, s[24:27], s61 offen sc1 lds
    s_mov_b32 exec_lo, 0xdf7df7df
    s_mov_b32 exec_hi, 0x7df7
    v_mad_u32_u24 v1, v197, s66, v196
    s_add_u32 m0, s65, 56320
    s_nop 0
    buffer_load_dwordx4 v1, s[24:27], s62 offen sc1 lds
    s_add_u32 s66, s63, 64
    s_add_u32 s61, s60, 4294361088
    s_add_u32 s62, s60, 4294688768
    s_mov_b32 exec_lo, -1
    s_mov_b32 exec_hi, 0xff
    v_mad_u32_u24 v1, v195, s66, v194
    s_add_u32 m0, s64, 25600
    s_nop 0
    buffer_load_dwordx4 v1, s[24:27], s61 offen sc1 lds
    s_mov_b32 exec_lo, 0xdf7df7df
    s_mov_b32 exec_hi, 0x7df7
    v_mad_u32_u24 v1, v197, s66, v196
    s_add_u32 m0, s65, 59392
    s_nop 0
    buffer_load_dwordx4 v1, s[24:27], s62 offen sc1 lds
    s_add_u32 s66, s63, 96
    s_add_u32 s61, s60, 4294361088
    s_add_u32 s62, s60, 4294688768
    s_mov_b32 exec_lo, -1
    s_mov_b32 exec_hi, 0xff
    v_mad_u32_u24 v1, v195, s66, v194
    s_add_u32 m0, s64, 28160
    s_nop 0
    buffer_load_dwordx4 v1, s[24:27], s61 offen sc1 lds
    s_mov_b32 exec_lo, 0xdf7df7df
    s_mov_b32 exec_hi, 0x7df7
    v_mad_u32_u24 v1, v197, s66, v196
    s_add_u32 m0, s65, 62464
    s_nop 0
    buffer_load_dwordx4 v1, s[24:27], s62 offen sc1 lds
L_blk_44:
    s_add_u32 s66, s63, 0
    s_add_u32 s61, s60, 0
    s_add_u32 s62, s60, 327680
    s_mov_b32 exec_lo, -1
    s_mov_b32 exec_hi, 0xff
    v_mad_u32_u24 v1, v195, s66, v194
    s_add_u32 m0, s64, 30720
    s_nop 0
    buffer_load_dwordx4 v1, s[24:27], s61 offen sc1 lds
    s_mov_b32 exec_lo, 0xdf7df7df
    s_mov_b32 exec_hi, 0x7df7
    v_mad_u32_u24 v1, v197, s66, v196
    s_add_u32 m0, s65, 65536
    s_nop 0
    buffer_load_dwordx4 v1, s[24:27], s62 offen sc1 lds
    s_add_u32 s66, s63, 32
    s_add_u32 s61, s60, 0
    s_add_u32 s62, s60, 327680
    s_mov_b32 exec_lo, -1
    s_mov_b32 exec_hi, 0xff
    v_mad_u32_u24 v1, v195, s66, v194
    s_add_u32 m0, s64, 33280
    s_nop 0
    buffer_load_dwordx4 v1, s[24:27], s61 offen sc1 lds
    s_mov_b32 exec_lo, 0xdf7df7df
    s_mov_b32 exec_hi, 0x7df7
    v_mad_u32_u24 v1, v197, s66, v196
    s_add_u32 m0, s65, 68608
    s_nop 0
    buffer_load_dwordx4 v1, s[24:27], s62 offen sc1 lds
    s_add_u32 s66, s63, 64
    s_add_u32 s61, s60, 0
    s_add_u32 s62, s60, 327680
    s_mov_b32 exec_lo, -1
    s_mov_b32 exec_hi, 0xff
    v_mad_u32_u24 v1, v195, s66, v194
    s_add_u32 m0, s64, 35840
    s_nop 0
    buffer_load_dwordx4 v1, s[24:27], s61 offen sc1 lds
    s_mov_b32 exec_lo, 0xdf7df7df
    s_mov_b32 exec_hi, 0x7df7
    v_mad_u32_u24 v1, v197, s66, v196
    s_add_u32 m0, s65, 71680
    s_nop 0
    buffer_load_dwordx4 v1, s[24:27], s62 offen sc1 lds
    s_add_u32 s66, s63, 96
    s_add_u32 s61, s60, 0
    s_add_u32 s62, s60, 327680
    s_mov_b32 exec_lo, -1
    s_mov_b32 exec_hi, 0xff
    v_mad_u32_u24 v1, v195, s66, v194
    s_add_u32 m0, s64, 38400
    s_nop 0
    buffer_load_dwordx4 v1, s[24:27], s61 offen sc1 lds
    s_mov_b32 exec_lo, 0xdf7df7df
    s_mov_b32 exec_hi, 0x7df7
    v_mad_u32_u24 v1, v197, s66, v196
    s_add_u32 m0, s65, 74752
    s_nop 0
    buffer_load_dwordx4 v1, s[24:27], s62 offen sc1 lds
    s_mov_b64 exec, -1
    s_cmp_lt_u32 s53, 2
    s_cbranch_scc1 L_rare_46
L_back_47:
    s_waitcnt vmcnt(15)
    s_waitcnt lgkmcnt(0)
    s_barrier
    s_cmp_eq_u32 s3, 0
    s_cbranch_scc0 L_flq_48
    s_lshl_b32 s42, s83, 6
    s_add_u32 s42, s42, 98304
    v_mov_b32 v1, 0
    v_mov_b32 v2, s40
    s_mov_b64 exec, 1
    buffer_store_dword v2, v1, s[24:27], s42 offen sc1
    s_mov_b64 exec, -1
L_flq_48:
    s_lshl_b32 s66, s53, 10
    s_add_u32 s66, s66, 98304
    v_lshlrev_b32 v176, 6, v0
    v_add_u32 v176, s66, v176
    v_and_b32 v1, 31, v0
    v_lshrrev_b32 v2, 5, v0
    s_lshl_b32 s66, s3, 5
    v_add_u32 v1, s66, v1
    v_mul_u32_u24 v1, 80, v1
    v_lshl_add_u32 v3, v2, 4, v1
    ds_read_b128 v[8:11], v3 offset:0
    ds_read_b128 v[16:19], v3 offset:48
    ds_read_b128 v[4:7], v1 offset:32
    ds_read_b128 v[128:131], v169 offset:0
    ds_read_b128 v[132:135], v170 offset:0
    ds_read_b128 v[136:139], v169 offset:48
    ds_read_b128 v[140:143], v170 offset:0
    ds_read_b64_tr_b16 v[144:145], v171 offset:0
    ds_read_b64_tr_b16 v[146:147], v171 offset:768
    ds_read_b64_tr_b16 v[148:149], v171 offset:1536
    ds_read_b64_tr_b16 v[150:151], v171 offset:2304
    v_cmp_gt_u32 vcc, 32, v0
    s_waitcnt lgkmcnt(8)
    s_nop 0
    v_cndmask_b32 v12, 0, v4, vcc
    v_cndmask_b32 v13, 0, v5, vcc
    v_mov_b32 v14, 0
    v_mov_b32 v15, 0
    v_mov_b32 v20, 0
    v_mov_b32 v21, 0
    v_cndmask_b32 v22, 0, v6, vcc
    v_cndmask_b32 v23, 0, v7, vcc
    s_waitcnt lgkmcnt(0)
    v_mfma_f32_32x32x16_bf16 v[88:103], v[128:131], v[8:11], v[40:55]
    v_mfma_f32_32x32x16_bf16 v[88:103], v[132:135], v[12:15], v[88:103]
    s_waitcnt lgkmcnt(0)
    s_nop 10
    v_exp_f32 v88, v88
    v_exp_f32 v89, v89
    v_exp_f32 v90, v90
    s_nop 7
    v_exp_f32 v91, v91
    ds_read_b64_tr_b16 v[152:153], v172 offset:0
    ds_read_b64_tr_b16 v[154:155], v172 offset:768
    v_cvt_pk_bf16_f32 v120, v88, v89
    v_cvt_pk_bf16_f32 v121, v90, v91
    v_exp_f32 v92, v92
    v_exp_f32 v93, v93
    v_exp_f32 v94, v94
    v_exp_f32 v95, v95
    v_mfma_f32_32x32x16_bf16 v[104:119], v[136:139], v[16:19], v[40:55]
    ds_read_b64_tr_b16 v[156:157], v172 offset:1536
    ds_read_b64_tr_b16 v[158:159], v172 offset:2304
    v_cvt_pk_bf16_f32 v122, v92, v93
    v_cvt_pk_bf16_f32 v123, v94, v95
    v_exp_f32 v96, v96
    v_exp_f32 v97, v97
    v_exp_f32 v98, v98
    v_exp_f32 v99, v99
    v_mfma_f32_32x32x16_bf16 v[104:119], v[140:143], v[20:23], v[104:119]
    ds_read_b128 v[128:131], v169 offset:2560
    ds_read_b128 v[132:135], v170 offset:2560
    v_cvt_pk_bf16_f32 v124, v96, v97
    v_cvt_pk_bf16_f32 v125, v98, v99
    v_exp_f32 v100, v100
    v_exp_f32 v101, v101
    v_exp_f32 v102, v102
    v_exp_f32 v103, v103
    v_mfma_f32_32x32x16_bf16 v[56:71], v[144:147], v[120:123], 0
    s_waitcnt lgkmcnt(0)
    v_cvt_pk_bf16_f32 v126, v100, v101
    v_cvt_pk_bf16_f32 v127, v102, v103
    v_exp_f32 v104, v104
    v_exp_f32 v105, v105
    v_exp_f32 v106, v106
    v_exp_f32 v107, v107
    v_mfma_f32_32x32x16_bf16 v[56:71], v[148:151], v[124:127], v[56:71]
    ds_read_b64_tr_b16 v[144:145], v171 offset:3072
    ds_read_b64_tr_b16 v[146:147], v171 offset:3840
    v_cvt_pk_bf16_f32 v120, v104, v105
    v_cvt_pk_bf16_f32 v121, v106, v107
    v_exp_f32 v108, v108
    v_exp_f32 v109, v109
    v_exp_f32 v110, v110
    v_exp_f32 v111, v111
    v_mfma_f32_32x32x16_bf16 v[88:103], v[128:131], v[8:11], 0
    ds_read_b64_tr_b16 v[148:149], v171 offset:4608
    ds_read_b64_tr_b16 v[150:151], v171 offset:5376
    v_cvt_pk_bf16_f32 v122, v108, v109
    v_cvt_pk_bf16_f32 v123, v110, v111
    v_exp_f32 v112, v112
    v_exp_f32 v113, v113
    v_exp_f32 v114, v114
    v_exp_f32 v115, v115
    v_mfma_f32_32x32x16_bf16 v[88:103], v[132:135], v[12:15], v[88:103]
    ds_read_b128 v[136:139], v169 offset:2608
    ds_read_b128 v[140:143], v170 offset:2560
    v_cvt_pk_bf16_f32 v124, v112, v113
    v_cvt_pk_bf16_f32 v125, v114, v115
    v_exp_f32 v116, v116
    v_exp_f32 v117, v117
    v_exp_f32 v118, v118
    v_exp_f32 v119, v119
    v_mfma_f32_32x32x16_bf16 v[72:87], v[152:155], v[120:123], 0
    s_waitcnt vmcnt(12)
    s_barrier
    s_waitcnt lgkmcnt(0)
    v_cvt_pk_bf16_f32 v126, v116, v117
    v_cvt_pk_bf16_f32 v127, v118, v119
    v_exp_f32 v88, v88
    v_exp_f32 v89, v89
    v_exp_f32 v90, v90
    v_exp_f32 v91, v91
    v_mfma_f32_32x32x16_bf16 v[72:87], v[156:159], v[124:127], v[72:87]
    ds_read_b64_tr_b16 v[152:153], v172 offset:3072
    ds_read_b64_tr_b16 v[154:155], v172 offset:3840
    v_cvt_pk_bf16_f32 v120, v88, v89
    v_cvt_pk_bf16_f32 v121, v90, v91
    v_exp_f32 v92, v92
    v_exp_f32 v93, v93
    v_exp_f32 v94, v94
    v_exp_f32 v95, v95
    v_mfma_f32_32x32x16_bf16 v[104:119], v[136:139], v[16:19], 0
    ds_read_b64_tr_b16 v[156:157], v172 offset:4608
    ds_read_b64_tr_b16 v[158:159], v172 offset:5376
    v_cvt_pk_bf16_f32 v122, v92, v93
    v_cvt_pk_bf16_f32 v123, v94, v95
    v_exp_f32 v96, v96
    v_exp_f32 v97, v97
    v_exp_f32 v98, v98
    v_exp_f32 v99, v99
    v_mfma_f32_32x32x16_bf16 v[104:119], v[140:143], v[20:23], v[104:119]
    ds_read_b128 v[128:131], v169 offset:5120
    ds_read_b128 v[132:135], v170 offset:5120
    v_cvt_pk_bf16_f32 v124, v96, v97
    v_cvt_pk_bf16_f32 v125, v98, v99
    v_exp_f32 v100, v100
    v_exp_f32 v101, v101
    v_exp_f32 v102, v102
    v_exp_f32 v103, v103
    v_mfma_f32_32x32x16_bf16 v[56:71], v[144:147], v[120:123], v[56:71]
    s_mov_b32 s67, 0
L_rphl_49:
    v_cmp_ne_u32 vcc, s40, v174
    s_cmp_gt_u32 s67, 0x40000
    s_cbranch_scc1 L_rphok_50
    s_add_u32 s67, s67, 1
    s_cbranch_vccz L_rphok_50
    buffer_load_dwordx2 v[174:175], v193, s[24:27], 0 offen sc1
    s_waitcnt vmcnt(0)
    s_branch L_rphl_49
L_rphok_50:
    v_cmp_ne_u32 vcc, s71, v175
    s_nop 1
    s_cmp_eq_u32 vcc_hi, 0
    s_cselect_b32 s70, 1, 0
    s_waitcnt lgkmcnt(0)
    v_cvt_pk_bf16_f32 v126, v100, v101
    v_cvt_pk_bf16_f32 v127, v102, v103
    v_exp_f32 v104, v104
    v_exp_f32 v105, v105
    v_exp_f32 v106, v106
    v_exp_f32 v107, v107
    v_mfma_f32_32x32x16_bf16 v[56:71], v[148:151], v[124:127], v[56:71]
    ds_read_b64_tr_b16 v[144:145], v171 offset:6144
    ds_read_b64_tr_b16 v[146:147], v171 offset:6912
    s_mul_i32 s64, s3, 5120
    s_add_u32 s64, s64, 20480
    s_mul_i32 s65, s56, 102400
    s_add_u32 s65, s65, s64
    s_add_u32 s65, s65, 23068672
    s_add_u32 s69, s65, 0
    s_add_u32 m0, s64, 61440
    s_nop 0
    buffer_load_dwordx4 v220, s[24:27], s69 offen offset:0 lds
    v_cvt_pk_bf16_f32 v120, v104, v105
    v_cvt_pk_bf16_f32 v121, v106, v107
    v_exp_f32 v108, v108
    v_exp_f32 v109, v109
    v_exp_f32 v110, v110
    v_exp_f32 v111, v111
    v_mfma_f32_32x32x16_bf16 v[88:103], v[128:131], v[8:11], 0
    ds_read_b64_tr_b16 v[148:149], v171 offset:7680
    ds_read_b64_tr_b16 v[150:151], v171 offset:8448
    buffer_load_dwordx4 v220, s[24:27], s69 offen offset:1024 lds
    v_cvt_pk_bf16_f32 v122, v108, v109
    v_cvt_pk_bf16_f32 v123, v110, v111
    v_exp_f32 v112, v112
    v_exp_f32 v113, v113
    v_exp_f32 v114, v114
    v_exp_f32 v115, v115
    v_mfma_f32_32x32x16_bf16 v[88:103], v[132:135], v[12:15], v[88:103]
    ds_read_b128 v[136:139], v169 offset:5168
    ds_read_b128 v[140:143], v170 offset:5120
    buffer_load_dwordx4 v220, s[24:27], s69 offen offset:2048 lds
    v_cvt_pk_bf16_f32 v124, v112, v113
    v_cvt_pk_bf16_f32 v125, v114, v115
    v_exp_f32 v116, v116
    v_exp_f32 v117, v117
    v_exp_f32 v118, v118
    v_exp_f32 v119, v119
    v_mfma_f32_32x32x16_bf16 v[72:87], v[152:155], v[120:123], v[72:87]
    s_waitcnt vmcnt(13)
    s_barrier
    s_waitcnt lgkmcnt(0)
    v_cvt_pk_bf16_f32 v126, v116, v117
    v_cvt_pk_bf16_f32 v127, v118, v119
    v_exp_f32 v88, v88
    v_exp_f32 v89, v89
    v_exp_f32 v90, v90
    v_exp_f32 v91, v91
    v_mfma_f32_32x32x16_bf16 v[72:87], v[156:159], v[124:127], v[72:87]
    ds_read_b64_tr_b16 v[152:153], v172 offset:6144
    ds_read_b64_tr_b16 v[154:155], v172 offset:6912
    buffer_load_dwordx4 v220, s[24:27], s69 offen offset:3072 lds
    v_cvt_pk_bf16_f32 v120, v88, v89
    v_cvt_pk_bf16_f32 v121, v90, v91
    v_exp_f32 v92, v92
    v_exp_f32 v93, v93
    v_exp_f32 v94, v94
    v_exp_f32 v95, v95
    v_mfma_f32_32x32x16_bf16 v[104:119], v[136:139], v[16:19], 0
    ds_read_b64_tr_b16 v[156:157], v172 offset:7680
    ds_read_b64_tr_b16 v[158:159], v172 offset:8448
    s_add_u32 s69, s65, 4096
    s_add_u32 m0, s64, 65536
    s_nop 0
    buffer_load_dwordx4 v220, s[24:27], s69 offen offset:0 lds
    v_cvt_pk_bf16_f32 v122, v92, v93
    v_cvt_pk_bf16_f32 v123, v94, v95
    v_exp_f32 v96, v96
    v_exp_f32 v97, v97
    v_exp_f32 v98, v98
    v_exp_f32 v99, v99
    v_mfma_f32_32x32x16_bf16 v[104:119], v[140:143], v[20:23], v[104:119]
    ds_read_b128 v[128:131], v169 offset:7680
    ds_read_b128 v[132:135], v170 offset:7680
    s_add_u32 s69, s65, 20480
    s_add_u32 m0, s64, 81920
    s_nop 0
    buffer_load_dwordx4 v220, s[24:27], s69 offen offset:0 lds
    v_cvt_pk_bf16_f32 v124, v96, v97
    v_cvt_pk_bf16_f32 v125, v98, v99
    v_exp_f32 v100, v100
    v_exp_f32 v101, v101
    v_exp_f32 v102, v102
    v_exp_f32 v103, v103
    v_mfma_f32_32x32x16_bf16 v[56:71], v[144:147], v[120:123], v[56:71]
    s_waitcnt lgkmcnt(0)
    v_cvt_pk_bf16_f32 v126, v100, v101
    v_cvt_pk_bf16_f32 v127, v102, v103
    v_exp_f32 v104, v104
    v_exp_f32 v105, v105
    v_exp_f32 v106, v106
    v_exp_f32 v107, v107
    v_mfma_f32_32x32x16_bf16 v[56:71], v[148:151], v[124:127], v[56:71]
    ds_read_b64_tr_b16 v[144:145], v171 offset:9216
    ds_read_b64_tr_b16 v[146:147], v171 offset:9984
    buffer_load_dwordx4 v220, s[24:27], s69 offen offset:1024 lds
    v_cvt_pk_bf16_f32 v120, v104, v105
    v_cvt_pk_bf16_f32 v121, v106, v107
    v_exp_f32 v108, v108
    v_exp_f32 v109, v109
    v_exp_f32 v110, v110
    v_exp_f32 v111, v111
    v_mfma_f32_32x32x16_bf16 v[88:103], v[128:131], v[8:11], 0
    ds_read_b64_tr_b16 v[148:149], v171 offset:10752
    ds_read_b64_tr_b16 v[150:151], v171 offset:11520
    buffer_load_dwordx4 v220, s[24:27], s69 offen offset:2048 lds
    v_cvt_pk_bf16_f32 v122, v108, v109
    v_cvt_pk_bf16_f32 v123, v110, v111
    v_exp_f32 v112, v112
    v_exp_f32 v113, v113
    v_exp_f32 v114, v114
    v_exp_f32 v115, v115
    v_mfma_f32_32x32x16_bf16 v[88:103], v[132:135], v[12:15], v[88:103]
    ds_read_b128 v[136:139], v169 offset:7728
    ds_read_b128 v[140:143], v170 offset:7680
    buffer_load_dwordx4 v220, s[24:27], s69 offen offset:3072 lds
    v_cvt_pk_bf16_f32 v124, v112, v113
    v_cvt_pk_bf16_f32 v125, v114, v115
    v_exp_f32 v116, v116
    v_exp_f32 v117, v117
    v_exp_f32 v118, v118
    v_exp_f32 v119, v119
    v_mfma_f32_32x32x16_bf16 v[72:87], v[152:155], v[120:123], v[72:87]
    s_waitcnt vmcnt(17)
    s_barrier
    s_waitcnt lgkmcnt(0)
    v_cvt_pk_bf16_f32 v126, v116, v117
    v_cvt_pk_bf16_f32 v127, v118, v119
    v_exp_f32 v88, v88
    v_exp_f32 v89, v89
    v_exp_f32 v90, v90
    v_exp_f32 v91, v91
    v_mfma_f32_32x32x16_bf16 v[72:87], v[156:159], v[124:127], v[72:87]
    ds_read_b64_tr_b16 v[152:153], v172 offset:9216
    ds_read_b64_tr_b16 v[154:155], v172 offset:9984
    s_add_u32 s69, s65, 24576
    s_add_u32 m0, s64, 86016
    s_nop 0
    buffer_load_dwordx4 v220, s[24:27], s69 offen offset:0 lds
    v_cvt_pk_bf16_f32 v120, v88, v89
    v_cvt_pk_bf16_f32 v121, v90, v91
    v_exp_f32 v92, v92
    v_exp_f32 v93, v93
    v_exp_f32 v94, v94
    v_exp_f32 v95, v95
    v_mfma_f32_32x32x16_bf16 v[104:119], v[136:139], v[16:19], 0
    ds_read_b64_tr_b16 v[156:157], v172 offset:10752
    ds_read_b64_tr_b16 v[158:159], v172 offset:11520
    s_add_u32 s69, s65, 40960
    s_add_u32 m0, s64, 102400
    s_nop 0
    buffer_load_dwordx4 v220, s[24:27], s69 offen offset:0 lds
    v_cvt_pk_bf16_f32 v122, v92, v93
    v_cvt_pk_bf16_f32 v123, v94, v95
    v_exp_f32 v96, v96
    v_exp_f32 v97, v97
    v_exp_f32 v98, v98
    v_exp_f32 v99, v99
    v_mfma_f32_32x32x16_bf16 v[104:119], v[140:143], v[20:23], v[104:119]
    ds_read_b128 v[128:131], v169 offset:10240
    ds_read_b128 v[132:135], v170 offset:10240
    buffer_load_dwordx4 v220, s[24:27], s69 offen offset:1024 lds
    v_cvt_pk_bf16_f32 v124, v96, v97
    v_cvt_pk_bf16_f32 v125, v98, v99
    v_exp_f32 v100, v100
    v_exp_f32 v101, v101
    v_exp_f32 v102, v102
    v_exp_f32 v103, v103
    v_mfma_f32_32x32x16_bf16 v[56:71], v[144:147], v[120:123], v[56:71]
    s_waitcnt lgkmcnt(0)
    v_cvt_pk_bf16_f32 v126, v100, v101
    v_cvt_pk_bf16_f32 v127, v102, v103
    v_exp_f32 v104, v104
    v_exp_f32 v105, v105
    v_exp_f32 v106, v106
    v_exp_f32 v107, v107
    v_mfma_f32_32x32x16_bf16 v[56:71], v[148:151], v[124:127], v[56:71]
    ds_read_b64_tr_b16 v[144:145], v171 offset:12288
    ds_read_b64_tr_b16 v[146:147], v171 offset:13056
    buffer_load_dwordx4 v220, s[24:27], s69 offen offset:2048 lds
    v_cvt_pk_bf16_f32 v120, v104, v105
    v_cvt_pk_bf16_f32 v121, v106, v107
    v_exp_f32 v108, v108
    v_exp_f32 v109, v109
    v_exp_f32 v110, v110
    v_exp_f32 v111, v111
    v_mfma_f32_32x32x16_bf16 v[88:103], v[128:131], v[8:11], 0
    ds_read_b64_tr_b16 v[148:149], v171 offset:13824
    ds_read_b64_tr_b16 v[150:151], v171 offset:14592
    buffer_load_dwordx4 v220, s[24:27], s69 offen offset:3072 lds
    v_cvt_pk_bf16_f32 v122, v108, v109
    v_cvt_pk_bf16_f32 v123, v110, v111
    v_exp_f32 v112, v112
    v_exp_f32 v113, v113
    v_exp_f32 v114, v114
    v_exp_f32 v115, v115
    v_mfma_f32_32x32x16_bf16 v[88:103], v[132:135], v[12:15], v[88:103]
    ds_read_b128 v[136:139], v169 offset:10288
    ds_read_b128 v[140:143], v170 offset:10240
    s_add_u32 s69, s65, 45056
    s_add_u32 m0, s64, 106496
    s_nop 0
    buffer_load_dwordx4 v220, s[24:27], s69 offen offset:0 lds
    v_cvt_pk_bf16_f32 v124, v112, v113
    v_cvt_pk_bf16_f32 v125, v114, v115
    v_exp_f32 v116, v116
    v_exp_f32 v117, v117
    v_exp_f32 v118, v118
    v_exp_f32 v119, v119
    v_mfma_f32_32x32x16_bf16 v[72:87], v[152:155], v[120:123], v[72:87]
    s_waitcnt vmcnt(21)
    s_barrier
    s_waitcnt lgkmcnt(0)
    v_cvt_pk_bf16_f32 v126, v116, v117
    v_cvt_pk_bf16_f32 v127, v118, v119
    v_exp_f32 v88, v88
    v_exp_f32 v89, v89
    v_exp_f32 v90, v90
    v_exp_f32 v91, v91
    v_mfma_f32_32x32x16_bf16 v[72:87], v[156:159], v[124:127], v[72:87]
    ds_read_b64_tr_b16 v[152:153], v172 offset:12288
    ds_read_b64_tr_b16 v[154:155], v172 offset:13056
    s_add_u32 s69, s65, 61440
    s_add_u32 m0, s64, 122880
    s_nop 0
    buffer_load_dwordx4 v220, s[24:27], s69 offen offset:0 lds
    v_cvt_pk_bf16_f32 v120, v88, v89
    v_cvt_pk_bf16_f32 v121, v90, v91
    v_exp_f32 v92, v92
    v_exp_f32 v93, v93
    v_exp_f32 v94, v94
    v_exp_f32 v95, v95
    v_mfma_f32_32x32x16_bf16 v[104:119], v[136:139], v[16:19], 0
    ds_read_b64_tr_b16 v[156:157], v172 offset:13824
    ds_read_b64_tr_b16 v[158:159], v172 offset:14592
    buffer_load_dwordx4 v220, s[24:27], s69 offen offset:1024 lds
    v_cvt_pk_bf16_f32 v122, v92, v93
    v_cvt_pk_bf16_f32 v123, v94, v95
    v_exp_f32 v96, v96
    v_exp_f32 v97, v97
    v_exp_f32 v98, v98
    v_exp_f32 v99, v99
    v_mfma_f32_32x32x16_bf16 v[104:119], v[140:143], v[20:23], v[104:119]
    ds_read_b128 v[128:131], v169 offset:12800
    ds_read_b128 v[132:135], v170 offset:12800
    buffer_load_dwordx4 v220, s[24:27], s69 offen offset:2048 lds
    v_cvt_pk_bf16_f32 v124, v96, v97
    v_cvt_pk_bf16_f32 v125, v98, v99
    v_exp_f32 v100, v100
    v_exp_f32 v101, v101
    v_exp_f32 v102, v102
    v_exp_f32 v103, v103
    v_mfma_f32_32x32x16_bf16 v[56:71], v[144:147], v[120:123], v[56:71]
    s_waitcnt lgkmcnt(0)
    v_cvt_pk_bf16_f32 v126, v100, v101
    v_cvt_pk_bf16_f32 v127, v102, v103
    v_exp_f32 v104, v104
    v_exp_f32 v105, v105
    v_exp_f32 v106, v106
    v_exp_f32 v107, v107
    v_mfma_f32_32x32x16_bf16 v[56:71], v[148:151], v[124:127], v[56:71]
    ds_read_b64_tr_b16 v[144:145], v171 offset:15360
    ds_read_b64_tr_b16 v[146:147], v171 offset:16128
    buffer_load_dwordx4 v220, s[24:27], s69 offen offset:3072 lds
    v_cvt_pk_bf16_f32 v120, v104, v105
    v_cvt_pk_bf16_f32 v121, v106, v107
    v_exp_f32 v108, v108
    v_exp_f32 v109, v109
    v_exp_f32 v110, v110
    v_exp_f32 v111, v111
    v_mfma_f32_32x32x16_bf16 v[88:103], v[128:131], v[8:11], 0
    ds_read_b64_tr_b16 v[148:149], v171 offset:16896
    ds_read_b64_tr_b16 v[150:151], v171 offset:17664
    s_add_u32 s69, s65, 65536
    s_add_u32 m0, s64, 126976
    s_nop 0
    buffer_load_dwordx4 v220, s[24:27], s69 offen offset:0 lds
    v_cvt_pk_bf16_f32 v122, v108, v109
    v_cvt_pk_bf16_f32 v123, v110, v111
    v_exp_f32 v112, v112
    v_exp_f32 v113, v113
    v_exp_f32 v114, v114
    v_exp_f32 v115, v115
    v_mfma_f32_32x32x16_bf16 v[88:103], v[132:135], v[12:15], v[88:103]
    ds_read_b128 v[136:139], v169 offset:12848
    ds_read_b128 v[140:143], v170 offset:12800
    v_cvt_pk_bf16_f32 v124, v112, v113
    v_cvt_pk_bf16_f32 v125, v114, v115
    v_exp_f32 v116, v116
    v_exp_f32 v117, v117
    v_exp_f32 v118, v118
    v_exp_f32 v119, v119
    v_mfma_f32_32x32x16_bf16 v[72:87], v[152:155], v[120:123], v[72:87]
    s_waitcnt vmcnt(24)
    s_barrier
    s_waitcnt lgkmcnt(0)
    v_cvt_pk_bf16_f32 v126, v116, v117
    v_cvt_pk_bf16_f32 v127, v118, v119
    v_exp_f32 v88, v88
    v_exp_f32 v89, v89
    v_exp_f32 v90, v90
    v_exp_f32 v91, v91
    v_mfma_f32_32x32x16_bf16 v[72:87], v[156:159], v[124:127], v[72:87]
    ds_read_b64_tr_b16 v[152:153], v172 offset:15360
    ds_read_b64_tr_b16 v[154:155], v172 offset:16128
    s_lshl_b32 s64, s39, 2
    s_add_u32 s64, s64, s3
    s_lshl_b32 s66, s38, 14
    s_lshl_b32 s65, s64, 7
    s_add_u32 s66, s66, s65
    s_add_u32 s66, s66, 14680064
    v_lshlrev_b32 v1, 7, v0
    s_mov_b64 exec, 0x1
    buffer_load_dword v199, v1, s[24:27], s66 offen sc1
    s_mov_b64 exec, -1
    s_lshr_b32 s65, s64, 6
    s_lshl_b32 s66, s38, 1
    s_add_u32 s65, s65, s66
    s_mul_i32 s65, s65, 606208
    s_and_b32 s66, s64, 63
    s_mul_i32 s66, s66, 1792
    s_add_u32 s66, s66, s65
    s_add_u32 s66, s66, 622592
    v_lshlrev_b32 v1, 7, v0
    s_mov_b64 exec, 0x3fff
    buffer_load_dword v199, v1, s[24:27], s66 offen sc1
    s_mov_b64 exec, -1
    v_cvt_pk_bf16_f32 v120, v88, v89
    v_cvt_pk_bf16_f32 v121, v90, v91
    v_exp_f32 v92, v92
    v_exp_f32 v93, v93
    v_exp_f32 v94, v94
    v_exp_f32 v95, v95
    v_mfma_f32_32x32x16_bf16 v[104:119], v[136:139], v[16:19], 0
    ds_read_b64_tr_b16 v[156:157], v172 offset:16896
    ds_read_b64_tr_b16 v[158:159], v172 offset:17664
    s_mul_i32 s64, s3, 7168
    s_add_u32 s64, s64, 86016
    s_mul_i32 s65, s54, 143360
    s_add_u32 s65, s65, s64
    s_add_u32 s65, s65, 24117248
    s_add_u32 s66, s65, 0
    buffer_load_dwordx4 a[80:83], v220, s[24:27], s66 offen offset:0
    v_cvt_pk_bf16_f32 v122, v92, v93
    v_cvt_pk_bf16_f32 v123, v94, v95
    v_exp_f32 v96, v96
    v_exp_f32 v97, v97
    v_exp_f32 v98, v98
    v_exp_f32 v99, v99
    v_mfma_f32_32x32x16_bf16 v[104:119], v[140:143], v[20:23], v[104:119]
    ds_read_b128 v[128:131], v169 offset:15360
    ds_read_b128 v[132:135], v170 offset:15360
    buffer_load_dwordx4 a[84:87], v220, s[24:27], s66 offen offset:1024
    v_cvt_pk_bf16_f32 v124, v96, v97
    v_cvt_pk_bf16_f32 v125, v98, v99
    v_exp_f32 v100, v100
    v_exp_f32 v101, v101
    v_exp_f32 v102, v102
    v_exp_f32 v103, v103
    v_mfma_f32_32x32x16_bf16 v[56:71], v[144:147], v[120:123], v[56:71]
    s_waitcnt lgkmcnt(0)
    v_cvt_pk_bf16_f32 v126, v100, v101
    v_cvt_pk_bf16_f32 v127, v102, v103
    v_exp_f32 v104, v104
    v_exp_f32 v105, v105
    v_exp_f32 v106, v106
    v_exp_f32 v107, v107
    v_mfma_f32_32x32x16_bf16 v[56:71], v[148:151], v[124:127], v[56:71]
    ds_read_b64_tr_b16 v[144:145], v171 offset:18432
    ds_read_b64_tr_b16 v[146:147], v171 offset:19200
    buffer_load_dwordx4 a[88:91], v220, s[24:27], s66 offen offset:2048
    v_cvt_pk_bf16_f32 v120, v104, v105
    v_cvt_pk_bf16_f32 v121, v106, v107
    v_exp_f32 v108, v108
    v_exp_f32 v109, v109
    v_exp_f32 v110, v110
    v_exp_f32 v111, v111
    v_mfma_f32_32x32x16_bf16 v[88:103], v[128:131], v[8:11], 0
    ds_read_b64_tr_b16 v[148:149], v171 offset:19968
    ds_read_b64_tr_b16 v[150:151], v171 offset:20736
    buffer_load_dwordx4 a[92:95], v220, s[24:27], s66 offen offset:3072
    v_cvt_pk_bf16_f32 v122, v108, v109
    v_cvt_pk_bf16_f32 v123, v110, v111
    v_exp_f32 v112, v112
    v_exp_f32 v113, v113
    v_exp_f32 v114, v114
    v_exp_f32 v115, v115
    v_mfma_f32_32x32x16_bf16 v[88:103], v[132:135], v[12:15], v[88:103]
    ds_read_b128 v[136:139], v169 offset:15408
    ds_read_b128 v[140:143], v170 offset:15360
    s_add_u32 s66, s65, 4096
    buffer_load_dwordx4 a[96:99], v220, s[24:27], s66 offen offset:0
    v_cvt_pk_bf16_f32 v124, v112, v113
    v_cvt_pk_bf16_f32 v125, v114, v115
    v_exp_f32 v116, v116
    v_exp_f32 v117, v117
    v_exp_f32 v118, v118
    v_exp_f32 v119, v119
    v_mfma_f32_32x32x16_bf16 v[72:87], v[152:155], v[120:123], v[72:87]
    s_waitcnt vmcnt(29)
    s_barrier
    s_mov_b64 exec, 0xffff
    buffer_load_dword v177, v176, s[24:27], 0 offen sc1
    s_mov_b64 exec, -1
    s_waitcnt lgkmcnt(0)
    v_cvt_pk_bf16_f32 v126, v116, v117
    v_cvt_pk_bf16_f32 v127, v118, v119
    v_exp_f32 v88, v88
    v_exp_f32 v89, v89
    v_exp_f32 v90, v90
    v_exp_f32 v91, v91
    v_mfma_f32_32x32x16_bf16 v[72:87], v[156:159], v[124:127], v[72:87]
    ds_read_b64_tr_b16 v[152:153], v172 offset:18432
    ds_read_b64_tr_b16 v[154:155], v172 offset:19200
    buffer_load_dwordx4 a[100:103], v220, s[24:27], s66 offen offset:1024
    v_cvt_pk_bf16_f32 v120, v88, v89
    v_cvt_pk_bf16_f32 v121, v90, v91
    v_exp_f32 v92, v92
    v_exp_f32 v93, v93
    v_exp_f32 v94, v94
    v_exp_f32 v95, v95
    v_mfma_f32_32x32x16_bf16 v[104:119], v[136:139], v[16:19], 0
    ds_read_b64_tr_b16 v[156:157], v172 offset:19968
    ds_read_b64_tr_b16 v[158:159], v172 offset:20736
    buffer_load_dwordx4 a[104:107], v220, s[24:27], s66 offen offset:2048
    v_cvt_pk_bf16_f32 v122, v92, v93
    v_cvt_pk_bf16_f32 v123, v94, v95
    v_exp_f32 v96, v96
    v_exp_f32 v97, v97
    v_exp_f32 v98, v98
    v_exp_f32 v99, v99
    v_mfma_f32_32x32x16_bf16 v[104:119], v[140:143], v[20:23], v[104:119]
    ds_read_b128 v[128:131], v169 offset:17920
    ds_read_b128 v[132:135], v170 offset:17920
    s_add_u32 s66, s65, 28672
    buffer_load_dwordx4 a[108:111], v220, s[24:27], s66 offen offset:0
    v_cvt_pk_bf16_f32 v124, v96, v97
    v_cvt_pk_bf16_f32 v125, v98, v99
    v_exp_f32 v100, v100
    v_exp_f32 v101, v101
    v_exp_f32 v102, v102
    v_exp_f32 v103, v103
    v_mfma_f32_32x32x16_bf16 v[56:71], v[144:147], v[120:123], v[56:71]
    s_waitcnt lgkmcnt(0)
    v_cvt_pk_bf16_f32 v126, v100, v101
    v_cvt_pk_bf16_f32 v127, v102, v103
    v_exp_f32 v104, v104
    v_exp_f32 v105, v105
    v_exp_f32 v106, v106
    v_exp_f32 v107, v107
    v_mfma_f32_32x32x16_bf16 v[56:71], v[148:151], v[124:127], v[56:71]
    ds_read_b64_tr_b16 v[144:145], v171 offset:21504
    ds_read_b64_tr_b16 v[146:147], v171 offset:22272
    buffer_load_dwordx4 a[112:115], v220, s[24:27], s66 offen offset:1024
    v_cvt_pk_bf16_f32 v120, v104, v105
    v_cvt_pk_bf16_f32 v121, v106, v107
    v_exp_f32 v108, v108
    v_exp_f32 v109, v109
    v_exp_f32 v110, v110
    v_exp_f32 v111, v111
    v_mfma_f32_32x32x16_bf16 v[88:103], v[128:131], v[8:11], 0
    ds_read_b64_tr_b16 v[148:149], v171 offset:23040
    ds_read_b64_tr_b16 v[150:151], v171 offset:23808
    buffer_load_dwordx4 a[116:119], v220, s[24:27], s66 offen offset:2048
    v_cvt_pk_bf16_f32 v122, v108, v109
    v_cvt_pk_bf16_f32 v123, v110, v111
    v_exp_f32 v112, v112
    v_exp_f32 v113, v113
    v_exp_f32 v114, v114
    v_exp_f32 v115, v115
    v_mfma_f32_32x32x16_bf16 v[88:103], v[132:135], v[12:15], v[88:103]
    ds_read_b128 v[136:139], v169 offset:17968
    ds_read_b128 v[140:143], v170 offset:17920
    buffer_load_dwordx4 a[120:123], v220, s[24:27], s66 offen offset:3072
    v_cvt_pk_bf16_f32 v124, v112, v113
    v_cvt_pk_bf16_f32 v125, v114, v115
    v_exp_f32 v116, v116
    v_exp_f32 v117, v117
    v_exp_f32 v118, v118
    v_exp_f32 v119, v119
    v_mfma_f32_32x32x16_bf16 v[72:87], v[152:155], v[120:123], v[72:87]
    s_waitcnt vmcnt(34)
    s_barrier
    s_waitcnt lgkmcnt(0)
    v_cvt_pk_bf16_f32 v126, v116, v117
    v_cvt_pk_bf16_f32 v127, v118, v119
    v_exp_f32 v88, v88
    v_exp_f32 v89, v89
    v_exp_f32 v90, v90
    v_exp_f32 v91, v91
    v_mfma_f32_32x32x16_bf16 v[72:87], v[156:159], v[124:127], v[72:87]
    ds_read_b64_tr_b16 v[152:153], v172 offset:21504
    ds_read_b64_tr_b16 v[154:155], v172 offset:22272
    s_add_u32 s66, s65, 32768
    buffer_load_dwordx4 a[124:127], v220, s[24:27], s66 offen offset:0
    v_cvt_pk_bf16_f32 v120, v88, v89
    v_cvt_pk_bf16_f32 v121, v90, v91
    v_exp_f32 v92, v92
    v_exp_f32 v93, v93
    v_exp_f32 v94, v94
    v_exp_f32 v95, v95
    v_mfma_f32_32x32x16_bf16 v[104:119], v[136:139], v[16:19], 0
    ds_read_b64_tr_b16 v[156:157], v172 offset:23040
    ds_read_b64_tr_b16 v[158:159], v172 offset:23808
    buffer_load_dwordx4 a[128:131], v220, s[24:27], s66 offen offset:1024
    v_cvt_pk_bf16_f32 v122, v92, v93
    v_cvt_pk_bf16_f32 v123, v94, v95
    v_exp_f32 v96, v96
    v_exp_f32 v97, v97
    v_exp_f32 v98, v98
    v_exp_f32 v99, v99
    v_mfma_f32_32x32x16_bf16 v[104:119], v[140:143], v[20:23], v[104:119]
    ds_read_b128 v[128:131], v169 offset:20480
    ds_read_b128 v[132:135], v170 offset:20480
    buffer_load_dwordx4 a[132:135], v220, s[24:27], s66 offen offset:2048
    v_cvt_pk_bf16_f32 v124, v96, v97
    v_cvt_pk_bf16_f32 v125, v98, v99
    v_exp_f32 v100, v100
    v_exp_f32 v101, v101
    v_exp_f32 v102, v102
    v_exp_f32 v103, v103
    v_mfma_f32_32x32x16_bf16 v[56:71], v[144:147], v[120:123], v[56:71]
    s_waitcnt lgkmcnt(0)
    v_cvt_pk_bf16_f32 v126, v100, v101
    v_cvt_pk_bf16_f32 v127, v102, v103
    v_exp_f32 v104, v104
    v_exp_f32 v105, v105
    v_exp_f32 v106, v106
    v_exp_f32 v107, v107
    v_mfma_f32_32x32x16_bf16 v[56:71], v[148:151], v[124:127], v[56:71]
    ds_read_b64_tr_b16 v[144:145], v171 offset:24576
    ds_read_b64_tr_b16 v[146:147], v171 offset:25344
    v_cvt_pk_bf16_f32 v120, v104, v105
    v_cvt_pk_bf16_f32 v121, v106, v107
    v_exp_f32 v108, v108
    v_exp_f32 v109, v109
    v_exp_f32 v110, v110
    v_exp_f32 v111, v111
    v_mfma_f32_32x32x16_bf16 v[88:103], v[128:131], v[8:11], v[24:39]
    ds_read_b64_tr_b16 v[148:149], v171 offset:26112
    ds_read_b64_tr_b16 v[150:151], v171 offset:26880
    v_cvt_pk_bf16_f32 v122, v108, v109
    v_cvt_pk_bf16_f32 v123, v110, v111
    v_exp_f32 v112, v112
    v_exp_f32 v113, v113
    v_exp_f32 v114, v114
    v_exp_f32 v115, v115
    v_mfma_f32_32x32x16_bf16 v[88:103], v[132:135], v[12:15], v[88:103]
    ds_read_b128 v[136:139], v169 offset:20528
    ds_read_b128 v[140:143], v170 offset:20480
    v_cvt_pk_bf16_f32 v124, v112, v113
    v_cvt_pk_bf16_f32 v125, v114, v115
    v_exp_f32 v116, v116
    v_exp_f32 v117, v117
    v_exp_f32 v118, v118
    v_exp_f32 v119, v119
    v_mfma_f32_32x32x16_bf16 v[72:87], v[152:155], v[120:123], v[72:87]
    s_waitcnt lgkmcnt(0)
    v_cvt_pk_bf16_f32 v126, v116, v117
    v_cvt_pk_bf16_f32 v127, v118, v119
    v_exp_f32 v88, v88
    v_exp_f32 v89, v89
    v_exp_f32 v90, v90
    v_exp_f32 v91, v91
    v_mfma_f32_32x32x16_bf16 v[72:87], v[156:159], v[124:127], v[72:87]
    ds_read_b64_tr_b16 v[152:153], v172 offset:24576
    ds_read_b64_tr_b16 v[154:155], v172 offset:25344
    v_cvt_pk_bf16_f32 v120, v88, v89
    v_cvt_pk_bf16_f32 v121, v90, v91
    v_exp_f32 v92, v92
    v_exp_f32 v93, v93
    v_exp_f32 v94, v94
    v_exp_f32 v95, v95
    v_mfma_f32_32x32x16_bf16 v[104:119], v[136:139], v[16:19], v[24:39]
    ds_read_b64_tr_b16 v[156:157], v172 offset:26112
    ds_read_b64_tr_b16 v[158:159], v172 offset:26880
    v_cvt_pk_bf16_f32 v122, v92, v93
    v_cvt_pk_bf16_f32 v123, v94, v95
    v_exp_f32 v96, v96
    v_exp_f32 v97, v97
    v_exp_f32 v98, v98
    v_exp_f32 v99, v99
    v_mfma_f32_32x32x16_bf16 v[104:119], v[140:143], v[20:23], v[104:119]
    v_cvt_pk_bf16_f32 v124, v96, v97
    v_cvt_pk_bf16_f32 v125, v98, v99
    v_exp_f32 v100, v100
    v_exp_f32 v101, v101
    v_exp_f32 v102, v102
    v_exp_f32 v103, v103
    v_mfma_f32_32x32x16_bf16 v[56:71], v[144:147], v[120:123], v[56:71]
    s_waitcnt lgkmcnt(0)
    v_cvt_pk_bf16_f32 v126, v100, v101
    v_cvt_pk_bf16_f32 v127, v102, v103
    s_nop 1
    v_exp_f32 v104, v104
    v_exp_f32 v105, v105
    v_exp_f32 v106, v106
    v_exp_f32 v107, v107
    v_mfma_f32_32x32x16_bf16 v[56:71], v[148:151], v[124:127], v[56:71]
    v_cvt_pk_bf16_f32 v120, v104, v105
    v_cvt_pk_bf16_f32 v121, v106, v107
    v_exp_f32 v108, v108
    v_exp_f32 v109, v109
    v_exp_f32 v110, v110
    v_exp_f32 v111, v111
    v_cvt_pk_bf16_f32 v122, v108, v109
    v_cvt_pk_bf16_f32 v123, v110, v111
    v_exp_f32 v112, v112
    v_exp_f32 v113, v113
    v_exp_f32 v114, v114
    v_exp_f32 v115, v115
    v_cvt_pk_bf16_f32 v124, v112, v113
    v_cvt_pk_bf16_f32 v125, v114, v115
    v_exp_f32 v116, v116
    v_exp_f32 v117, v117
    v_exp_f32 v118, v118
    v_exp_f32 v119, v119
    v_mfma_f32_32x32x16_bf16 v[72:87], v[152:155], v[120:123], v[72:87]
    v_cvt_pk_bf16_f32 v126, v116, v117
    v_cvt_pk_bf16_f32 v127, v118, v119
    s_nop 1
    v_mfma_f32_32x32x16_bf16 v[72:87], v[156:159], v[124:127], v[72:87]
    s_waitcnt vmcnt(9)
    s_mov_b64 exec, 0xffff
    v_cmp_ne_u32 vcc, s40, v177
    s_mov_b64 exec, -1
    s_cmp_lg_u64 vcc, 0
    s_cbranch_scc1 L_rare_51
L_back_52:
    v_mov_b32 v1, v64
    v_mov_b32 v2, v64
    s_nop 3
    v_mov_b32 v3, v80
    v_mov_b32 v4, v80
    s_mov_b32 s60, 0x2b800000
    s_mov_b32 s61, 0x53800000
    v_permlane32_swap_b32 v1, v2
    v_permlane32_swap_b32 v3, v4
    v_cmp_nle_f32 vcc, s60, v2
    v_cmp_nge_f32 s[62:63], s61, v2
    v_cmp_nle_f32 s[64:65], s60, v4
    v_cmp_nge_f32 s[66:67], s61, v4
    s_or_b64 vcc, vcc, s[62:63]
    s_or_b64 s[64:65], s[64:65], s[66:67]
    s_or_b64 vcc, vcc, s[64:65]
    s_cmp_lg_u64 vcc, 0
    s_cbranch_scc1 L_rare_55
L_back_56:
    v_mov_b32 v1, v64
    v_mov_b32 v2, v64
    s_nop 1
    v_permlane32_swap_b32 v1, v2
    v_rcp_f32 v2, v2
    s_nop 0
    v_pk_mul_f32 v[56:57], v[56:57], v[2:3] op_sel_hi:[1,0]
    v_pk_mul_f32 v[58:59], v[58:59], v[2:3] op_sel_hi:[1,0]
    v_pk_mul_f32 v[60:61], v[60:61], v[2:3] op_sel_hi:[1,0]
    v_pk_mul_f32 v[62:63], v[62:63], v[2:3] op_sel_hi:[1,0]
    v_pk_mul_f32 v[64:65], v[64:65], v[2:3] op_sel_hi:[1,0]
    v_pk_mul_f32 v[66:67], v[66:67], v[2:3] op_sel_hi:[1,0]
    v_cvt_pk_bf16_f32 v128, v56, v57
    v_cvt_pk_bf16_f32 v129, v58, v59
    v_cvt_pk_bf16_f32 v130, v60, v61
    v_cvt_pk_bf16_f32 v131, v62, v63
    v_cvt_pk_bf16_f32 v132, v64, v65
    v_cvt_pk_bf16_f32 v133, v66, v67
    v_permlane32_swap_b32 v128, v130
    v_permlane32_swap_b32 v129, v131
    v_mov_b32 v1, v80
    v_mov_b32 v2, v80
    s_nop 1
    v_permlane32_swap_b32 v1, v2
    v_rcp_f32 v2, v2
    s_nop 0
    v_pk_mul_f32 v[72:73], v[72:73], v[2:3] op_sel_hi:[1,0]
    v_pk_mul_f32 v[74:75], v[74:75], v[2:3] op_sel_hi:[1,0]
    v_pk_mul_f32 v[76:77], v[76:77], v[2:3] op_sel_hi:[1,0]
    v_pk_mul_f32 v[78:79], v[78:79], v[2:3] op_sel_hi:[1,0]
    v_pk_mul_f32 v[80:81], v[80:81], v[2:3] op_sel_hi:[1,0]
    v_pk_mul_f32 v[82:83], v[82:83], v[2:3] op_sel_hi:[1,0]
    v_cvt_pk_bf16_f32 v134, v72, v73
    v_cvt_pk_bf16_f32 v135, v74, v75
    v_cvt_pk_bf16_f32 v136, v76, v77
    v_cvt_pk_bf16_f32 v137, v78, v79
    v_cvt_pk_bf16_f32 v4, v80, v81
    v_cvt_pk_bf16_f32 v5, v82, v83
    v_cmp_gt_u32 vcc, 32, v0
    s_nop 1
    v_cndmask_b32 v132, v134, v132, vcc
    v_cndmask_b32 v133, v135, v133, vcc
    v_permlane32_swap_b32 v134, v136
    v_permlane32_swap_b32 v135, v137
    v_permlane32_swap_b32 v138, v4
    v_permlane32_swap_b32 v139, v5
    v_lshrrev_b32 v1, 5, v0
    s_mul_i32 s66, s54, 5
    v_add_u32 v1, s66, v1
    v_bfe_u32 v2, v0, 4, 1
    v_mul_u32_u24 v2, 20480, v2
    v_and_b32 v3, 15, v0
    v_lshl_add_u32 v2, v3, 4, v2
    s_mul_i32 s66, s53, 606208
    s_mul_i32 s67, s3, 40960
    s_add_u32 s66, s66, s67
    s_add_u32 s60, s66, 294912
    v_add_u32 v4, 0, v1
    v_lshrrev_b32 v5, 2, v4
    v_and_b32 v4, 3, v4
    v_lshlrev_b32 v5, 10, v5
    v_lshl_add_u32 v5, v4, 8, v5
    v_add_u32 v8, v5, v2
    v_add_u32 v4, 2, v1
    v_lshrrev_b32 v5, 2, v4
    v_and_b32 v4, 3, v4
    v_lshlrev_b32 v5, 10, v5
    v_lshl_add_u32 v5, v4, 8, v5
    v_add_u32 v9, v5, v2
    v_add_u32 v4, 3, v1
    v_lshrrev_b32 v5, 2, v4
    v_and_b32 v4, 3, v4
    v_lshlrev_b32 v5, 10, v5
    v_lshl_add_u32 v5, v4, 8, v5
    v_add_u32 v10, v5, v2
    s_cmp_eq_u32 s70, 0
    s_cbranch_scc1 L_alt_73
    buffer_store_dwordx4 v[128:131], v8, s[24:27], s60 offen
    buffer_store_dwordx4 v[132:135], v9, s[24:27], s60 offen
    s_mov_b32 exec_lo, 0
    buffer_store_dwordx4 v[136:139], v10, s[24:27], s60 offen
    s_mov_b64 exec, -1
L_join_74:
    s_waitcnt vmcnt(0)
    s_barrier
    s_cmp_eq_u32 s3, 0
    s_cbranch_scc0 L_pub_75
    s_cmp_eq_u32 s70, 0
    s_cbranch_scc1 L_alt_76
    s_lshl_b32 s42, s83, 6
    s_add_u32 s42, s42, 16384
    v_mov_b32 v1, 0
    v_mov_b32 v2, s40
    s_mov_b64 exec, 1
    buffer_store_dword v2, v1, s[24:27], s42 offen
    s_mov_b64 exec, -1
L_join_77:
    s_lshl_b32 s42, s83, 6
    s_add_u32 s42, s42, 114688
    v_mov_b32 v1, 0
    v_mov_b32 v2, s40
    s_mov_b64 exec, 1
    buffer_store_dword v2, v1, s[24:27], s42 offen sc1
    s_mov_b64 exec, -1
L_pub_75:
    s_mul_i32 s64, s3, 5120
    s_add_u32 s64, s64, 0
    s_mul_i32 s65, s56, 102400
    s_add_u32 s65, s65, s64
    s_add_u32 s65, s65, 23068672
    s_add_u32 s69, s65, 0
    s_add_u32 m0, s64, 61440
    s_nop 0
    buffer_load_dwordx4 v220, s[24:27], s69 offen offset:0 lds
    buffer_load_dwordx4 v220, s[24:27], s69 offen offset:1024 lds
    buffer_load_dwordx4 v220, s[24:27], s69 offen offset:2048 lds
    buffer_load_dwordx4 v220, s[24:27], s69 offen offset:3072 lds
    s_add_u32 s69, s65, 4096
    s_add_u32 m0, s64, 65536
    s_nop 0
    buffer_load_dwordx4 v220, s[24:27], s69 offen offset:0 lds
    s_lshr_b32 s66, s55, 1
    s_lshl_b32 s66, s66, 10
    s_add_u32 s66, s66, 16384
    v_lshlrev_b32 v7, 6, v0
    v_add_u32 v7, s66, v7
    s_lshr_b32 s66, s3, 1
    s_mul_i32 s66, s66, 51200
    s_add_u32 s66, s66, 61440
    v_add_u32 v96, s66, v220
    v_lshlrev_b32 v56, 16, v210
    v_and_b32 v57, 0xffff0000, v210
    v_lshlrev_b32 v58, 16, v211
    v_and_b32 v59, 0xffff0000, v211
    v_lshlrev_b32 v60, 16, v212
    v_and_b32 v61, 0xffff0000, v212
    v_lshlrev_b32 v62, 16, v213
    v_and_b32 v63, 0xffff0000, v213
    v_lshlrev_b32 v64, 16, v214
    v_and_b32 v65, 0xffff0000, v214
    v_lshlrev_b32 v66, 16, v215
    v_and_b32 v67, 0xffff0000, v215
    v_lshlrev_b32 v68, 16, v216
    v_and_b32 v69, 0xffff0000, v216
    v_lshlrev_b32 v70, 16, v217
    v_and_b32 v71, 0xffff0000, v217
    v_lshlrev_b32 v72, 16, v218
    v_and_b32 v73, 0xffff0000, v218
    v_lshlrev_b32 v74, 16, v219
    v_and_b32 v75, 0xffff0000, v219
    s_lshr_b32 s66, s55, 1
    v_lshrrev_b32 v8, 4, v0
    v_add_u32 v8, 1, v8
    v_add_u32 v8, s66, v8
    v_min_u32 v8, 15, v8
    v_lshlrev_b32 v8, 4, v8
    v_and_b32 v9, 15, v0
    v_add_u32 v8, v8, v9
    v_lshlrev_b32 v8, 6, v8
    v_add_u32 v8, 114688, v8
    s_and_b32 s66, s3, 1
    s_lshr_b32 s67, s3, 1
    s_lshl_b32 s66, s66, 1
    s_and_b32 s68, s55, 1
    s_lshl_b32 s68, s68, 2
    s_add_u32 s66, s66, s68
    s_add_u32 s60, s66, s67
    s_xor_b32 s68, s67, 1
    s_add_u32 s61, s66, s68
    s_mul_i32 s67, s67, 10
    s_mul_i32 s60, s60, 20
    s_mul_i32 s61, s61, 20
    s_add_u32 s60, s60, s67
    s_add_u32 s61, s61, s67
    s_lshl_b32 s60, s60, 10
    s_lshl_b32 s61, s61, 10
    s_lshr_b32 s66, s55, 1
    s_mul_i32 s66, s66, 606208
    s_add_u32 s66, s66, 294912
    s_add_u32 s60, s60, s66
    s_add_u32 s61, s61, s66
    s_cmp_eq_u32 s3, 0
    s_cbranch_scc0 L_polldone_80
    s_mov_b32 s42, 0
    s_mov_b64 exec, 0xffff
L_poll_78:
    buffer_load_dword v2, v7, s[24:27], 0 offen sc1
    s_add_u32 s42, s42, 1
    s_waitcnt vmcnt(0)
    v_cmp_ne_u32 vcc, s40, v2
    s_cmp_gt_u32 s42, 0x40000
    s_cbranch_scc1 L_got_79
    s_nop 1
    s_cbranch_vccnz L_poll_78
L_got_79:
    s_mov_b64 exec, -1
L_polldone_80:
    s_barrier
    buffer_load_dwordx4 a[0:3], v220, s[24:27], s60 offen offset:0 sc1
    buffer_load_dwordx4 a[4:7], v220, s[24:27], s61 offen offset:0 sc1
    buffer_load_dwordx4 a[8:11], v220, s[24:27], s60 offen offset:1024 sc1
    buffer_load_dwordx4 a[12:15], v220, s[24:27], s61 offen offset:1024 sc1
    buffer_load_dwordx4 a[16:19], v220, s[24:27], s60 offen offset:2048 sc1
    buffer_load_dwordx4 a[20:23], v220, s[24:27], s61 offen offset:2048 sc1
    s_waitcnt vmcnt(6)
    s_barrier
    ds_read_b128 v[100:103], v96 offset:0
    ds_read_b128 v[104:107], v96 offset:1024
    ds_read_b128 v[108:111], v96 offset:2048
    ds_read_b128 v[112:115], v96 offset:3072
    ds_read_b128 v[116:119], v96 offset:4096
    s_waitcnt vmcnt(4)
    s_waitcnt lgkmcnt(4)
    v_mfma_f32_16x16x32_bf16 v[56:59], v[100:103], a[0:3], v[56:59]
    v_mfma_f32_16x16x32_bf16 v[76:79], v[100:103], a[4:7], 0
    ds_read_b128 v[120:123], v96 offset:5120
    buffer_load_dwordx4 a[24:27], v220, s[24:27], s60 offen offset:3072 sc1
    buffer_load_dwordx4 a[28:31], v220, s[24:27], s61 offen offset:3072 sc1
    s_waitcnt lgkmcnt(4)
    v_mfma_f32_16x16x32_bf16 v[60:63], v[104:107], a[0:3], v[60:63]
    v_mfma_f32_16x16x32_bf16 v[80:83], v[104:107], a[4:7], 0
    ds_read_b128 v[124:127], v96 offset:6144
    s_waitcnt lgkmcnt(4)
    v_mfma_f32_16x16x32_bf16 v[64:67], v[108:111], a[0:3], v[64:67]
    v_mfma_f32_16x16x32_bf16 v[84:87], v[108:111], a[4:7], 0
    ds_read_b128 v[128:131], v96 offset:7168
    s_add_u32 s60, s60, 4096
    buffer_load_dwordx4 a[32:35], v220, s[24:27], s60 offen offset:0 sc1
    s_add_u32 s61, s61, 4096
    buffer_load_dwordx4 a[36:39], v220, s[24:27], s61 offen offset:0 sc1
    s_waitcnt lgkmcnt(4)
    v_mfma_f32_16x16x32_bf16 v[68:71], v[112:115], a[0:3], v[68:71]
    v_mfma_f32_16x16x32_bf16 v[88:91], v[112:115], a[4:7], 0
    ds_read_b128 v[132:135], v96 offset:8192
    s_waitcnt lgkmcnt(4)
    v_mfma_f32_16x16x32_bf16 v[72:75], v[116:119], a[0:3], v[72:75]
    v_mfma_f32_16x16x32_bf16 v[92:95], v[116:119], a[4:7], 0
    ds_read_b128 v[136:139], v96 offset:9216
    s_waitcnt vmcnt(6)
    s_waitcnt lgkmcnt(4)
    v_mfma_f32_16x16x32_bf16 v[56:59], v[120:123], a[8:11], v[56:59]
    v_mfma_f32_16x16x32_bf16 v[76:79], v[120:123], a[12:15], v[76:79]
    ds_read_b128 v[100:103], v96 offset:10240
    buffer_load_dwordx4 a[40:43], v220, s[24:27], s60 offen offset:1024 sc1
    buffer_load_dwordx4 a[44:47], v220, s[24:27], s61 offen offset:1024 sc1
    s_waitcnt lgkmcnt(4)
    v_mfma_f32_16x16x32_bf16 v[60:63], v[124:127], a[8:11], v[60:63]
    v_mfma_f32_16x16x32_bf16 v[80:83], v[124:127], a[12:15], v[80:83]
    ds_read_b128 v[104:107], v96 offset:11264
    s_waitcnt lgkmcnt(4)
    v_mfma_f32_16x16x32_bf16 v[64:67], v[128:131], a[8:11], v[64:67]
    v_mfma_f32_16x16x32_bf16 v[84:87], v[128:131], a[12:15], v[84:87]
    ds_read_b128 v[108:111], v96 offset:12288
    buffer_load_dwordx4 a[48:51], v220, s[24:27], s60 offen offset:2048 sc1
    buffer_load_dwordx4 a[52:55], v220, s[24:27], s61 offen offset:2048 sc1
    s_waitcnt lgkmcnt(4)
    v_mfma_f32_16x16x32_bf16 v[68:71], v[132:135], a[8:11], v[68:71]
    v_mfma_f32_16x16x32_bf16 v[88:91], v[132:135], a[12:15], v[88:91]
    ds_read_b128 v[112:115], v96 offset:13312
    s_waitcnt lgkmcnt(4)
    v_mfma_f32_16x16x32_bf16 v[72:75], v[136:139], a[8:11], v[72:75]
    v_mfma_f32_16x16x32_bf16 v[92:95], v[136:139], a[12:15], v[92:95]
    ds_read_b128 v[116:119], v96 offset:14336
    s_waitcnt vmcnt(8)
    s_waitcnt lgkmcnt(4)
    v_mfma_f32_16x16x32_bf16 v[56:59], v[100:103], a[16:19], v[56:59]
    v_mfma_f32_16x16x32_bf16 v[76:79], v[100:103], a[20:23], v[76:79]
    ds_read_b128 v[120:123], v96 offset:15360
    buffer_load_dwordx4 a[56:59], v220, s[24:27], s60 offen offset:3072 sc1
    buffer_load_dwordx4 a[60:63], v220, s[24:27], s61 offen offset:3072 sc1
    s_waitcnt lgkmcnt(4)
    v_mfma_f32_16x16x32_bf16 v[60:63], v[104:107], a[16:19], v[60:63]
    v_mfma_f32_16x16x32_bf16 v[80:83], v[104:107], a[20:23], v[80:83]
    ds_read_b128 v[124:127], v96 offset:16384
    s_waitcnt lgkmcnt(4)
    v_mfma_f32_16x16x32_bf16 v[64:67], v[108:111], a[16:19], v[64:67]
    v_mfma_f32_16x16x32_bf16 v[84:87], v[108:111], a[20:23], v[84:87]
    ds_read_b128 v[128:131], v96 offset:17408
    s_add_u32 s60, s60, 4096
    buffer_load_dwordx4 a[64:67], v220, s[24:27], s60 offen offset:0 sc1
    s_add_u32 s61, s61, 4096
    buffer_load_dwordx4 a[68:71], v220, s[24:27], s61 offen offset:0 sc1
    s_waitcnt lgkmcnt(4)
    v_mfma_f32_16x16x32_bf16 v[68:71], v[112:115], a[16:19], v[68:71]
    v_mfma_f32_16x16x32_bf16 v[88:91], v[112:115], a[20:23], v[88:91]
    ds_read_b128 v[132:135], v96 offset:18432
    s_waitcnt lgkmcnt(4)
    v_mfma_f32_16x16x32_bf16 v[72:75], v[116:119], a[16:19], v[72:75]
    v_mfma_f32_16x16x32_bf16 v[92:95], v[116:119], a[20:23], v[92:95]
    ds_read_b128 v[136:139], v96 offset:19456
    s_waitcnt vmcnt(10)
    s_waitcnt lgkmcnt(4)
    v_mfma_f32_16x16x32_bf16 v[56:59], v[120:123], a[24:27], v[56:59]
    v_mfma_f32_16x16x32_bf16 v[76:79], v[120:123], a[28:31], v[76:79]
    ds_read_b128 v[100:103], v96 offset:20480
    buffer_load_dwordx4 a[72:75], v220, s[24:27], s60 offen offset:1024 sc1
    buffer_load_dwordx4 a[76:79], v220, s[24:27], s61 offen offset:1024 sc1
    s_waitcnt lgkmcnt(4)
    v_mfma_f32_16x16x32_bf16 v[60:63], v[124:127], a[24:27], v[60:63]
    v_mfma_f32_16x16x32_bf16 v[80:83], v[124:127], a[28:31], v[80:83]
    ds_read_b128 v[104:107], v96 offset:21504
    s_waitcnt lgkmcnt(4)
    v_mfma_f32_16x16x32_bf16 v[64:67], v[128:131], a[24:27], v[64:67]
    v_mfma_f32_16x16x32_bf16 v[84:87], v[128:131], a[28:31], v[84:87]
    ds_read_b128 v[108:111], v96 offset:22528
    s_waitcnt lgkmcnt(4)
    v_mfma_f32_16x16x32_bf16 v[68:71], v[132:135], a[24:27], v[68:71]
    v_mfma_f32_16x16x32_bf16 v[88:91], v[132:135], a[28:31], v[88:91]
    ds_read_b128 v[112:115], v96 offset:23552
    s_waitcnt lgkmcnt(4)
    v_mfma_f32_16x16x32_bf16 v[72:75], v[136:139], a[24:27], v[72:75]
    v_mfma_f32_16x16x32_bf16 v[92:95], v[136:139], a[28:31], v[92:95]
    ds_read_b128 v[116:119], v96 offset:24576
    s_waitcnt vmcnt(10)
    s_waitcnt lgkmcnt(4)
    v_mfma_f32_16x16x32_bf16 v[56:59], v[100:103], a[32:35], v[56:59]
    v_mfma_f32_16x16x32_bf16 v[76:79], v[100:103], a[36:39], v[76:79]
    ds_read_b128 v[120:123], v96 offset:25600
    s_mul_i32 s64, s3, 14336
    s_add_u32 s64, s64, 0
    s_mul_i32 s65, s54, 143360
    s_add_u32 s65, s65, s64
    s_add_u32 s65, s65, 24117248
    s_add_u32 s69, s65, 0
    s_add_u32 m0, s64, 0
    s_nop 0
    buffer_load_dwordx4 v220, s[24:27], s69 offen offset:0 lds
    s_waitcnt lgkmcnt(4)
    v_mfma_f32_16x16x32_bf16 v[60:63], v[104:107], a[32:35], v[60:63]
    v_mfma_f32_16x16x32_bf16 v[80:83], v[104:107], a[36:39], v[80:83]
    ds_read_b128 v[124:127], v96 offset:26624
    s_mov_b64 exec, 0xffffffff
    buffer_load_dword v9, v8, s[24:27], 0 offen sc1
    s_mov_b64 exec, -1
    s_waitcnt lgkmcnt(4)
    v_mfma_f32_16x16x32_bf16 v[64:67], v[108:111], a[32:35], v[64:67]
    v_mfma_f32_16x16x32_bf16 v[84:87], v[108:111], a[36:39], v[84:87]
    ds_read_b128 v[128:131], v96 offset:27648
    buffer_load_dwordx4 v220, s[24:27], s69 offen offset:1024 lds
    s_waitcnt lgkmcnt(4)
    v_mfma_f32_16x16x32_bf16 v[68:71], v[112:115], a[32:35], v[68:71]
    v_mfma_f32_16x16x32_bf16 v[88:91], v[112:115], a[36:39], v[88:91]
    ds_read_b128 v[132:135], v96 offset:28672
    s_waitcnt lgkmcnt(4)
    v_mfma_f32_16x16x32_bf16 v[72:75], v[116:119], a[32:35], v[72:75]
    v_mfma_f32_16x16x32_bf16 v[92:95], v[116:119], a[36:39], v[92:95]
    ds_read_b128 v[136:139], v96 offset:29696
    buffer_load_dwordx4 v220, s[24:27], s69 offen offset:2048 lds
    s_waitcnt vmcnt(12)
    s_waitcnt lgkmcnt(4)
    v_mfma_f32_16x16x32_bf16 v[56:59], v[120:123], a[40:43], v[56:59]
    v_mfma_f32_16x16x32_bf16 v[76:79], v[120:123], a[44:47], v[76:79]
    ds_read_b128 v[100:103], v96 offset:30720
    buffer_load_dwordx4 v220, s[24:27], s69 offen offset:3072 lds
    s_waitcnt lgkmcnt(4)
    v_mfma_f32_16x16x32_bf16 v[60:63], v[124:127], a[40:43], v[60:63]
    v_mfma_f32_16x16x32_bf16 v[80:83], v[124:127], a[44:47], v[80:83]
    ds_read_b128 v[104:107], v96 offset:31744
    s_waitcnt lgkmcnt(4)
    v_mfma_f32_16x16x32_bf16 v[64:67], v[128:131], a[40:43], v[64:67]
    v_mfma_f32_16x16x32_bf16 v[84:87], v[128:131], a[44:47], v[84:87]
    ds_read_b128 v[108:111], v96 offset:32768
    s_add_u32 s69, s65, 4096
    s_add_u32 m0, s64, 4096
    s_nop 0
    buffer_load_dwordx4 v220, s[24:27], s69 offen offset:0 lds
    s_waitcnt lgkmcnt(4)
    v_mfma_f32_16x16x32_bf16 v[68:71], v[132:135], a[40:43], v[68:71]
    v_mfma_f32_16x16x32_bf16 v[88:91], v[132:135], a[44:47], v[88:91]
    ds_read_b128 v[112:115], v96 offset:33792
    s_waitcnt lgkmcnt(4)
    v_mfma_f32_16x16x32_bf16 v[72:75], v[136:139], a[40:43], v[72:75]
    v_mfma_f32_16x16x32_bf16 v[92:95], v[136:139], a[44:47], v[92:95]
    ds_read_b128 v[116:119], v96 offset:34816
    buffer_load_dwordx4 v220, s[24:27], s69 offen offset:1024 lds
    s_waitcnt vmcnt(13)
    s_waitcnt lgkmcnt(4)
    v_mfma_f32_16x16x32_bf16 v[56:59], v[100:103], a[48:51], v[56:59]
    v_mfma_f32_16x16x32_bf16 v[76:79], v[100:103], a[52:55], v[76:79]
    ds_read_b128 v[120:123], v96 offset:35840
    buffer_load_dwordx4 v220, s[24:27], s69 offen offset:2048 lds
    s_waitcnt lgkmcnt(4)
    v_mfma_f32_16x16x32_bf16 v[60:63], v[104:107], a[48:51], v[60:63]
    v_mfma_f32_16x16x32_bf16 v[80:83], v[104:107], a[52:55], v[80:83]
    ds_read_b128 v[124:127], v96 offset:36864
    s_waitcnt lgkmcnt(4)
    v_mfma_f32_16x16x32_bf16 v[64:67], v[108:111], a[48:51], v[64:67]
    v_mfma_f32_16x16x32_bf16 v[84:87], v[108:111], a[52:55], v[84:87]
    ds_read_b128 v[128:131], v96 offset:37888
    s_mul_i32 s64, s3, 14336
    s_add_u32 s64, s64, 7168
    s_mul_i32 s65, s54, 143360
    s_add_u32 s65, s65, s64
    s_add_u32 s65, s65, 24117248
    s_add_u32 s69, s65, 0
    s_add_u32 m0, s64, 0
    s_nop 0
    buffer_load_dwordx4 v220, s[24:27], s69 offen offset:0 lds
    s_waitcnt lgkmcnt(4)
    v_mfma_f32_16x16x32_bf16 v[68:71], v[112:115], a[48:51], v[68:71]
    v_mfma_f32_16x16x32_bf16 v[88:91], v[112:115], a[52:55], v[88:91]
    ds_read_b128 v[132:135], v96 offset:38912
    s_waitcnt lgkmcnt(4)
    v_mfma_f32_16x16x32_bf16 v[72:75], v[116:119], a[48:51], v[72:75]
    v_mfma_f32_16x16x32_bf16 v[92:95], v[116:119], a[52:55], v[92:95]
    ds_read_b128 v[136:139], v96 offset:39936
    buffer_load_dwordx4 v220, s[24:27], s69 offen offset:1024 lds
    s_waitcnt vmcnt(14)
    s_waitcnt lgkmcnt(4)
    v_mfma_f32_16x16x32_bf16 v[56:59], v[120:123], a[56:59], v[56:59]
    v_mfma_f32_16x16x32_bf16 v[76:79], v[120:123], a[60:63], v[76:79]
    ds_read_b128 v[100:103], v96 offset:40960
    buffer_load_dwordx4 v220, s[24:27], s69 offen offset:2048 lds
    s_waitcnt lgkmcnt(4)
    v_mfma_f32_16x16x32_bf16 v[60:63], v[124:127], a[56:59], v[60:63]
    v_mfma_f32_16x16x32_bf16 v[80:83], v[124:127], a[60:63], v[80:83]
    ds_read_b128 v[104:107], v96 offset:41984
    s_waitcnt lgkmcnt(4)
    v_mfma_f32_16x16x32_bf16 v[64:67], v[128:131], a[56:59], v[64:67]
    v_mfma_f32_16x16x32_bf16 v[84:87], v[128:131], a[60:63], v[84:87]
    ds_read_b128 v[108:111], v96 offset:43008
    buffer_load_dwordx4 v220, s[24:27], s69 offen offset:3072 lds
    s_waitcnt lgkmcnt(4)
    v_mfma_f32_16x16x32_bf16 v[68:71], v[132:135], a[56:59], v[68:71]
    v_mfma_f32_16x16x32_bf16 v[88:91], v[132:135], a[60:63], v[88:91]
    ds_read_b128 v[112:115], v96 offset:44032
    s_waitcnt lgkmcnt(4)
    v_mfma_f32_16x16x32_bf16 v[72:75], v[136:139], a[56:59], v[72:75]
    v_mfma_f32_16x16x32_bf16 v[92:95], v[136:139], a[60:63], v[92:95]
    ds_read_b128 v[116:119], v96 offset:45056
    s_add_u32 s69, s65, 4096
    s_add_u32 m0, s64, 4096
    s_nop 0
    buffer_load_dwordx4 v220, s[24:27], s69 offen offset:0 lds
    s_waitcnt vmcnt(15)
    s_waitcnt lgkmcnt(4)
    v_mfma_f32_16x16x32_bf16 v[56:59], v[100:103], a[64:67], v[56:59]
    v_mfma_f32_16x16x32_bf16 v[76:79], v[100:103], a[68:71], v[76:79]
    ds_read_b128 v[120:123], v96 offset:46080
    buffer_load_dwordx4 v220, s[24:27], s69 offen offset:1024 lds
    s_waitcnt lgkmcnt(4)
    v_mfma_f32_16x16x32_bf16 v[60:63], v[104:107], a[64:67], v[60:63]
    v_mfma_f32_16x16x32_bf16 v[80:83], v[104:107], a[68:71], v[80:83]
    ds_read_b128 v[124:127], v96 offset:47104
    s_waitcnt lgkmcnt(4)
    v_mfma_f32_16x16x32_bf16 v[64:67], v[108:111], a[64:67], v[64:67]
    v_mfma_f32_16x16x32_bf16 v[84:87], v[108:111], a[68:71], v[84:87]
    ds_read_b128 v[128:131], v96 offset:48128
    buffer_load_dwordx4 v220, s[24:27], s69 offen offset:2048 lds
    s_waitcnt lgkmcnt(4)
    v_mfma_f32_16x16x32_bf16 v[68:71], v[112:115], a[64:67], v[68:71]
    v_mfma_f32_16x16x32_bf16 v[88:91], v[112:115], a[68:71], v[88:91]
    ds_read_b128 v[132:135], v96 offset:49152
    s_waitcnt lgkmcnt(4)
    v_mfma_f32_16x16x32_bf16 v[72:75], v[116:119], a[64:67], v[72:75]
    v_mfma_f32_16x16x32_bf16 v[92:95], v[116:119], a[68:71], v[92:95]
    ds_read_b128 v[136:139], v96 offset:50176
    s_waitcnt vmcnt(15)
    s_waitcnt lgkmcnt(4)
    v_mfma_f32_16x16x32_bf16 v[56:59], v[120:123], a[72:75], v[56:59]
    v_mfma_f32_16x16x32_bf16 v[76:79], v[120:123], a[76:79], v[76:79]
    s_waitcnt lgkmcnt(3)
    v_mfma_f32_16x16x32_bf16 v[60:63], v[124:127], a[72:75], v[60:63]
    v_mfma_f32_16x16x32_bf16 v[80:83], v[124:127], a[76:79], v[80:83]
    s_waitcnt lgkmcnt(2)
    v_mfma_f32_16x16x32_bf16 v[64:67], v[128:131], a[72:75], v[64:67]
    v_mfma_f32_16x16x32_bf16 v[84:87], v[128:131], a[76:79], v[84:87]
    s_waitcnt lgkmcnt(1)
    v_mfma_f32_16x16x32_bf16 v[68:71], v[132:135], a[72:75], v[68:71]
    v_mfma_f32_16x16x32_bf16 v[88:91], v[132:135], a[76:79], v[88:91]
    s_waitcnt lgkmcnt(0)
    v_mfma_f32_16x16x32_bf16 v[72:75], v[136:139], a[72:75], v[72:75]
    v_mfma_f32_16x16x32_bf16 v[92:95], v[136:139], a[76:79], v[92:95]
    s_waitcnt vmcnt(13)
    s_mov_b64 exec, 0xffffffff
    v_cmp_ne_u32 vcc, s40, v9
    s_mov_b64 exec, -1
    s_cmp_lg_u64 vcc, 0
    s_cbranch_scc1 L_rare_81
L_back_82:
    s_barrier
    s_mul_i32 s66, s3, 5120
    s_add_u32 s66, s66, 143360
    v_add_u32 v1, s66, v220
    s_xor_b32 s67, s3, 2
    s_mul_i32 s67, s67, 5120
    s_add_u32 s67, s67, 143360
    v_add_u32 v2, s67, v220
    ds_write_b128 v1, v[76:79] offset:0
    ds_write_b128 v1, v[80:83] offset:1024
    ds_write_b128 v1, v[84:87] offset:2048
    ds_write_b128 v1, v[88:91] offset:3072
    ds_write_b128 v1, v[92:95] offset:4096
    s_and_b32 s66, s3, 1
    s_lshl_b32 s66, s66, 1
    s_lshr_b32 s67, s3, 1
    s_add_u32 s66, s66, s67
    s_lshl_b32 s67, s55, 2
    s_add_u32 s60, s66, s67
    s_mul_i32 s61, s56, 5
    s_add_u32 s62, s61, s57
    s_lshr_b32 s62, s62, 1
    s_and_b32 s63, s60, 7
    s_mul_i32 s63, s63, 20
    s_lshr_b32 s65, s60, 3
    s_mul_i32 s65, s65, 606208
    s_add_u32 s65, s65, 131072
    s_add_u32 s62, s62, s63
    s_lshl_b32 s62, s62, 10
    s_add_u32 s62, s62, s65
    s_add_u32 s68, s61, 4
    s_sub_u32 s69, s61, 1
    s_cmp_eq_u32 s57, 0
    s_cselect_b32 s68, s68, s69
    s_lshr_b32 s68, s68, 1
    s_add_u32 s68, s68, s63
    s_lshl_b32 s68, s68, 10
    s_lshl_b32 s69, s57, 3
    s_add_u32 s68, s68, s69
    s_add_u32 s63, s68, s65
    s_lshl_b32 s66, s60, 3
    s_add_u32 s66, s66, s56
    s_lshl_b32 s66, s66, 7
    s_add_u32 s61, s66, 14680064
    v_lshlrev_b32 v3, 3, v0
    s_waitcnt lgkmcnt(0)
    s_barrier
    ds_read_b128 v[100:103], v2 offset:0
    ds_read_b128 v[104:107], v2 offset:1024
    ds_read_b128 v[108:111], v2 offset:2048
    ds_read_b128 v[112:115], v2 offset:3072
    ds_read_b128 v[116:119], v2 offset:4096
    s_waitcnt lgkmcnt(4)
    v_pk_add_f32 v[56:57], v[56:57], v[100:101]
    v_pk_add_f32 v[58:59], v[58:59], v[102:103]
    s_waitcnt lgkmcnt(3)
    v_pk_add_f32 v[60:61], v[60:61], v[104:105]
    v_pk_add_f32 v[62:63], v[62:63], v[106:107]
    s_waitcnt lgkmcnt(2)
    v_pk_add_f32 v[64:65], v[64:65], v[108:109]
    v_pk_add_f32 v[66:67], v[66:67], v[110:111]
    s_waitcnt lgkmcnt(1)
    v_pk_add_f32 v[68:69], v[68:69], v[112:113]
    v_pk_add_f32 v[70:71], v[70:71], v[114:115]
    s_waitcnt lgkmcnt(0)
    v_pk_add_f32 v[72:73], v[72:73], v[116:117]
    v_pk_add_f32 v[74:75], v[74:75], v[118:119]
    v_cvt_pk_bf16_f32 v200, v56, v57
    v_cvt_pk_bf16_f32 v201, v58, v59
    v_cvt_pk_bf16_f32 v202, v60, v61
    v_cvt_pk_bf16_f32 v203, v62, v63
    v_cvt_pk_bf16_f32 v204, v64, v65
    v_cvt_pk_bf16_f32 v205, v66, v67
    v_cvt_pk_bf16_f32 v206, v68, v69
    v_cvt_pk_bf16_f32 v207, v70, v71
    v_cvt_pk_bf16_f32 v208, v72, v73
    v_cvt_pk_bf16_f32 v209, v74, v75
    s_cmp_eq_u32 s70, 0
    s_cbranch_scc1 L_alt_85
    buffer_store_dwordx4 v[200:203], v220, s[24:27], s62 offen
    buffer_store_dwordx4 v[204:207], v220, s[24:27], s62 offen offset:1024
    buffer_store_dwordx2 v[208:209], v220, s[24:27], s63 offen
L_join_86:
    v_pk_add_f32 v[4:5], v[56:57], v[58:59]
    v_pk_mul_f32 v[8:9], v[56:57], v[56:57]
    v_pk_add_f32 v[10:11], v[60:61], v[62:63]
    v_pk_mul_f32 v[12:13], v[58:59], v[58:59]
    v_pk_fma_f32 v[8:9], v[60:61], v[60:61], v[8:9]
    v_pk_fma_f32 v[12:13], v[62:63], v[62:63], v[12:13]
    v_pk_fma_f32 v[8:9], v[64:65], v[64:65], v[8:9]
    v_pk_add_f32 v[4:5], v[4:5], v[64:65]
    v_pk_fma_f32 v[12:13], v[66:67], v[66:67], v[12:13]
    v_pk_add_f32 v[10:11], v[10:11], v[66:67]
    v_pk_fma_f32 v[8:9], v[68:69], v[68:69], v[8:9]
    v_pk_add_f32 v[4:5], v[4:5], v[68:69]
    v_pk_fma_f32 v[12:13], v[70:71], v[70:71], v[12:13]
    v_pk_add_f32 v[10:11], v[10:11], v[70:71]
    v_pk_fma_f32 v[8:9], v[72:73], v[72:73], v[8:9]
    v_pk_add_f32 v[4:5], v[4:5], v[72:73]
    v_pk_fma_f32 v[12:13], v[74:75], v[74:75], v[12:13]
    v_pk_add_f32 v[10:11], v[10:11], v[74:75]
    v_pk_add_f32 v[4:5], v[4:5], v[10:11]
    v_pk_add_f32 v[8:9], v[8:9], v[12:13]
    v_add_f32 v4, v4, v5
    v_add_f32 v5, v8, v9
    v_mov_b32 v6, v4
    s_nop 1
    v_permlane16_swap_b32 v4, v6
    v_add_f32 v4, v4, v6
    v_mov_b32 v6, v4
    s_nop 1
    v_permlane32_swap_b32 v4, v6
    v_add_f32 v4, v4, v6
    v_mov_b32 v6, v5
    s_nop 1
    v_permlane16_swap_b32 v5, v6
    v_add_f32 v5, v5, v6
    v_mov_b32 v6, v5
    s_nop 1
    v_permlane32_swap_b32 v5, v6
    v_add_f32 v5, v5, v6
    s_cmp_eq_u32 s70, 0
    s_cbranch_scc1 L_alt_87
    s_mov_b64 exec, 0xffff
    buffer_store_dwordx2 v[4:5], v3, s[24:27], s61 offen
    s_mov_b64 exec, -1
L_join_88:
    s_mul_i32 s64, s3, 7168
    s_add_u32 s64, s64, 57344
    s_mul_i32 s65, s54, 143360
    s_add_u32 s65, s65, s64
    s_add_u32 s65, s65, 24117248
    s_add_u32 s69, s65, 0
    s_add_u32 m0, s64, 0
    s_nop 0
    buffer_load_dwordx4 v220, s[24:27], s69 offen offset:0 lds
    buffer_load_dwordx4 v220, s[24:27], s69 offen offset:1024 lds
    buffer_load_dwordx4 v220, s[24:27], s69 offen offset:2048 lds
    buffer_load_dwordx4 v220, s[24:27], s69 offen offset:3072 lds
    s_add_u32 s69, s65, 4096
    s_add_u32 m0, s64, 4096
    s_nop 0
    buffer_load_dwordx4 v220, s[24:27], s69 offen offset:0 lds
    buffer_load_dwordx4 v220, s[24:27], s69 offen offset:1024 lds
    buffer_load_dwordx4 v220, s[24:27], s69 offen offset:2048 lds
    s_waitcnt vmcnt(7)
    s_barrier
    s_cmp_eq_u32 s3, 0
    s_cbranch_scc0 L_pub_89
    s_cmp_eq_u32 s70, 0
    s_cbranch_scc1 L_alt_90
    s_lshl_b32 s42, s83, 6
    s_add_u32 s42, s42, 32768
    v_mov_b32 v1, 0
    v_mov_b32 v2, s40
    s_mov_b64 exec, 1
    buffer_store_dword v2, v1, s[24:27], s42 offen
    s_mov_b64 exec, -1
L_join_91:
L_pub_89:
    s_mul_i32 s66, s3, 7168
    s_add_u32 s66, s66, 86016
    v_add_u32 v1, s66, v220
    ds_write_b128 v1, a[80:83] offset:0
    ds_write_b128 v1, a[84:87] offset:1024
    ds_write_b128 v1, a[88:91] offset:2048
    ds_write_b128 v1, a[92:95] offset:3072
    ds_write_b128 v1, a[96:99] offset:4096
    ds_write_b128 v1, a[100:103] offset:5120
    ds_write_b128 v1, a[104:107] offset:6144
    ds_write_b128 v1, a[108:111] offset:28672
    ds_write_b128 v1, a[112:115] offset:29696
    ds_write_b128 v1, a[116:119] offset:30720
    ds_write_b128 v1, a[120:123] offset:31744
    ds_write_b128 v1, a[124:127] offset:32768
    ds_write_b128 v1, a[128:131] offset:33792
    ds_write_b128 v1, a[132:135] offset:34816
    s_waitcnt lgkmcnt(0)
    s_lshr_b32 s66, s53, 0
    s_lshl_b32 s66, s66, 10
    s_add_u32 s66, s66, 32768
    v_lshlrev_b32 v7, 6, v0
    v_add_u32 v7, s66, v7
    s_lshl_b32 s66, s54, 6
    s_add_u32 s66, s66, 65536
    v_mov_b32 v1, s66
    v_cmp_eq_u32 vcc, 16, v0
    s_nop 1
    v_cndmask_b32 v7, v7, v1, vcc
    v_mov_b32 v168, v220
    v_add_u32 v169, 64512, v220
    v_add_u32 v170, 129024, v220
    v_lshrrev_b32 v1, 4, v0
    v_lshlrev_b32 v1, 2, v1
    s_add_u32 s66, s58, s59
    s_lshl_b32 s66, s66, 4
    v_add_u32 v2, s66, v1
    s_cmp_lt_u32 s54, 12
    s_cselect_b32 s66, 6, 5
    s_cmp_eq_u32 s59, 0
    s_cselect_b32 s66, s66, 0
    s_add_u32 s66, s66, s58
    s_lshl_b32 s66, s66, 4
    v_add_u32 v3, s66, v1
    v_lshlrev_b32 v4, 1, v2
    v_lshlrev_b32 v5, 1, v3
    v_lshlrev_b32 v50, 2, v2
    v_lshlrev_b32 v51, 2, v3
    s_lshl_b32 s66, s53, 3
    s_lshl_b32 s67, s3, 1
    s_add_u32 s66, s66, s67
    s_mul_i32 s60, s67, 20480
    s_mul_i32 s68, s53, 606208
    s_add_u32 s60, s60, s68
    s_add_u32 s60, s60, 131072
    s_lshl_b32 s61, s66, 10
    s_add_u32 s61, s61, 14680064
    v_lshrrev_b32 v52, 4, v0
    v_lshlrev_b32 v52, 8, v52
    v_and_b32 v2, 15, v0
    v_lshl_add_u32 v52, v2, 3, v52
    s_cmp_eq_u32 s3, 0
    s_cbranch_scc0 L_polldone_94
    s_mov_b32 s42, 0
    s_mov_b64 exec, 0x1ffff
L_poll_92:
    buffer_load_dword v2, v7, s[24:27], 0 offen sc1
    s_add_u32 s42, s42, 1
    s_waitcnt vmcnt(0)
    v_cmp_ne_u32 vcc, s40, v2
    s_cmp_gt_u32 s42, 0x40000
    s_cbranch_scc1 L_got_93
    s_nop 1
    s_cbranch_vccnz L_poll_92
L_got_93:
    s_mov_b64 exec, -1
L_polldone_94:
    s_barrier
    s_add_u32 s63, s60, 20480
    buffer_load_dwordx4 a[0:3], v220, s[24:27], s60 offen offset:0 sc1
    buffer_load_dwordx4 a[4:7], v220, s[24:27], s63 offen offset:0 sc1
    buffer_load_dwordx4 a[8:11], v220, s[24:27], s60 offen offset:1024 sc1
    buffer_load_dwordx4 a[12:15], v220, s[24:27], s63 offen offset:1024 sc1
    buffer_load_dwordx4 a[16:19], v220, s[24:27], s60 offen offset:2048 sc1
    buffer_load_dwordx4 a[20:23], v220, s[24:27], s63 offen offset:2048 sc1
    ds_read_b128 v[112:115], v168 offset:0
    ds_read_b128 v[116:119], v168 offset:1024
    ds_read_b128 v[120:123], v168 offset:2048
    ds_read_b128 v[124:127], v168 offset:3072
    ds_read_b128 v[128:131], v168 offset:4096
    ds_read_b128 v[132:135], v168 offset:5120
    ds_read_b128 v[136:139], v168 offset:6144
    s_waitcnt vmcnt(4)
    s_waitcnt lgkmcnt(6)
    v_mfma_f32_16x16x32_bf16 v[56:59], v[112:115], a[0:3], 0
    v_mfma_f32_16x16x32_bf16 v[84:87], v[112:115], a[4:7], 0
    ds_read_b128 v[140:143], v168 offset:7168
    s_waitcnt lgkmcnt(6)
    v_mfma_f32_16x16x32_bf16 v[60:63], v[116:119], a[0:3], 0
    v_mfma_f32_16x16x32_bf16 v[88:91], v[116:119], a[4:7], 0
    ds_read_b128 v[144:147], v168 offset:8192
    buffer_load_dwordx4 a[24:27], v220, s[24:27], s60 offen offset:3072 sc1
    buffer_load_dwordx4 a[28:31], v220, s[24:27], s63 offen offset:3072 sc1
    s_waitcnt lgkmcnt(6)
    v_mfma_f32_16x16x32_bf16 v[64:67], v[120:123], a[0:3], 0
    v_mfma_f32_16x16x32_bf16 v[92:95], v[120:123], a[4:7], 0
    ds_read_b128 v[148:151], v168 offset:9216
    s_waitcnt lgkmcnt(6)
    v_mfma_f32_16x16x32_bf16 v[68:71], v[124:127], a[0:3], 0
    v_mfma_f32_16x16x32_bf16 v[96:99], v[124:127], a[4:7], 0
    ds_read_b128 v[152:155], v168 offset:10240
    s_waitcnt lgkmcnt(6)
    v_mfma_f32_16x16x32_bf16 v[72:75], v[128:131], a[0:3], 0
    v_mfma_f32_16x16x32_bf16 v[100:103], v[128:131], a[4:7], 0
    ds_read_b128 v[156:159], v168 offset:11264
    s_add_u32 s60, s60, 4096
    buffer_load_dwordx4 a[32:35], v220, s[24:27], s60 offen offset:0 sc1
    s_add_u32 s63, s63, 4096
    buffer_load_dwordx4 a[36:39], v220, s[24:27], s63 offen offset:0 sc1
    s_waitcnt lgkmcnt(6)
    v_mfma_f32_16x16x32_bf16 v[76:79], v[132:135], a[0:3], 0
    v_mfma_f32_16x16x32_bf16 v[104:107], v[132:135], a[4:7], 0
    ds_read_b128 v[160:163], v168 offset:12288
    s_waitcnt lgkmcnt(6)
    v_mfma_f32_16x16x32_bf16 v[80:83], v[136:139], a[0:3], 0
    v_mfma_f32_16x16x32_bf16 v[108:111], v[136:139], a[4:7], 0
    ds_read_b128 v[164:167], v168 offset:13312
    s_waitcnt vmcnt(6)
    s_waitcnt lgkmcnt(6)
    v_mfma_f32_16x16x32_bf16 v[56:59], v[140:143], a[8:11], v[56:59]
    v_mfma_f32_16x16x32_bf16 v[84:87], v[140:143], a[12:15], v[84:87]
    ds_read_b128 v[112:115], v168 offset:14336
    s_waitcnt lgkmcnt(6)
    v_mfma_f32_16x16x32_bf16 v[60:63], v[144:147], a[8:11], v[60:63]
    v_mfma_f32_16x16x32_bf16 v[88:91], v[144:147], a[12:15], v[88:91]
    ds_read_b128 v[116:119], v168 offset:15360
    buffer_load_dwordx4 a[40:43], v220, s[24:27], s60 offen offset:1024 sc1
    buffer_load_dwordx4 a[44:47], v220, s[24:27], s63 offen offset:1024 sc1
    s_waitcnt lgkmcnt(6)
    v_mfma_f32_16x16x32_bf16 v[64:67], v[148:151], a[8:11], v[64:67]
    v_mfma_f32_16x16x32_bf16 v[92:95], v[148:151], a[12:15], v[92:95]
    ds_read_b128 v[120:123], v168 offset:16384
    s_waitcnt lgkmcnt(6)
    v_mfma_f32_16x16x32_bf16 v[68:71], v[152:155], a[8:11], v[68:71]
    v_mfma_f32_16x16x32_bf16 v[96:99], v[152:155], a[12:15], v[96:99]
    ds_read_b128 v[124:127], v168 offset:17408
    s_waitcnt lgkmcnt(6)
    v_mfma_f32_16x16x32_bf16 v[72:75], v[156:159], a[8:11], v[72:75]
    v_mfma_f32_16x16x32_bf16 v[100:103], v[156:159], a[12:15], v[100:103]
    ds_read_b128 v[128:131], v168 offset:18432
    buffer_load_dwordx4 a[48:51], v220, s[24:27], s60 offen offset:2048 sc1
    buffer_load_dwordx4 a[52:55], v220, s[24:27], s63 offen offset:2048 sc1
    s_waitcnt lgkmcnt(6)
    v_mfma_f32_16x16x32_bf16 v[76:79], v[160:163], a[8:11], v[76:79]
    v_mfma_f32_16x16x32_bf16 v[104:107], v[160:163], a[12:15], v[104:107]
    ds_read_b128 v[132:135], v168 offset:19456
    s_waitcnt lgkmcnt(6)
    v_mfma_f32_16x16x32_bf16 v[80:83], v[164:167], a[8:11], v[80:83]
    v_mfma_f32_16x16x32_bf16 v[108:111], v[164:167], a[12:15], v[108:111]
    ds_read_b128 v[136:139], v168 offset:20480
    s_waitcnt vmcnt(8)
    s_waitcnt lgkmcnt(6)
    v_mfma_f32_16x16x32_bf16 v[56:59], v[112:115], a[16:19], v[56:59]
    v_mfma_f32_16x16x32_bf16 v[84:87], v[112:115], a[20:23], v[84:87]
    ds_read_b128 v[140:143], v168 offset:21504
    s_waitcnt lgkmcnt(6)
    v_mfma_f32_16x16x32_bf16 v[60:63], v[116:119], a[16:19], v[60:63]
    v_mfma_f32_16x16x32_bf16 v[88:91], v[116:119], a[20:23], v[88:91]
    ds_read_b128 v[144:147], v168 offset:22528
    buffer_load_dwordx4 a[56:59], v220, s[24:27], s60 offen offset:3072 sc1
    buffer_load_dwordx4 a[60:63], v220, s[24:27], s63 offen offset:3072 sc1
    s_waitcnt lgkmcnt(6)
    v_mfma_f32_16x16x32_bf16 v[64:67], v[120:123], a[16:19], v[64:67]
    v_mfma_f32_16x16x32_bf16 v[92:95], v[120:123], a[20:23], v[92:95]
    ds_read_b128 v[148:151], v168 offset:23552
    s_waitcnt lgkmcnt(6)
    v_mfma_f32_16x16x32_bf16 v[68:71], v[124:127], a[16:19], v[68:71]
    v_mfma_f32_16x16x32_bf16 v[96:99], v[124:127], a[20:23], v[96:99]
    ds_read_b128 v[152:155], v168 offset:24576
    s_waitcnt lgkmcnt(6)
    v_mfma_f32_16x16x32_bf16 v[72:75], v[128:131], a[16:19], v[72:75]
    v_mfma_f32_16x16x32_bf16 v[100:103], v[128:131], a[20:23], v[100:103]
    ds_read_b128 v[156:159], v168 offset:25600
    s_add_u32 s60, s60, 4096
    buffer_load_dwordx4 a[64:67], v220, s[24:27], s60 offen offset:0 sc1
    s_add_u32 s63, s63, 4096
    buffer_load_dwordx4 a[68:71], v220, s[24:27], s63 offen offset:0 sc1
    s_waitcnt lgkmcnt(6)
    v_mfma_f32_16x16x32_bf16 v[76:79], v[132:135], a[16:19], v[76:79]
    v_mfma_f32_16x16x32_bf16 v[104:107], v[132:135], a[20:23], v[104:107]
    ds_read_b128 v[160:163], v168 offset:26624
    s_waitcnt lgkmcnt(6)
    v_mfma_f32_16x16x32_bf16 v[80:83], v[136:139], a[16:19], v[80:83]
    v_mfma_f32_16x16x32_bf16 v[108:111], v[136:139], a[20:23], v[108:111]
    ds_read_b128 v[164:167], v168 offset:27648
    s_waitcnt vmcnt(10)
    s_waitcnt lgkmcnt(6)
    v_mfma_f32_16x16x32_bf16 v[56:59], v[140:143], a[24:27], v[56:59]
    v_mfma_f32_16x16x32_bf16 v[84:87], v[140:143], a[28:31], v[84:87]
    ds_read_b128 v[112:115], v168 offset:28672
    s_waitcnt lgkmcnt(6)
    v_mfma_f32_16x16x32_bf16 v[60:63], v[144:147], a[24:27], v[60:63]
    v_mfma_f32_16x16x32_bf16 v[88:91], v[144:147], a[28:31], v[88:91]
    ds_read_b128 v[116:119], v168 offset:29696
    buffer_load_dwordx4 a[72:75], v220, s[24:27], s60 offen offset:1024 sc1
    buffer_load_dwordx4 a[76:79], v220, s[24:27], s63 offen offset:1024 sc1
    s_waitcnt lgkmcnt(6)
    v_mfma_f32_16x16x32_bf16 v[64:67], v[148:151], a[24:27], v[64:67]
    v_mfma_f32_16x16x32_bf16 v[92:95], v[148:151], a[28:31], v[92:95]
    ds_read_b128 v[120:123], v168 offset:30720
    s_waitcnt lgkmcnt(6)
    v_mfma_f32_16x16x32_bf16 v[68:71], v[152:155], a[24:27], v[68:71]
    v_mfma_f32_16x16x32_bf16 v[96:99], v[152:155], a[28:31], v[96:99]
    ds_read_b128 v[124:127], v168 offset:31744
    s_waitcnt lgkmcnt(6)
    v_mfma_f32_16x16x32_bf16 v[72:75], v[156:159], a[24:27], v[72:75]
    v_mfma_f32_16x16x32_bf16 v[100:103], v[156:159], a[28:31], v[100:103]
    ds_read_b128 v[128:131], v168 offset:32768
    buffer_load_dwordx4 a[80:83], v220, s[24:27], s60 offen offset:2048 sc1
    buffer_load_dwordx4 a[84:87], v220, s[24:27], s63 offen offset:2048 sc1
    s_waitcnt lgkmcnt(6)
    v_mfma_f32_16x16x32_bf16 v[76:79], v[160:163], a[24:27], v[76:79]
    v_mfma_f32_16x16x32_bf16 v[104:107], v[160:163], a[28:31], v[104:107]
    ds_read_b128 v[132:135], v168 offset:33792
    s_waitcnt lgkmcnt(6)
    v_mfma_f32_16x16x32_bf16 v[80:83], v[164:167], a[24:27], v[80:83]
    v_mfma_f32_16x16x32_bf16 v[108:111], v[164:167], a[28:31], v[108:111]
    ds_read_b128 v[136:139], v168 offset:34816
    s_waitcnt vmcnt(12)
    s_waitcnt lgkmcnt(6)
    v_mfma_f32_16x16x32_bf16 v[56:59], v[112:115], a[32:35], v[56:59]
    v_mfma_f32_16x16x32_bf16 v[84:87], v[112:115], a[36:39], v[84:87]
    ds_read_b128 v[140:143], v168 offset:35840
    s_waitcnt lgkmcnt(6)
    v_mfma_f32_16x16x32_bf16 v[60:63], v[116:119], a[32:35], v[60:63]
    v_mfma_f32_16x16x32_bf16 v[88:91], v[116:119], a[36:39], v[88:91]
    ds_read_b128 v[144:147], v168 offset:36864
    buffer_load_dwordx4 a[88:91], v220, s[24:27], s60 offen offset:3072 sc1
    buffer_load_dwordx4 a[92:95], v220, s[24:27], s63 offen offset:3072 sc1
    s_waitcnt lgkmcnt(6)
    v_mfma_f32_16x16x32_bf16 v[64:67], v[120:123], a[32:35], v[64:67]
    v_mfma_f32_16x16x32_bf16 v[92:95], v[120:123], a[36:39], v[92:95]
    ds_read_b128 v[148:151], v168 offset:37888
    s_waitcnt lgkmcnt(6)
    v_mfma_f32_16x16x32_bf16 v[68:71], v[124:127], a[32:35], v[68:71]
    v_mfma_f32_16x16x32_bf16 v[96:99], v[124:127], a[36:39], v[96:99]
    ds_read_b128 v[152:155], v168 offset:38912
    s_waitcnt lgkmcnt(6)
    v_mfma_f32_16x16x32_bf16 v[72:75], v[128:131], a[32:35], v[72:75]
    v_mfma_f32_16x16x32_bf16 v[100:103], v[128:131], a[36:39], v[100:103]
    ds_read_b128 v[156:159], v168 offset:39936
    s_add_u32 s60, s60, 4096
    buffer_load_dwordx4 a[96:99], v220, s[24:27], s60 offen offset:0 sc1
    s_add_u32 s63, s63, 4096
    buffer_load_dwordx4 a[100:103], v220, s[24:27], s63 offen offset:0 sc1
    s_waitcnt lgkmcnt(6)
    v_mfma_f32_16x16x32_bf16 v[76:79], v[132:135], a[32:35], v[76:79]
    v_mfma_f32_16x16x32_bf16 v[104:107], v[132:135], a[36:39], v[104:107]
    ds_read_b128 v[160:163], v168 offset:40960
    s_waitcnt lgkmcnt(6)
    v_mfma_f32_16x16x32_bf16 v[80:83], v[136:139], a[32:35], v[80:83]
    v_mfma_f32_16x16x32_bf16 v[108:111], v[136:139], a[36:39], v[108:111]
    ds_read_b128 v[164:167], v168 offset:41984
    s_waitcnt vmcnt(14)
    s_waitcnt lgkmcnt(6)
    v_mfma_f32_16x16x32_bf16 v[56:59], v[140:143], a[40:43], v[56:59]
    v_mfma_f32_16x16x32_bf16 v[84:87], v[140:143], a[44:47], v[84:87]
    ds_read_b128 v[112:115], v168 offset:43008
    s_waitcnt lgkmcnt(6)
    v_mfma_f32_16x16x32_bf16 v[60:63], v[144:147], a[40:43], v[60:63]
    v_mfma_f32_16x16x32_bf16 v[88:91], v[144:147], a[44:47], v[88:91]
    ds_read_b128 v[116:119], v168 offset:44032
    buffer_load_dwordx4 a[104:107], v220, s[24:27], s60 offen offset:1024 sc1
    buffer_load_dwordx4 a[108:111], v220, s[24:27], s63 offen offset:1024 sc1
    s_waitcnt lgkmcnt(6)
    v_mfma_f32_16x16x32_bf16 v[64:67], v[148:151], a[40:43], v[64:67]
    v_mfma_f32_16x16x32_bf16 v[92:95], v[148:151], a[44:47], v[92:95]
    ds_read_b128 v[120:123], v168 offset:45056
    s_waitcnt lgkmcnt(6)
    v_mfma_f32_16x16x32_bf16 v[68:71], v[152:155], a[40:43], v[68:71]
    v_mfma_f32_16x16x32_bf16 v[96:99], v[152:155], a[44:47], v[96:99]
    ds_read_b128 v[124:127], v168 offset:46080
    s_waitcnt lgkmcnt(6)
    v_mfma_f32_16x16x32_bf16 v[72:75], v[156:159], a[40:43], v[72:75]
    v_mfma_f32_16x16x32_bf16 v[100:103], v[156:159], a[44:47], v[100:103]
    ds_read_b128 v[128:131], v168 offset:47104
    buffer_load_dwordx4 a[112:115], v220, s[24:27], s60 offen offset:2048 sc1
    buffer_load_dwordx4 a[116:119], v220, s[24:27], s63 offen offset:2048 sc1
    s_waitcnt lgkmcnt(6)
    v_mfma_f32_16x16x32_bf16 v[76:79], v[160:163], a[40:43], v[76:79]
    v_mfma_f32_16x16x32_bf16 v[104:107], v[160:163], a[44:47], v[104:107]
    ds_read_b128 v[132:135], v168 offset:48128
    s_waitcnt lgkmcnt(6)
    v_mfma_f32_16x16x32_bf16 v[80:83], v[164:167], a[40:43], v[80:83]
    v_mfma_f32_16x16x32_bf16 v[108:111], v[164:167], a[44:47], v[108:111]
    ds_read_b128 v[136:139], v168 offset:49152
    s_waitcnt vmcnt(16)
    s_waitcnt lgkmcnt(6)
    v_mfma_f32_16x16x32_bf16 v[56:59], v[112:115], a[48:51], v[56:59]
    v_mfma_f32_16x16x32_bf16 v[84:87], v[112:115], a[52:55], v[84:87]
    ds_read_b128 v[140:143], v168 offset:50176
    s_waitcnt lgkmcnt(6)
    v_mfma_f32_16x16x32_bf16 v[60:63], v[116:119], a[48:51], v[60:63]
    v_mfma_f32_16x16x32_bf16 v[88:91], v[116:119], a[52:55], v[88:91]
    ds_read_b128 v[144:147], v168 offset:51200
    buffer_load_dwordx4 a[120:123], v220, s[24:27], s60 offen offset:3072 sc1
    buffer_load_dwordx4 a[124:127], v220, s[24:27], s63 offen offset:3072 sc1
    s_waitcnt lgkmcnt(6)
    v_mfma_f32_16x16x32_bf16 v[64:67], v[120:123], a[48:51], v[64:67]
    v_mfma_f32_16x16x32_bf16 v[92:95], v[120:123], a[52:55], v[92:95]
    ds_read_b128 v[148:151], v168 offset:52224
    s_waitcnt lgkmcnt(6)
    v_mfma_f32_16x16x32_bf16 v[68:71], v[124:127], a[48:51], v[68:71]
    v_mfma_f32_16x16x32_bf16 v[96:99], v[124:127], a[52:55], v[96:99]
    ds_read_b128 v[152:155], v168 offset:53248
    s_waitcnt lgkmcnt(6)
    v_mfma_f32_16x16x32_bf16 v[72:75], v[128:131], a[48:51], v[72:75]
    v_mfma_f32_16x16x32_bf16 v[100:103], v[128:131], a[52:55], v[100:103]
    ds_read_b128 v[156:159], v168 offset:54272
    s_add_u32 s60, s60, 4096
    buffer_load_dwordx4 a[128:131], v220, s[24:27], s60 offen offset:0 sc1
    s_add_u32 s63, s63, 4096
    buffer_load_dwordx4 a[132:135], v220, s[24:27], s63 offen offset:0 sc1
    s_waitcnt lgkmcnt(6)
    v_mfma_f32_16x16x32_bf16 v[76:79], v[132:135], a[48:51], v[76:79]
    v_mfma_f32_16x16x32_bf16 v[104:107], v[132:135], a[52:55], v[104:107]
    ds_read_b128 v[160:163], v168 offset:55296
    s_waitcnt lgkmcnt(6)
    v_mfma_f32_16x16x32_bf16 v[80:83], v[136:139], a[48:51], v[80:83]
    v_mfma_f32_16x16x32_bf16 v[108:111], v[136:139], a[52:55], v[108:111]
    ds_read_b128 v[164:167], v168 offset:56320
    s_barrier
    s_waitcnt vmcnt(18)
    s_waitcnt lgkmcnt(6)
    v_mfma_f32_16x16x32_bf16 v[56:59], v[140:143], a[56:59], v[56:59]
    v_mfma_f32_16x16x32_bf16 v[84:87], v[140:143], a[60:63], v[84:87]
    ds_read_b128 v[112:115], v168 offset:57344
    s_waitcnt lgkmcnt(6)
    v_mfma_f32_16x16x32_bf16 v[60:63], v[144:147], a[56:59], v[60:63]
    v_mfma_f32_16x16x32_bf16 v[88:91], v[144:147], a[60:63], v[88:91]
    ds_read_b128 v[116:119], v168 offset:58368
    buffer_load_dwordx4 a[136:139], v220, s[24:27], s60 offen offset:1024 sc1
    buffer_load_dwordx4 a[140:143], v220, s[24:27], s63 offen offset:1024 sc1
    s_waitcnt lgkmcnt(6)
    v_mfma_f32_16x16x32_bf16 v[64:67], v[148:151], a[56:59], v[64:67]
    v_mfma_f32_16x16x32_bf16 v[92:95], v[148:151], a[60:63], v[92:95]
    ds_read_b128 v[120:123], v168 offset:59392
    s_waitcnt lgkmcnt(6)
    v_mfma_f32_16x16x32_bf16 v[68:71], v[152:155], a[56:59], v[68:71]
    v_mfma_f32_16x16x32_bf16 v[96:99], v[152:155], a[60:63], v[96:99]
    ds_read_b128 v[124:127], v168 offset:60416
    s_waitcnt lgkmcnt(6)
    v_mfma_f32_16x16x32_bf16 v[72:75], v[156:159], a[56:59], v[72:75]
    v_mfma_f32_16x16x32_bf16 v[100:103], v[156:159], a[60:63], v[100:103]
    ds_read_b128 v[128:131], v168 offset:61440
    s_waitcnt lgkmcnt(6)
    v_mfma_f32_16x16x32_bf16 v[76:79], v[160:163], a[56:59], v[76:79]
    v_mfma_f32_16x16x32_bf16 v[104:107], v[160:163], a[60:63], v[104:107]
    ds_read_b128 v[132:135], v168 offset:62464
    s_waitcnt lgkmcnt(6)
    v_mfma_f32_16x16x32_bf16 v[80:83], v[164:167], a[56:59], v[80:83]
    v_mfma_f32_16x16x32_bf16 v[108:111], v[164:167], a[60:63], v[108:111]
    ds_read_b128 v[136:139], v168 offset:63488
    s_waitcnt vmcnt(18)
    s_waitcnt lgkmcnt(6)
    v_mfma_f32_16x16x32_bf16 v[56:59], v[112:115], a[64:67], v[56:59]
    v_mfma_f32_16x16x32_bf16 v[84:87], v[112:115], a[68:71], v[84:87]
    ds_read_b128 v[140:143], v169 offset:0
    s_waitcnt lgkmcnt(6)
    v_mfma_f32_16x16x32_bf16 v[60:63], v[116:119], a[64:67], v[60:63]
    v_mfma_f32_16x16x32_bf16 v[88:91], v[116:119], a[68:71], v[88:91]
    ds_read_b128 v[144:147], v169 offset:1024
    buffer_load_dwordx4 a[144:147], v220, s[24:27], s60 offen offset:2048 sc1
    buffer_load_dwordx4 a[148:151], v220, s[24:27], s63 offen offset:2048 sc1
    s_waitcnt lgkmcnt(6)
    v_mfma_f32_16x16x32_bf16 v[64:67], v[120:123], a[64:67], v[64:67]
    v_mfma_f32_16x16x32_bf16 v[92:95], v[120:123], a[68:71], v[92:95]
    ds_read_b128 v[148:151], v169 offset:2048
    s_waitcnt lgkmcnt(6)
    v_mfma_f32_16x16x32_bf16 v[68:71], v[124:127], a[64:67], v[68:71]
    v_mfma_f32_16x16x32_bf16 v[96:99], v[124:127], a[68:71], v[96:99]
    ds_read_b128 v[152:155], v169 offset:3072
    s_waitcnt lgkmcnt(6)
    v_mfma_f32_16x16x32_bf16 v[72:75], v[128:131], a[64:67], v[72:75]
    v_mfma_f32_16x16x32_bf16 v[100:103], v[128:131], a[68:71], v[100:103]
    ds_read_b128 v[156:159], v169 offset:4096
    s_waitcnt lgkmcnt(6)
    v_mfma_f32_16x16x32_bf16 v[76:79], v[132:135], a[64:67], v[76:79]
    v_mfma_f32_16x16x32_bf16 v[104:107], v[132:135], a[68:71], v[104:107]
    ds_read_b128 v[160:163], v169 offset:5120
    s_waitcnt lgkmcnt(6)
    v_mfma_f32_16x16x32_bf16 v[80:83], v[136:139], a[64:67], v[80:83]
    v_mfma_f32_16x16x32_bf16 v[108:111], v[136:139], a[68:71], v[108:111]
    ds_read_b128 v[164:167], v169 offset:6144
    s_waitcnt vmcnt(18)
    s_waitcnt lgkmcnt(6)
    v_mfma_f32_16x16x32_bf16 v[56:59], v[140:143], a[72:75], v[56:59]
    v_mfma_f32_16x16x32_bf16 v[84:87], v[140:143], a[76:79], v[84:87]
    ds_read_b128 v[112:115], v169 offset:7168
    s_waitcnt lgkmcnt(6)
    v_mfma_f32_16x16x32_bf16 v[60:63], v[144:147], a[72:75], v[60:63]
    v_mfma_f32_16x16x32_bf16 v[88:91], v[144:147], a[76:79], v[88:91]
    ds_read_b128 v[116:119], v169 offset:8192
    buffer_load_dwordx4 a[152:155], v220, s[24:27], s60 offen offset:3072 sc1
    buffer_load_dwordx4 a[156:159], v220, s[24:27], s63 offen offset:3072 sc1
    s_waitcnt lgkmcnt(6)
    v_mfma_f32_16x16x32_bf16 v[64:67], v[148:151], a[72:75], v[64:67]
    v_mfma_f32_16x16x32_bf16 v[92:95], v[148:151], a[76:79], v[92:95]
    ds_read_b128 v[120:123], v169 offset:9216
    s_waitcnt lgkmcnt(6)
    v_mfma_f32_16x16x32_bf16 v[68:71], v[152:155], a[72:75], v[68:71]
    v_mfma_f32_16x16x32_bf16 v[96:99], v[152:155], a[76:79], v[96:99]
    ds_read_b128 v[124:127], v169 offset:10240
    s_waitcnt lgkmcnt(6)
    v_mfma_f32_16x16x32_bf16 v[72:75], v[156:159], a[72:75], v[72:75]
    v_mfma_f32_16x16x32_bf16 v[100:103], v[156:159], a[76:79], v[100:103]
    ds_read_b128 v[128:131], v169 offset:11264
    s_waitcnt lgkmcnt(6)
    v_mfma_f32_16x16x32_bf16 v[76:79], v[160:163], a[72:75], v[76:79]
    v_mfma_f32_16x16x32_bf16 v[104:107], v[160:163], a[76:79], v[104:107]
    ds_read_b128 v[132:135], v169 offset:12288
    s_waitcnt lgkmcnt(6)
    v_mfma_f32_16x16x32_bf16 v[80:83], v[164:167], a[72:75], v[80:83]
    v_mfma_f32_16x16x32_bf16 v[108:111], v[164:167], a[76:79], v[108:111]
    ds_read_b128 v[136:139], v169 offset:13312
    s_waitcnt vmcnt(18)
    s_waitcnt lgkmcnt(6)
    v_mfma_f32_16x16x32_bf16 v[56:59], v[112:115], a[80:83], v[56:59]
    v_mfma_f32_16x16x32_bf16 v[84:87], v[112:115], a[84:87], v[84:87]
    ds_read_b128 v[140:143], v169 offset:14336
    s_waitcnt lgkmcnt(6)
    v_mfma_f32_16x16x32_bf16 v[60:63], v[116:119], a[80:83], v[60:63]
    v_mfma_f32_16x16x32_bf16 v[88:91], v[116:119], a[84:87], v[88:91]
    ds_read_b128 v[144:147], v169 offset:15360
    s_waitcnt lgkmcnt(6)
    v_mfma_f32_16x16x32_bf16 v[64:67], v[120:123], a[80:83], v[64:67]
    v_mfma_f32_16x16x32_bf16 v[92:95], v[120:123], a[84:87], v[92:95]
    ds_read_b128 v[148:151], v169 offset:16384
    s_waitcnt lgkmcnt(6)
    v_mfma_f32_16x16x32_bf16 v[68:71], v[124:127], a[80:83], v[68:71]
    v_mfma_f32_16x16x32_bf16 v[96:99], v[124:127], a[84:87], v[96:99]
    ds_read_b128 v[152:155], v169 offset:17408
    s_waitcnt lgkmcnt(6)
    v_mfma_f32_16x16x32_bf16 v[72:75], v[128:131], a[80:83], v[72:75]
    v_mfma_f32_16x16x32_bf16 v[100:103], v[128:131], a[84:87], v[100:103]
    ds_read_b128 v[156:159], v169 offset:18432
    s_waitcnt lgkmcnt(6)
    v_mfma_f32_16x16x32_bf16 v[76:79], v[132:135], a[80:83], v[76:79]
    v_mfma_f32_16x16x32_bf16 v[104:107], v[132:135], a[84:87], v[104:107]
    ds_read_b128 v[160:163], v169 offset:19456
    s_waitcnt lgkmcnt(6)
    v_mfma_f32_16x16x32_bf16 v[80:83], v[136:139], a[80:83], v[80:83]
    v_mfma_f32_16x16x32_bf16 v[108:111], v[136:139], a[84:87], v[108:111]
    ds_read_b128 v[164:167], v169 offset:20480
    buffer_load_dwordx2 v[176:177], v52, s[24:27], s61 offen offset:0 sc1
    buffer_load_dwordx2 v[178:179], v52, s[24:27], s61 offen offset:128 sc1
    buffer_load_dwordx2 v[180:181], v52, s[24:27], s61 offen offset:1024 sc1
    buffer_load_dwordx2 v[182:183], v52, s[24:27], s61 offen offset:1152 sc1
    s_mov_b32 s62, 14942208
    buffer_load_dwordx4 v[8:11], v50, s[24:27], s62 offen offset:0 sc1
    buffer_load_dwordx4 v[12:15], v50, s[24:27], s62 offen offset:64 sc1
    buffer_load_dwordx4 v[16:19], v50, s[24:27], s62 offen offset:128 sc1
    buffer_load_dwordx4 v[20:23], v50, s[24:27], s62 offen offset:192 sc1
    buffer_load_dwordx4 v[24:27], v50, s[24:27], s62 offen offset:256 sc1
    buffer_load_dwordx4 v[28:31], v50, s[24:27], s62 offen offset:320 sc1
    buffer_load_dwordx4 v[32:35], v51, s[24:27], s62 offen sc1
    s_waitcnt vmcnt(27)
    s_waitcnt lgkmcnt(6)
    v_mfma_f32_16x16x32_bf16 v[56:59], v[140:143], a[88:91], v[56:59]
    v_mfma_f32_16x16x32_bf16 v[84:87], v[140:143], a[92:95], v[84:87]
    ds_read_b128 v[112:115], v169 offset:21504
    s_lshr_b32 s66, s3, 1
    s_and_b32 s67, s3, 1
    s_mul_i32 s81, s66, 81920
    s_mul_i32 s68, s67, 5120
    s_add_u32 s81, s81, s68
    s_mul_i32 s82, s66, 138240
    s_add_u32 s82, s82, s68
    s_mul_i32 s68, s56, 276480
    s_add_u32 s82, s82, s68
    s_add_u32 s82, s82, 27262976
    s_add_u32 s66, s82, 0
    buffer_load_dwordx4 a[160:163], v220, s[24:27], s66 offen offset:0
    s_waitcnt lgkmcnt(6)
    v_mfma_f32_16x16x32_bf16 v[60:63], v[144:147], a[88:91], v[60:63]
    v_mfma_f32_16x16x32_bf16 v[88:91], v[144:147], a[92:95], v[88:91]
    ds_read_b128 v[116:119], v169 offset:22528
    s_waitcnt lgkmcnt(6)
    v_mfma_f32_16x16x32_bf16 v[64:67], v[148:151], a[88:91], v[64:67]
    v_mfma_f32_16x16x32_bf16 v[92:95], v[148:151], a[92:95], v[92:95]
    ds_read_b128 v[120:123], v169 offset:23552
    s_waitcnt lgkmcnt(6)
    v_mfma_f32_16x16x32_bf16 v[68:71], v[152:155], a[88:91], v[68:71]
    v_mfma_f32_16x16x32_bf16 v[96:99], v[152:155], a[92:95], v[96:99]
    ds_read_b128 v[124:127], v169 offset:24576
    buffer_load_dwordx4 a[164:167], v220, s[24:27], s66 offen offset:1024
    s_waitcnt lgkmcnt(6)
    v_mfma_f32_16x16x32_bf16 v[72:75], v[156:159], a[88:91], v[72:75]
    v_mfma_f32_16x16x32_bf16 v[100:103], v[156:159], a[92:95], v[100:103]
    ds_read_b128 v[128:131], v169 offset:25600
    s_waitcnt lgkmcnt(6)
    v_mfma_f32_16x16x32_bf16 v[76:79], v[160:163], a[88:91], v[76:79]
    v_mfma_f32_16x16x32_bf16 v[104:107], v[160:163], a[92:95], v[104:107]
    ds_read_b128 v[132:135], v169 offset:26624
    s_waitcnt lgkmcnt(6)
    v_mfma_f32_16x16x32_bf16 v[80:83], v[164:167], a[88:91], v[80:83]
    v_mfma_f32_16x16x32_bf16 v[108:111], v[164:167], a[92:95], v[108:111]
    ds_read_b128 v[136:139], v169 offset:27648
    s_waitcnt vmcnt(27)
    s_waitcnt lgkmcnt(6)
    v_mfma_f32_16x16x32_bf16 v[56:59], v[112:115], a[96:99], v[56:59]
    v_mfma_f32_16x16x32_bf16 v[84:87], v[112:115], a[100:103], v[84:87]
    ds_read_b128 v[140:143], v169 offset:28672
    buffer_load_dwordx4 a[168:171], v220, s[24:27], s66 offen offset:2048
    s_waitcnt lgkmcnt(6)
    v_mfma_f32_16x16x32_bf16 v[60:63], v[116:119], a[96:99], v[60:63]
    v_mfma_f32_16x16x32_bf16 v[88:91], v[116:119], a[100:103], v[88:91]
    ds_read_b128 v[144:147], v169 offset:29696
    s_waitcnt lgkmcnt(6)
    v_mfma_f32_16x16x32_bf16 v[64:67], v[120:123], a[96:99], v[64:67]
    v_mfma_f32_16x16x32_bf16 v[92:95], v[120:123], a[100:103], v[92:95]
    ds_read_b128 v[148:151], v169 offset:30720
    s_waitcnt lgkmcnt(6)
    v_mfma_f32_16x16x32_bf16 v[68:71], v[124:127], a[96:99], v[68:71]
    v_mfma_f32_16x16x32_bf16 v[96:99], v[124:127], a[100:103], v[96:99]
    ds_read_b128 v[152:155], v169 offset:31744
    buffer_load_dwordx4 a[172:175], v220, s[24:27], s66 offen offset:3072
    s_waitcnt lgkmcnt(6)
    v_mfma_f32_16x16x32_bf16 v[72:75], v[128:131], a[96:99], v[72:75]
    v_mfma_f32_16x16x32_bf16 v[100:103], v[128:131], a[100:103], v[100:103]
    ds_read_b128 v[156:159], v169 offset:32768
    s_waitcnt lgkmcnt(6)
    v_mfma_f32_16x16x32_bf16 v[76:79], v[132:135], a[96:99], v[76:79]
    v_mfma_f32_16x16x32_bf16 v[104:107], v[132:135], a[100:103], v[104:107]
    ds_read_b128 v[160:163], v169 offset:33792
    s_waitcnt lgkmcnt(6)
    v_mfma_f32_16x16x32_bf16 v[80:83], v[136:139], a[96:99], v[80:83]
    v_mfma_f32_16x16x32_bf16 v[108:111], v[136:139], a[100:103], v[108:111]
    ds_read_b128 v[164:167], v169 offset:34816
    s_waitcnt vmcnt(27)
    s_waitcnt lgkmcnt(6)
    v_mfma_f32_16x16x32_bf16 v[56:59], v[140:143], a[104:107], v[56:59]
    v_mfma_f32_16x16x32_bf16 v[84:87], v[140:143], a[108:111], v[84:87]
    ds_read_b128 v[112:115], v169 offset:35840
    s_add_u32 s66, s82, 4096
    buffer_load_dwordx4 a[176:179], v220, s[24:27], s66 offen offset:0
    s_waitcnt lgkmcnt(6)
    v_mfma_f32_16x16x32_bf16 v[60:63], v[144:147], a[104:107], v[60:63]
    v_mfma_f32_16x16x32_bf16 v[88:91], v[144:147], a[108:111], v[88:91]
    ds_read_b128 v[116:119], v169 offset:36864
    s_waitcnt lgkmcnt(6)
    v_mfma_f32_16x16x32_bf16 v[64:67], v[148:151], a[104:107], v[64:67]
    v_mfma_f32_16x16x32_bf16 v[92:95], v[148:151], a[108:111], v[92:95]
    ds_read_b128 v[120:123], v169 offset:37888
    s_waitcnt lgkmcnt(6)
    v_mfma_f32_16x16x32_bf16 v[68:71], v[152:155], a[104:107], v[68:71]
    v_mfma_f32_16x16x32_bf16 v[96:99], v[152:155], a[108:111], v[96:99]
    ds_read_b128 v[124:127], v169 offset:38912
    s_add_u32 s66, s82, 10240
    buffer_load_dwordx4 a[180:183], v220, s[24:27], s66 offen offset:0
    s_waitcnt lgkmcnt(6)
    v_mfma_f32_16x16x32_bf16 v[72:75], v[156:159], a[104:107], v[72:75]
    v_mfma_f32_16x16x32_bf16 v[100:103], v[156:159], a[108:111], v[100:103]
    ds_read_b128 v[128:131], v169 offset:39936
    s_waitcnt lgkmcnt(6)
    v_mfma_f32_16x16x32_bf16 v[76:79], v[160:163], a[104:107], v[76:79]
    v_mfma_f32_16x16x32_bf16 v[104:107], v[160:163], a[108:111], v[104:107]
    ds_read_b128 v[132:135], v169 offset:40960
    s_waitcnt lgkmcnt(6)
    v_mfma_f32_16x16x32_bf16 v[80:83], v[164:167], a[104:107], v[80:83]
    v_mfma_f32_16x16x32_bf16 v[108:111], v[164:167], a[108:111], v[108:111]
    ds_read_b128 v[136:139], v169 offset:41984
    s_waitcnt vmcnt(27)
    s_waitcnt lgkmcnt(6)
    v_mfma_f32_16x16x32_bf16 v[56:59], v[112:115], a[112:115], v[56:59]
    v_mfma_f32_16x16x32_bf16 v[84:87], v[112:115], a[116:119], v[84:87]
    ds_read_b128 v[140:143], v169 offset:43008
    buffer_load_dwordx4 a[184:187], v220, s[24:27], s66 offen offset:1024
    s_waitcnt lgkmcnt(6)
    v_mfma_f32_16x16x32_bf16 v[60:63], v[116:119], a[112:115], v[60:63]
    v_mfma_f32_16x16x32_bf16 v[88:91], v[116:119], a[116:119], v[88:91]
    ds_read_b128 v[144:147], v169 offset:44032
    s_waitcnt lgkmcnt(6)
    v_mfma_f32_16x16x32_bf16 v[64:67], v[120:123], a[112:115], v[64:67]
    v_mfma_f32_16x16x32_bf16 v[92:95], v[120:123], a[116:119], v[92:95]
    ds_read_b128 v[148:151], v169 offset:45056
    s_waitcnt lgkmcnt(6)
    v_mfma_f32_16x16x32_bf16 v[68:71], v[124:127], a[112:115], v[68:71]
    v_mfma_f32_16x16x32_bf16 v[96:99], v[124:127], a[116:119], v[96:99]
    ds_read_b128 v[152:155], v169 offset:46080
    buffer_load_dwordx4 a[188:191], v220, s[24:27], s66 offen offset:2048
    s_waitcnt lgkmcnt(6)
    v_mfma_f32_16x16x32_bf16 v[72:75], v[128:131], a[112:115], v[72:75]
    v_mfma_f32_16x16x32_bf16 v[100:103], v[128:131], a[116:119], v[100:103]
    ds_read_b128 v[156:159], v169 offset:47104
    s_waitcnt lgkmcnt(6)
    v_mfma_f32_16x16x32_bf16 v[76:79], v[132:135], a[112:115], v[76:79]
    v_mfma_f32_16x16x32_bf16 v[104:107], v[132:135], a[116:119], v[104:107]
    ds_read_b128 v[160:163], v169 offset:48128
    s_waitcnt lgkmcnt(6)
    v_mfma_f32_16x16x32_bf16 v[80:83], v[136:139], a[112:115], v[80:83]
    v_mfma_f32_16x16x32_bf16 v[108:111], v[136:139], a[116:119], v[108:111]
    ds_read_b128 v[164:167], v169 offset:49152
    s_waitcnt vmcnt(27)
    s_waitcnt lgkmcnt(6)
    v_mfma_f32_16x16x32_bf16 v[56:59], v[140:143], a[120:123], v[56:59]
    v_mfma_f32_16x16x32_bf16 v[84:87], v[140:143], a[124:127], v[84:87]
    ds_read_b128 v[112:115], v169 offset:50176
    buffer_load_dwordx4 a[192:195], v220, s[24:27], s66 offen offset:3072
    s_waitcnt lgkmcnt(6)
    v_mfma_f32_16x16x32_bf16 v[60:63], v[144:147], a[120:123], v[60:63]
    v_mfma_f32_16x16x32_bf16 v[88:91], v[144:147], a[124:127], v[88:91]
    ds_read_b128 v[116:119], v169 offset:51200
    s_waitcnt lgkmcnt(6)
    v_mfma_f32_16x16x32_bf16 v[64:67], v[148:151], a[120:123], v[64:67]
    v_mfma_f32_16x16x32_bf16 v[92:95], v[148:151], a[124:127], v[92:95]
    ds_read_b128 v[120:123], v169 offset:52224
    s_waitcnt lgkmcnt(6)
    v_mfma_f32_16x16x32_bf16 v[68:71], v[152:155], a[120:123], v[68:71]
    v_mfma_f32_16x16x32_bf16 v[96:99], v[152:155], a[124:127], v[96:99]
    ds_read_b128 v[124:127], v169 offset:53248
    s_add_u32 s66, s82, 14336
    buffer_load_dwordx4 a[196:199], v220, s[24:27], s66 offen offset:0
    s_waitcnt lgkmcnt(6)
    v_mfma_f32_16x16x32_bf16 v[72:75], v[156:159], a[120:123], v[72:75]
    v_mfma_f32_16x16x32_bf16 v[100:103], v[156:159], a[124:127], v[100:103]
    ds_read_b128 v[128:131], v169 offset:54272
    s_waitcnt lgkmcnt(6)
    v_mfma_f32_16x16x32_bf16 v[76:79], v[160:163], a[120:123], v[76:79]
    v_mfma_f32_16x16x32_bf16 v[104:107], v[160:163], a[124:127], v[104:107]
    ds_read_b128 v[132:135], v169 offset:55296
    s_waitcnt lgkmcnt(6)
    v_mfma_f32_16x16x32_bf16 v[80:83], v[164:167], a[120:123], v[80:83]
    v_mfma_f32_16x16x32_bf16 v[108:111], v[164:167], a[124:127], v[108:111]
    ds_read_b128 v[136:139], v169 offset:56320
    s_waitcnt vmcnt(27)
    s_waitcnt lgkmcnt(6)
    v_mfma_f32_16x16x32_bf16 v[56:59], v[112:115], a[128:131], v[56:59]
    v_mfma_f32_16x16x32_bf16 v[84:87], v[112:115], a[132:135], v[84:87]
    ds_read_b128 v[140:143], v169 offset:57344
    s_add_u32 s66, s82, 20480
    buffer_load_dwordx4 a[200:203], v220, s[24:27], s66 offen offset:0
    s_waitcnt lgkmcnt(6)
    v_mfma_f32_16x16x32_bf16 v[60:63], v[116:119], a[128:131], v[60:63]
    v_mfma_f32_16x16x32_bf16 v[88:91], v[116:119], a[132:135], v[88:91]
    ds_read_b128 v[144:147], v169 offset:58368
    s_waitcnt lgkmcnt(6)
    v_mfma_f32_16x16x32_bf16 v[64:67], v[120:123], a[128:131], v[64:67]
    v_mfma_f32_16x16x32_bf16 v[92:95], v[120:123], a[132:135], v[92:95]
    ds_read_b128 v[148:151], v169 offset:59392
    s_waitcnt lgkmcnt(6)
    v_mfma_f32_16x16x32_bf16 v[68:71], v[124:127], a[128:131], v[68:71]
    v_mfma_f32_16x16x32_bf16 v[96:99], v[124:127], a[132:135], v[96:99]
    ds_read_b128 v[152:155], v169 offset:60416
    buffer_load_dwordx4 a[204:207], v220, s[24:27], s66 offen offset:1024
    s_waitcnt lgkmcnt(6)
    v_mfma_f32_16x16x32_bf16 v[72:75], v[128:131], a[128:131], v[72:75]
    v_mfma_f32_16x16x32_bf16 v[100:103], v[128:131], a[132:135], v[100:103]
    ds_read_b128 v[156:159], v169 offset:61440
    s_waitcnt lgkmcnt(6)
    v_mfma_f32_16x16x32_bf16 v[76:79], v[132:135], a[128:131], v[76:79]
    v_mfma_f32_16x16x32_bf16 v[104:107], v[132:135], a[132:135], v[104:107]
    ds_read_b128 v[160:163], v169 offset:62464
    s_waitcnt lgkmcnt(6)
    v_mfma_f32_16x16x32_bf16 v[80:83], v[136:139], a[128:131], v[80:83]
    v_mfma_f32_16x16x32_bf16 v[108:111], v[136:139], a[132:135], v[108:111]
    ds_read_b128 v[164:167], v169 offset:63488
    s_waitcnt vmcnt(27)
    s_waitcnt lgkmcnt(6)
    v_mfma_f32_16x16x32_bf16 v[56:59], v[140:143], a[136:139], v[56:59]
    v_mfma_f32_16x16x32_bf16 v[84:87], v[140:143], a[140:143], v[84:87]
    ds_read_b128 v[112:115], v170 offset:0
    buffer_load_dwordx4 a[208:211], v220, s[24:27], s66 offen offset:2048
    s_waitcnt lgkmcnt(6)
    v_mfma_f32_16x16x32_bf16 v[60:63], v[144:147], a[136:139], v[60:63]
    v_mfma_f32_16x16x32_bf16 v[88:91], v[144:147], a[140:143], v[88:91]
    ds_read_b128 v[116:119], v170 offset:1024
    s_waitcnt lgkmcnt(6)
    v_mfma_f32_16x16x32_bf16 v[64:67], v[148:151], a[136:139], v[64:67]
    v_mfma_f32_16x16x32_bf16 v[92:95], v[148:151], a[140:143], v[92:95]
    ds_read_b128 v[120:123], v170 offset:2048
    s_waitcnt lgkmcnt(6)
    v_mfma_f32_16x16x32_bf16 v[68:71], v[152:155], a[136:139], v[68:71]
    v_mfma_f32_16x16x32_bf16 v[96:99], v[152:155], a[140:143], v[96:99]
    ds_read_b128 v[124:127], v170 offset:3072
    buffer_load_dwordx4 a[212:215], v220, s[24:27], s66 offen offset:3072
    s_waitcnt lgkmcnt(6)
    v_mfma_f32_16x16x32_bf16 v[72:75], v[156:159], a[136:139], v[72:75]
    v_mfma_f32_16x16x32_bf16 v[100:103], v[156:159], a[140:143], v[100:103]
    ds_read_b128 v[128:131], v170 offset:4096
    s_waitcnt lgkmcnt(6)
    v_mfma_f32_16x16x32_bf16 v[76:79], v[160:163], a[136:139], v[76:79]
    v_mfma_f32_16x16x32_bf16 v[104:107], v[160:163], a[140:143], v[104:107]
    ds_read_b128 v[132:135], v170 offset:5120
    s_waitcnt lgkmcnt(6)
    v_mfma_f32_16x16x32_bf16 v[80:83], v[164:167], a[136:139], v[80:83]
    v_mfma_f32_16x16x32_bf16 v[108:111], v[164:167], a[140:143], v[108:111]
    ds_read_b128 v[136:139], v170 offset:6144
    s_waitcnt vmcnt(27)
    s_waitcnt lgkmcnt(6)
    v_mfma_f32_16x16x32_bf16 v[56:59], v[112:115], a[144:147], v[56:59]
    v_mfma_f32_16x16x32_bf16 v[84:87], v[112:115], a[148:151], v[84:87]
    ds_read_b128 v[140:143], v170 offset:7168
    s_add_u32 s66, s82, 24576
    buffer_load_dwordx4 a[0:3], v220, s[24:27], s66 offen offset:0
    s_waitcnt lgkmcnt(6)
    v_mfma_f32_16x16x32_bf16 v[60:63], v[116:119], a[144:147], v[60:63]
    v_mfma_f32_16x16x32_bf16 v[88:91], v[116:119], a[148:151], v[88:91]
    ds_read_b128 v[144:147], v170 offset:8192
    s_waitcnt lgkmcnt(6)
    v_mfma_f32_16x16x32_bf16 v[64:67], v[120:123], a[144:147], v[64:67]
    v_mfma_f32_16x16x32_bf16 v[92:95], v[120:123], a[148:151], v[92:95]
    ds_read_b128 v[148:151], v170 offset:9216
    s_waitcnt lgkmcnt(6)
    v_mfma_f32_16x16x32_bf16 v[68:71], v[124:127], a[144:147], v[68:71]
    v_mfma_f32_16x16x32_bf16 v[96:99], v[124:127], a[148:151], v[96:99]
    ds_read_b128 v[152:155], v170 offset:10240
    s_add_u32 s66, s82, 30720
    buffer_load_dwordx4 a[4:7], v220, s[24:27], s66 offen offset:0
    s_waitcnt lgkmcnt(6)
    v_mfma_f32_16x16x32_bf16 v[72:75], v[128:131], a[144:147], v[72:75]
    v_mfma_f32_16x16x32_bf16 v[100:103], v[128:131], a[148:151], v[100:103]
    ds_read_b128 v[156:159], v170 offset:11264
    s_waitcnt lgkmcnt(6)
    v_mfma_f32_16x16x32_bf16 v[76:79], v[132:135], a[144:147], v[76:79]
    v_mfma_f32_16x16x32_bf16 v[104:107], v[132:135], a[148:151], v[104:107]
    ds_read_b128 v[160:163], v170 offset:12288
    s_waitcnt lgkmcnt(6)
    v_mfma_f32_16x16x32_bf16 v[80:83], v[136:139], a[144:147], v[80:83]
    v_mfma_f32_16x16x32_bf16 v[108:111], v[136:139], a[148:151], v[108:111]
    ds_read_b128 v[164:167], v170 offset:13312
    s_waitcnt vmcnt(27)
    s_waitcnt lgkmcnt(6)
    v_mfma_f32_16x16x32_bf16 v[56:59], v[140:143], a[152:155], v[56:59]
    v_mfma_f32_16x16x32_bf16 v[84:87], v[140:143], a[156:159], v[84:87]
    buffer_load_dwordx4 a[8:11], v220, s[24:27], s66 offen offset:1024
    s_waitcnt lgkmcnt(5)
    v_mfma_f32_16x16x32_bf16 v[60:63], v[144:147], a[152:155], v[60:63]
    v_mfma_f32_16x16x32_bf16 v[88:91], v[144:147], a[156:159], v[88:91]
    s_waitcnt lgkmcnt(4)
    v_mfma_f32_16x16x32_bf16 v[64:67], v[148:151], a[152:155], v[64:67]
    v_mfma_f32_16x16x32_bf16 v[92:95], v[148:151], a[156:159], v[92:95]
    s_waitcnt lgkmcnt(3)
    v_mfma_f32_16x16x32_bf16 v[68:71], v[152:155], a[152:155], v[68:71]
    v_mfma_f32_16x16x32_bf16 v[96:99], v[152:155], a[156:159], v[96:99]
    buffer_load_dwordx4 a[12:15], v220, s[24:27], s66 offen offset:2048
    s_waitcnt lgkmcnt(2)
    v_mfma_f32_16x16x32_bf16 v[72:75], v[156:159], a[152:155], v[72:75]
    v_mfma_f32_16x16x32_bf16 v[100:103], v[156:159], a[156:159], v[100:103]
    s_waitcnt lgkmcnt(1)
    v_mfma_f32_16x16x32_bf16 v[76:79], v[160:163], a[152:155], v[76:79]
    v_mfma_f32_16x16x32_bf16 v[104:107], v[160:163], a[156:159], v[104:107]
    s_waitcnt lgkmcnt(0)
    v_mfma_f32_16x16x32_bf16 v[80:83], v[164:167], a[152:155], v[80:83]
    v_mfma_f32_16x16x32_bf16 v[108:111], v[164:167], a[156:159], v[108:111]
    s_barrier
    s_waitcnt vmcnt(18)
    v_accvgpr_read_b32 v36, a226
    v_accvgpr_read_b32 v37, a227
    v_accvgpr_read_b32 v38, a228
    v_accvgpr_read_b32 v39, a229
    v_accvgpr_read_b32 v40, a230
    v_accvgpr_read_b32 v41, a231
    v_accvgpr_read_b32 v42, a232
    v_accvgpr_read_b32 v43, a233
    v_accvgpr_read_b32 v44, a234
    v_accvgpr_read_b32 v45, a235
    v_accvgpr_read_b32 v46, a236
    v_accvgpr_read_b32 v47, a237
    v_accvgpr_read_b32 v48, a238
    v_accvgpr_read_b32 v49, a239
    v_lshlrev_b32 v112, 16, v36
    v_and_b32 v113, 0xffff0000, v36
    v_lshlrev_b32 v114, 16, v37
    v_and_b32 v115, 0xffff0000, v37
    v_lshlrev_b32 v116, 16, v38
    v_and_b32 v117, 0xffff0000, v38
    v_lshlrev_b32 v118, 16, v39
    v_and_b32 v119, 0xffff0000, v39
    v_lshlrev_b32 v120, 16, v40
    v_and_b32 v121, 0xffff0000, v40
    v_lshlrev_b32 v122, 16, v41
    v_and_b32 v123, 0xffff0000, v41
    v_lshlrev_b32 v124, 16, v42
    v_and_b32 v125, 0xffff0000, v42
    v_lshlrev_b32 v126, 16, v43
    v_and_b32 v127, 0xffff0000, v43
    v_lshlrev_b32 v128, 16, v44
    v_and_b32 v129, 0xffff0000, v44
    v_lshlrev_b32 v130, 16, v45
    v_and_b32 v131, 0xffff0000, v45
    v_lshlrev_b32 v132, 16, v46
    v_and_b32 v133, 0xffff0000, v46
    v_lshlrev_b32 v134, 16, v47
    v_and_b32 v135, 0xffff0000, v47
    v_lshlrev_b32 v136, 16, v48
    v_and_b32 v137, 0xffff0000, v48
    v_lshlrev_b32 v138, 16, v49
    v_and_b32 v139, 0xffff0000, v49
    v_add_f32 v2, v176, v178
    v_add_f32 v184, v177, v179
    v_mov_b32 v6, v2
    s_nop 1
    v_permlane16_swap_b32 v2, v6
    v_add_f32 v2, v2, v6
    v_mov_b32 v6, v2
    s_nop 1
    v_permlane32_swap_b32 v2, v6
    v_add_f32 v2, v2, v6
    v_mov_b32 v6, v184
    s_nop 1
    v_permlane16_swap_b32 v184, v6
    v_add_f32 v184, v184, v6
    v_mov_b32 v6, v184
    s_nop 1
    v_permlane32_swap_b32 v184, v6
    v_add_f32 v184, v184, v6
    v_mul_f32 v2, 0x3acccccd, v2
    v_mul_f32 v184, 0x3acccccd, v184
    v_fma_f32 v184, -v2, v2, v184
    v_max_f32 v184, 0, v184
    v_add_f32 v184, 0x3727c5ac, v184
    v_rsq_f32 v184, v184
    s_nop 0
    v_mul_f32 v2, v2, v184
    v_sub_f32 v2, 0, v2
    v_add_f32 v4, v180, v182
    v_add_f32 v186, v181, v183
    v_mov_b32 v6, v4
    s_nop 1
    v_permlane16_swap_b32 v4, v6
    v_add_f32 v4, v4, v6
    v_mov_b32 v6, v4
    s_nop 1
    v_permlane32_swap_b32 v4, v6
    v_add_f32 v4, v4, v6
    v_mov_b32 v6, v186
    s_nop 1
    v_permlane16_swap_b32 v186, v6
    v_add_f32 v186, v186, v6
    v_mov_b32 v6, v186
    s_nop 1
    v_permlane32_swap_b32 v186, v6
    v_add_f32 v186, v186, v6
    v_mul_f32 v4, 0x3acccccd, v4
    v_mul_f32 v186, 0x3acccccd, v186
    v_fma_f32 v186, -v4, v4, v186
    v_max_f32 v186, 0, v186
    v_add_f32 v186, 0x3727c5ac, v186
    v_rsq_f32 v186, v186
    s_nop 0
    v_mul_f32 v4, v4, v186
    v_sub_f32 v4, 0, v4
    buffer_load_dwordx4 a[16:19], v220, s[24:27], s66 offen offset:3072
    s_add_u32 s66, s82, 34816
    buffer_load_dwordx4 a[20:23], v220, s[24:27], s66 offen offset:0
    v_pk_fma_f32 v[188:189], v[8:9], v[2:3], v[112:113] op_sel_hi:[1,0,1]
    v_pk_fma_f32 v[190:191], v[10:11], v[2:3], v[114:115] op_sel_hi:[1,0,1]
    v_pk_fma_f32 v[192:193], v[8:9], v[4:5], v[112:113] op_sel_hi:[1,0,1]
    v_pk_fma_f32 v[194:195], v[10:11], v[4:5], v[114:115] op_sel_hi:[1,0,1]
    v_pk_fma_f32 v[56:57], v[56:57], v[184:185], v[188:189] op_sel_hi:[1,0,1]
    v_pk_fma_f32 v[58:59], v[58:59], v[184:185], v[190:191] op_sel_hi:[1,0,1]
    v_pk_fma_f32 v[84:85], v[84:85], v[186:187], v[192:193] op_sel_hi:[1,0,1]
    v_pk_fma_f32 v[86:87], v[86:87], v[186:187], v[194:195] op_sel_hi:[1,0,1]
    v_max_f32 v56, 0, v56
    v_max_f32 v57, 0, v57
    v_max_f32 v58, 0, v58
    v_max_f32 v59, 0, v59
    v_max_f32 v84, 0, v84
    v_max_f32 v85, 0, v85
    v_max_f32 v86, 0, v86
    v_max_f32 v87, 0, v87
    v_pk_mul_f32 v[56:57], v[56:57], v[56:57]
    v_pk_mul_f32 v[58:59], v[58:59], v[58:59]
    v_pk_mul_f32 v[84:85], v[84:85], v[84:85]
    v_pk_mul_f32 v[86:87], v[86:87], v[86:87]
    v_cvt_pk_bf16_f32 v140, v56, v57
    v_cvt_pk_bf16_f32 v141, v58, v59
    v_cvt_pk_bf16_f32 v154, v84, v85
    v_cvt_pk_bf16_f32 v155, v86, v87
    s_add_u32 s66, s82, 40960
    buffer_load_dwordx4 a[24:27], v220, s[24:27], s66 offen offset:0
    buffer_load_dwordx4 a[28:31], v220, s[24:27], s66 offen offset:1024
    v_pk_fma_f32 v[188:189], v[12:13], v[2:3], v[116:117] op_sel_hi:[1,0,1]
    v_pk_fma_f32 v[190:191], v[14:15], v[2:3], v[118:119] op_sel_hi:[1,0,1]
    v_pk_fma_f32 v[192:193], v[12:13], v[4:5], v[116:117] op_sel_hi:[1,0,1]
    v_pk_fma_f32 v[194:195], v[14:15], v[4:5], v[118:119] op_sel_hi:[1,0,1]
    v_pk_fma_f32 v[60:61], v[60:61], v[184:185], v[188:189] op_sel_hi:[1,0,1]
    v_pk_fma_f32 v[62:63], v[62:63], v[184:185], v[190:191] op_sel_hi:[1,0,1]
    v_pk_fma_f32 v[88:89], v[88:89], v[186:187], v[192:193] op_sel_hi:[1,0,1]
    v_pk_fma_f32 v[90:91], v[90:91], v[186:187], v[194:195] op_sel_hi:[1,0,1]
    v_max_f32 v60, 0, v60
    v_max_f32 v61, 0, v61
    v_max_f32 v62, 0, v62
    v_max_f32 v63, 0, v63
    v_max_f32 v88, 0, v88
    v_max_f32 v89, 0, v89
    v_max_f32 v90, 0, v90
    v_max_f32 v91, 0, v91
    v_pk_mul_f32 v[60:61], v[60:61], v[60:61]
    v_pk_mul_f32 v[62:63], v[62:63], v[62:63]
    v_pk_mul_f32 v[88:89], v[88:89], v[88:89]
    v_pk_mul_f32 v[90:91], v[90:91], v[90:91]
    v_cvt_pk_bf16_f32 v142, v60, v61
    v_cvt_pk_bf16_f32 v143, v62, v63
    v_cvt_pk_bf16_f32 v156, v88, v89
    v_cvt_pk_bf16_f32 v157, v90, v91
    buffer_load_dwordx4 a[32:35], v220, s[24:27], s66 offen offset:2048
    buffer_load_dwordx4 a[36:39], v220, s[24:27], s66 offen offset:3072
    v_pk_fma_f32 v[188:189], v[16:17], v[2:3], v[120:121] op_sel_hi:[1,0,1]
    v_pk_fma_f32 v[190:191], v[18:19], v[2:3], v[122:123] op_sel_hi:[1,0,1]
    v_pk_fma_f32 v[192:193], v[16:17], v[4:5], v[120:121] op_sel_hi:[1,0,1]
    v_pk_fma_f32 v[194:195], v[18:19], v[4:5], v[122:123] op_sel_hi:[1,0,1]
    v_pk_fma_f32 v[64:65], v[64:65], v[184:185], v[188:189] op_sel_hi:[1,0,1]
    v_pk_fma_f32 v[66:67], v[66:67], v[184:185], v[190:191] op_sel_hi:[1,0,1]
    v_pk_fma_f32 v[92:93], v[92:93], v[186:187], v[192:193] op_sel_hi:[1,0,1]
    v_pk_fma_f32 v[94:95], v[94:95], v[186:187], v[194:195] op_sel_hi:[1,0,1]
    v_max_f32 v64, 0, v64
    v_max_f32 v65, 0, v65
    v_max_f32 v66, 0, v66
    v_max_f32 v67, 0, v67
    v_max_f32 v92, 0, v92
    v_max_f32 v93, 0, v93
    v_max_f32 v94, 0, v94
    v_max_f32 v95, 0, v95
    v_pk_mul_f32 v[64:65], v[64:65], v[64:65]
    v_pk_mul_f32 v[66:67], v[66:67], v[66:67]
    v_pk_mul_f32 v[92:93], v[92:93], v[92:93]
    v_pk_mul_f32 v[94:95], v[94:95], v[94:95]
    v_cvt_pk_bf16_f32 v144, v64, v65
    v_cvt_pk_bf16_f32 v145, v66, v67
    v_cvt_pk_bf16_f32 v158, v92, v93
    v_cvt_pk_bf16_f32 v159, v94, v95
    s_add_u32 s66, s82, 45056
    buffer_load_dwordx4 a[40:43], v220, s[24:27], s66 offen offset:0
    s_add_u32 s66, s82, 51200
    buffer_load_dwordx4 a[44:47], v220, s[24:27], s66 offen offset:0
    v_pk_fma_f32 v[188:189], v[20:21], v[2:3], v[124:125] op_sel_hi:[1,0,1]
    v_pk_fma_f32 v[190:191], v[22:23], v[2:3], v[126:127] op_sel_hi:[1,0,1]
    v_pk_fma_f32 v[192:193], v[20:21], v[4:5], v[124:125] op_sel_hi:[1,0,1]
    v_pk_fma_f32 v[194:195], v[22:23], v[4:5], v[126:127] op_sel_hi:[1,0,1]
    v_pk_fma_f32 v[68:69], v[68:69], v[184:185], v[188:189] op_sel_hi:[1,0,1]
    v_pk_fma_f32 v[70:71], v[70:71], v[184:185], v[190:191] op_sel_hi:[1,0,1]
    v_pk_fma_f32 v[96:97], v[96:97], v[186:187], v[192:193] op_sel_hi:[1,0,1]
    v_pk_fma_f32 v[98:99], v[98:99], v[186:187], v[194:195] op_sel_hi:[1,0,1]
    v_max_f32 v68, 0, v68
    v_max_f32 v69, 0, v69
    v_max_f32 v70, 0, v70
    v_max_f32 v71, 0, v71
    v_max_f32 v96, 0, v96
    v_max_f32 v97, 0, v97
    v_max_f32 v98, 0, v98
    v_max_f32 v99, 0, v99
    v_pk_mul_f32 v[68:69], v[68:69], v[68:69]
    v_pk_mul_f32 v[70:71], v[70:71], v[70:71]
    v_pk_mul_f32 v[96:97], v[96:97], v[96:97]
    v_pk_mul_f32 v[98:99], v[98:99], v[98:99]
    v_cvt_pk_bf16_f32 v146, v68, v69
    v_cvt_pk_bf16_f32 v147, v70, v71
    v_cvt_pk_bf16_f32 v160, v96, v97
    v_cvt_pk_bf16_f32 v161, v98, v99
    buffer_load_dwordx4 a[48:51], v220, s[24:27], s66 offen offset:1024
    buffer_load_dwordx4 a[52:55], v220, s[24:27], s66 offen offset:2048
    v_pk_fma_f32 v[188:189], v[24:25], v[2:3], v[128:129] op_sel_hi:[1,0,1]
    v_pk_fma_f32 v[190:191], v[26:27], v[2:3], v[130:131] op_sel_hi:[1,0,1]
    v_pk_fma_f32 v[192:193], v[24:25], v[4:5], v[128:129] op_sel_hi:[1,0,1]
    v_pk_fma_f32 v[194:195], v[26:27], v[4:5], v[130:131] op_sel_hi:[1,0,1]
    v_pk_fma_f32 v[72:73], v[72:73], v[184:185], v[188:189] op_sel_hi:[1,0,1]
    v_pk_fma_f32 v[74:75], v[74:75], v[184:185], v[190:191] op_sel_hi:[1,0,1]
    v_pk_fma_f32 v[100:101], v[100:101], v[186:187], v[192:193] op_sel_hi:[1,0,1]
    v_pk_fma_f32 v[102:103], v[102:103], v[186:187], v[194:195] op_sel_hi:[1,0,1]
    v_max_f32 v72, 0, v72
    v_max_f32 v73, 0, v73
    v_max_f32 v74, 0, v74
    v_max_f32 v75, 0, v75
    v_max_f32 v100, 0, v100
    v_max_f32 v101, 0, v101
    v_max_f32 v102, 0, v102
    v_max_f32 v103, 0, v103
    v_pk_mul_f32 v[72:73], v[72:73], v[72:73]
    v_pk_mul_f32 v[74:75], v[74:75], v[74:75]
    v_pk_mul_f32 v[100:101], v[100:101], v[100:101]
    v_pk_mul_f32 v[102:103], v[102:103], v[102:103]
    v_cvt_pk_bf16_f32 v148, v72, v73
    v_cvt_pk_bf16_f32 v149, v74, v75
    v_cvt_pk_bf16_f32 v162, v100, v101
    v_cvt_pk_bf16_f32 v163, v102, v103
    buffer_load_dwordx4 a[56:59], v220, s[24:27], s66 offen offset:3072
    s_add_u32 s66, s82, 55296
    buffer_load_dwordx4 a[60:63], v220, s[24:27], s66 offen offset:0
    v_pk_fma_f32 v[188:189], v[28:29], v[2:3], v[132:133] op_sel_hi:[1,0,1]
    v_pk_fma_f32 v[190:191], v[30:31], v[2:3], v[134:135] op_sel_hi:[1,0,1]
    v_pk_fma_f32 v[192:193], v[28:29], v[4:5], v[132:133] op_sel_hi:[1,0,1]
    v_pk_fma_f32 v[194:195], v[30:31], v[4:5], v[134:135] op_sel_hi:[1,0,1]
    v_pk_fma_f32 v[76:77], v[76:77], v[184:185], v[188:189] op_sel_hi:[1,0,1]
    v_pk_fma_f32 v[78:79], v[78:79], v[184:185], v[190:191] op_sel_hi:[1,0,1]
    v_pk_fma_f32 v[104:105], v[104:105], v[186:187], v[192:193] op_sel_hi:[1,0,1]
    v_pk_fma_f32 v[106:107], v[106:107], v[186:187], v[194:195] op_sel_hi:[1,0,1]
    v_max_f32 v76, 0, v76
    v_max_f32 v77, 0, v77
    v_max_f32 v78, 0, v78
    v_max_f32 v79, 0, v79
    v_max_f32 v104, 0, v104
    v_max_f32 v105, 0, v105
    v_max_f32 v106, 0, v106
    v_max_f32 v107, 0, v107
    v_pk_mul_f32 v[76:77], v[76:77], v[76:77]
    v_pk_mul_f32 v[78:79], v[78:79], v[78:79]
    v_pk_mul_f32 v[104:105], v[104:105], v[104:105]
    v_pk_mul_f32 v[106:107], v[106:107], v[106:107]
    v_cvt_pk_bf16_f32 v150, v76, v77
    v_cvt_pk_bf16_f32 v151, v78, v79
    v_cvt_pk_bf16_f32 v164, v104, v105
    v_cvt_pk_bf16_f32 v165, v106, v107
    v_pk_fma_f32 v[188:189], v[32:33], v[2:3], v[136:137] op_sel_hi:[1,0,1]
    v_pk_fma_f32 v[190:191], v[34:35], v[2:3], v[138:139] op_sel_hi:[1,0,1]
    v_pk_fma_f32 v[192:193], v[32:33], v[4:5], v[136:137] op_sel_hi:[1,0,1]
    v_pk_fma_f32 v[194:195], v[34:35], v[4:5], v[138:139] op_sel_hi:[1,0,1]
    v_pk_fma_f32 v[80:81], v[80:81], v[184:185], v[188:189] op_sel_hi:[1,0,1]
    v_pk_fma_f32 v[82:83], v[82:83], v[184:185], v[190:191] op_sel_hi:[1,0,1]
    v_pk_fma_f32 v[108:109], v[108:109], v[186:187], v[192:193] op_sel_hi:[1,0,1]
    v_pk_fma_f32 v[110:111], v[110:111], v[186:187], v[194:195] op_sel_hi:[1,0,1]
    v_max_f32 v80, 0, v80
    v_max_f32 v81, 0, v81
    v_max_f32 v82, 0, v82
    v_max_f32 v83, 0, v83
    v_max_f32 v108, 0, v108
    v_max_f32 v109, 0, v109
    v_max_f32 v110, 0, v110
    v_max_f32 v111, 0, v111
    v_pk_mul_f32 v[80:81], v[80:81], v[80:81]
    v_pk_mul_f32 v[82:83], v[82:83], v[82:83]
    v_pk_mul_f32 v[108:109], v[108:109], v[108:109]
    v_pk_mul_f32 v[110:111], v[110:111], v[110:111]
    v_cvt_pk_bf16_f32 v152, v80, v81
    v_cvt_pk_bf16_f32 v153, v82, v83
    v_cvt_pk_bf16_f32 v166, v108, v109
    v_cvt_pk_bf16_f32 v167, v110, v111
    s_lshl_b32 s66, s3, 1
    s_mul_i32 s66, s66, 54
    s_mul_i32 s63, s53, 606208
    s_add_u32 s63, s63, 294912
    s_add_u32 s67, s58, s59
    s_lshr_b32 s67, s67, 1
    s_add_u32 s60, s66, s67
    s_lshl_b32 s60, s60, 10
    s_add_u32 s60, s60, s63
    s_add_u32 s67, s58, 6
    s_cmp_eq_u32 s59, 0
    s_cselect_b32 s67, s67, s58
    s_lshr_b32 s67, s67, 1
    s_add_u32 s61, s66, s67
    s_lshl_b32 s61, s61, 10
    s_lshl_b32 s67, s59, 3
    s_add_u32 s61, s61, s67
    s_add_u32 s61, s61, s63
    s_cmp_eq_u32 s70, 0
    s_cbranch_scc1 L_alt_95
    s_cmp_lt_u32 s54, 12
    s_cbranch_scc0 L_nohalf_97
    s_add_u32 s62, s61, 0
    buffer_store_dwordx2 v[152:153], v220, s[24:27], s62 offen
    s_add_u32 s62, s61, 55296
    buffer_store_dwordx2 v[166:167], v220, s[24:27], s62 offen
L_nohalf_97:
    s_add_u32 s62, s60, 0
    buffer_store_dwordx4 v[140:143], v220, s[24:27], s62 offen
    s_add_u32 s62, s60, 1024
    buffer_store_dwordx4 v[144:147], v220, s[24:27], s62 offen
    s_add_u32 s62, s60, 2048
    buffer_store_dwordx4 v[148:151], v220, s[24:27], s62 offen
    s_add_u32 s62, s60, 55296
    buffer_store_dwordx4 v[154:157], v220, s[24:27], s62 offen
    s_add_u32 s62, s60, 56320
    buffer_store_dwordx4 v[158:161], v220, s[24:27], s62 offen
    s_add_u32 s62, s60, 57344
    buffer_store_dwordx4 v[162:165], v220, s[24:27], s62 offen
L_join_96:
    s_add_u32 s69, s82, 61440
    s_add_u32 m0, s81, 61440
    s_nop 0
    buffer_load_dwordx4 v220, s[24:27], s69 offen offset:0 lds
    buffer_load_dwordx4 v220, s[24:27], s69 offen offset:1024 lds
    buffer_load_dwordx4 v220, s[24:27], s69 offen offset:2048 lds
    buffer_load_dwordx4 v220, s[24:27], s69 offen offset:3072 lds
    s_add_u32 s69, s82, 65536
    s_add_u32 m0, s81, 65536
    s_nop 0
    buffer_load_dwordx4 v220, s[24:27], s69 offen offset:0 lds
    s_add_u32 s69, s82, 71680
    s_add_u32 m0, s81, 71680
    s_nop 0
    buffer_load_dwordx4 v220, s[24:27], s69 offen offset:0 lds
    buffer_load_dwordx4 v220, s[24:27], s69 offen offset:1024 lds
    buffer_load_dwordx4 v220, s[24:27], s69 offen offset:2048 lds
    buffer_load_dwordx4 v220, s[24:27], s69 offen offset:3072 lds
    s_add_u32 s69, s82, 75776
    s_add_u32 m0, s81, 75776
    s_nop 0
    buffer_load_dwordx4 v220, s[24:27], s69 offen offset:0 lds
    v_add_u32 v1, s81, v220
    v_mov_b32 v198, v1
    ds_write_b128 v198, a[160:163] offset:0
    ds_write_b128 v198, a[164:167] offset:1024
    ds_write_b128 v198, a[168:171] offset:2048
    ds_write_b128 v198, a[172:175] offset:3072
    ds_write_b128 v198, a[176:179] offset:4096
    ds_write_b128 v198, a[180:183] offset:10240
    ds_write_b128 v198, a[184:187] offset:11264
    ds_write_b128 v198, a[188:191] offset:12288
    ds_write_b128 v198, a[192:195] offset:13312
    ds_write_b128 v198, a[196:199] offset:14336
    ds_write_b128 v198, a[200:203] offset:20480
    ds_write_b128 v198, a[204:207] offset:21504
    s_waitcnt vmcnt(10)
    s_barrier
    s_cmp_eq_u32 s3, 0
    s_cbranch_scc0 L_pub_99
    s_cmp_eq_u32 s70, 0
    s_cbranch_scc1 L_alt_100
    s_lshl_b32 s42, s83, 6
    s_add_u32 s42, s42, 49152
    v_mov_b32 v1, 0
    v_mov_b32 v2, s40
    s_mov_b64 exec, 1
    buffer_store_dword v2, v1, s[24:27], s42 offen
    s_mov_b64 exec, -1
L_join_101:
L_pub_99:
    ds_write_b128 v198, a[208:211] offset:22528
    ds_write_b128 v198, a[212:215] offset:23552
    ds_write_b128 v198, a[0:3] offset:24576
    s_waitcnt lgkmcnt(14)
    ds_write_b128 v198, a[4:7] offset:30720
    s_waitcnt lgkmcnt(14)
    ds_write_b128 v198, a[8:11] offset:31744
    s_waitcnt lgkmcnt(14)
    ds_write_b128 v198, a[12:15] offset:32768
    s_waitcnt lgkmcnt(14)
    ds_write_b128 v198, a[16:19] offset:33792
    s_waitcnt lgkmcnt(14)
    ds_write_b128 v198, a[20:23] offset:34816
    s_waitcnt lgkmcnt(14)
    ds_write_b128 v198, a[24:27] offset:40960
    s_waitcnt lgkmcnt(14)
    ds_write_b128 v198, a[28:31] offset:41984
    s_waitcnt lgkmcnt(14)
    ds_write_b128 v198, a[32:35] offset:43008
    s_waitcnt lgkmcnt(14)
    ds_write_b128 v198, a[36:39] offset:44032
    s_waitcnt lgkmcnt(14)
    ds_write_b128 v198, a[40:43] offset:45056
    s_waitcnt lgkmcnt(14)
    ds_write_b128 v198, a[44:47] offset:51200
    s_waitcnt lgkmcnt(14)
    ds_write_b128 v198, a[48:51] offset:52224
    s_waitcnt lgkmcnt(14)
    ds_write_b128 v198, a[52:55] offset:53248
    s_waitcnt lgkmcnt(14)
    ds_write_b128 v198, a[56:59] offset:54272
    s_waitcnt lgkmcnt(14)
    ds_write_b128 v198, a[60:63] offset:55296
    s_lshr_b32 s66, s55, 1
    s_lshl_b32 s66, s66, 10
    s_add_u32 s66, s66, 49152
    v_lshlrev_b32 v7, 6, v0
    v_add_u32 v7, s66, v7
    s_lshr_b32 s66, s3, 1
    s_mul_i32 s66, s66, 81920
    v_add_u32 v96, s66, v220
    v_add_u32 v97, 40960, v96
    v_lshrrev_b32 v1, 4, v0
    v_lshlrev_b32 v1, 3, v1
    s_mul_i32 s66, s56, 160
    s_lshl_b32 s67, s57, 5
    s_add_u32 s67, s67, s66
    v_add_u32 v2, s67, v1
    s_cmp_eq_u32 s57, 0
    s_cselect_b32 s67, 128, 0
    s_add_u32 s67, s67, s66
    v_add_u32 v3, s67, v1
    v_accvgpr_read_b32 v8, a216
    v_accvgpr_read_b32 v9, a217
    v_accvgpr_read_b32 v10, a218
    v_accvgpr_read_b32 v11, a219
    v_accvgpr_read_b32 v12, a220
    v_accvgpr_read_b32 v13, a221
    v_accvgpr_read_b32 v14, a222
    v_accvgpr_read_b32 v15, a223
    v_accvgpr_read_b32 v16, a224
    v_accvgpr_read_b32 v17, a225
    s_and_b32 s66, s3, 1
    s_lshr_b32 s67, s3, 1
    s_lshl_b32 s66, s66, 1
    s_and_b32 s68, s55, 1
    s_lshl_b32 s68, s68, 2
    s_add_u32 s66, s66, s68
    s_add_u32 s60, s66, s67
    s_xor_b32 s68, s67, 1
    s_add_u32 s61, s66, s68
    s_mul_i32 s67, s67, 27
    s_mul_i32 s60, s60, 54
    s_mul_i32 s61, s61, 54
    s_add_u32 s60, s60, s67
    s_add_u32 s61, s61, s67
    s_lshl_b32 s60, s60, 10
    s_lshl_b32 s61, s61, 10
    s_lshr_b32 s66, s55, 1
    s_mul_i32 s66, s66, 606208
    s_add_u32 s66, s66, 294912
    s_add_u32 s60, s60, s66
    s_add_u32 s61, s61, s66
    v_and_b32 v3, 15, v0
    v_mul_u32_u24 v3, 176, v3
    v_lshrrev_b32 v4, 4, v0
    v_lshl_add_u32 v3, v4, 3, v3
    s_mul_i32 s66, s3, 2816
    s_add_u32 s66, s66, 24576
    s_lshl_b32 s67, s57, 5
    s_add_u32 s67, s67, s66
    v_add_u32 v20, s67, v3
    s_cmp_eq_u32 s57, 0
    s_cselect_b32 s67, 128, 0
    s_add_u32 s67, s67, s66
    v_add_u32 v21, s67, v3
    s_mov_b32 s69, 1280
    v_add_u32 v4, 0, v0
    v_mul_u32_u24 v5, 205, v4
    v_lshrrev_b32 v5, 11, v5
    v_mul_u32_u24 v6, 10, v5
    v_sub_u32 v6, v4, v6
    v_lshlrev_b32 v6, 4, v6
    v_mad_u32_u24 v25, v5, s69, v6
    v_mul_u32_u24 v5, 176, v5
    v_add_u32 v5, v5, v6
    v_add_u32 v22, s66, v5
    v_add_u32 v4, 64, v0
    v_mul_u32_u24 v5, 205, v4
    v_lshrrev_b32 v5, 11, v5
    v_mul_u32_u24 v6, 10, v5
    v_sub_u32 v6, v4, v6
    v_lshlrev_b32 v6, 4, v6
    v_mad_u32_u24 v26, v5, s69, v6
    v_mul_u32_u24 v5, 176, v5
    v_add_u32 v5, v5, v6
    v_add_u32 v23, s66, v5
    v_add_u32 v4, 128, v0
    v_mul_u32_u24 v5, 205, v4
    v_lshrrev_b32 v5, 11, v5
    v_mul_u32_u24 v6, 10, v5
    v_sub_u32 v6, v4, v6
    v_lshlrev_b32 v6, 4, v6
    v_mad_u32_u24 v27, v5, s69, v6
    v_mul_u32_u24 v5, 176, v5
    v_add_u32 v5, v5, v6
    v_add_u32 v24, s66, v5
    v_lshlrev_b32 v56, 16, v200
    v_and_b32 v57, 0xffff0000, v200
    v_lshlrev_b32 v4, 16, v8
    v_and_b32 v5, 0xffff0000, v8
    v_pk_add_f32 v[56:57], v[56:57], v[4:5]
    v_lshlrev_b32 v58, 16, v201
    v_and_b32 v59, 0xffff0000, v201
    v_lshlrev_b32 v4, 16, v9
    v_and_b32 v5, 0xffff0000, v9
    v_pk_add_f32 v[58:59], v[58:59], v[4:5]
    v_lshlrev_b32 v60, 16, v202
    v_and_b32 v61, 0xffff0000, v202
    v_lshlrev_b32 v4, 16, v10
    v_and_b32 v5, 0xffff0000, v10
    v_pk_add_f32 v[60:61], v[60:61], v[4:5]
    v_lshlrev_b32 v62, 16, v203
    v_and_b32 v63, 0xffff0000, v203
    v_lshlrev_b32 v4, 16, v11
    v_and_b32 v5, 0xffff0000, v11
    v_pk_add_f32 v[62:63], v[62:63], v[4:5]
    v_lshlrev_b32 v64, 16, v204
    v_and_b32 v65, 0xffff0000, v204
    v_lshlrev_b32 v4, 16, v12
    v_and_b32 v5, 0xffff0000, v12
    v_pk_add_f32 v[64:65], v[64:65], v[4:5]
    v_lshlrev_b32 v66, 16, v205
    v_and_b32 v67, 0xffff0000, v205
    v_lshlrev_b32 v4, 16, v13
    v_and_b32 v5, 0xffff0000, v13
    v_pk_add_f32 v[66:67], v[66:67], v[4:5]
    v_lshlrev_b32 v68, 16, v206
    v_and_b32 v69, 0xffff0000, v206
    v_lshlrev_b32 v4, 16, v14
    v_and_b32 v5, 0xffff0000, v14
    v_pk_add_f32 v[68:69], v[68:69], v[4:5]
    v_lshlrev_b32 v70, 16, v207
    v_and_b32 v71, 0xffff0000, v207
    v_lshlrev_b32 v4, 16, v15
    v_and_b32 v5, 0xffff0000, v15
    v_pk_add_f32 v[70:71], v[70:71], v[4:5]
    v_lshlrev_b32 v72, 16, v208
    v_and_b32 v73, 0xffff0000, v208
    v_lshlrev_b32 v4, 16, v16
    v_and_b32 v5, 0xffff0000, v16
    v_pk_add_f32 v[72:73], v[72:73], v[4:5]
    v_lshlrev_b32 v74, 16, v209
    v_and_b32 v75, 0xffff0000, v209
    v_lshlrev_b32 v4, 16, v17
    v_and_b32 v5, 0xffff0000, v17
    v_pk_add_f32 v[74:75], v[74:75], v[4:5]
    s_waitcnt lgkmcnt(0)
    s_cmp_eq_u32 s3, 0
    s_cbranch_scc0 L_polldone_104
    s_mov_b32 s42, 0
    s_mov_b64 exec, 0xffff
L_poll_102:
    buffer_load_dword v2, v7, s[24:27], 0 offen sc1
    s_add_u32 s42, s42, 1
    s_waitcnt vmcnt(0)
    v_cmp_ne_u32 vcc, s40, v2
    s_cmp_gt_u32 s42, 0x40000
    s_cbranch_scc1 L_got_103
    s_nop 1
    s_cbranch_vccnz L_poll_102
L_got_103:
    s_mov_b64 exec, -1
L_polldone_104:
    s_barrier
    buffer_load_dwordx4 a[0:3], v220, s[24:27], s60 offen offset:0 sc1
    buffer_load_dwordx4 a[4:7], v220, s[24:27], s61 offen offset:0 sc1
    buffer_load_dwordx4 a[8:11], v220, s[24:27], s60 offen offset:1024 sc1
    buffer_load_dwordx4 a[12:15], v220, s[24:27], s61 offen offset:1024 sc1
    buffer_load_dwordx4 a[16:19], v220, s[24:27], s60 offen offset:2048 sc1
    buffer_load_dwordx4 a[20:23], v220, s[24:27], s61 offen offset:2048 sc1
    ds_read_b128 v[100:103], v96 offset:0
    ds_read_b128 v[104:107], v96 offset:1024
    ds_read_b128 v[108:111], v96 offset:2048
    ds_read_b128 v[112:115], v96 offset:3072
    ds_read_b128 v[116:119], v96 offset:4096
    s_waitcnt vmcnt(4)
    s_waitcnt lgkmcnt(4)
    v_mfma_f32_16x16x32_bf16 v[56:59], v[100:103], a[0:3], v[56:59]
    v_mfma_f32_16x16x32_bf16 v[76:79], v[100:103], a[4:7], 0
    ds_read_b128 v[120:123], v96 offset:5120
    s_waitcnt lgkmcnt(4)
    v_mfma_f32_16x16x32_bf16 v[60:63], v[104:107], a[0:3], v[60:63]
    v_mfma_f32_16x16x32_bf16 v[80:83], v[104:107], a[4:7], 0
    ds_read_b128 v[124:127], v96 offset:6144
    s_waitcnt lgkmcnt(4)
    v_mfma_f32_16x16x32_bf16 v[64:67], v[108:111], a[0:3], v[64:67]
    v_mfma_f32_16x16x32_bf16 v[84:87], v[108:111], a[4:7], 0
    ds_read_b128 v[128:131], v96 offset:7168
    buffer_load_dwordx4 a[24:27], v220, s[24:27], s60 offen offset:3072 sc1
    buffer_load_dwordx4 a[28:31], v220, s[24:27], s61 offen offset:3072 sc1
    s_waitcnt lgkmcnt(4)
    v_mfma_f32_16x16x32_bf16 v[68:71], v[112:115], a[0:3], v[68:71]
    v_mfma_f32_16x16x32_bf16 v[88:91], v[112:115], a[4:7], 0
    ds_read_b128 v[132:135], v96 offset:8192
    s_add_u32 s60, s60, 4096
    buffer_load_dwordx4 a[32:35], v220, s[24:27], s60 offen offset:0 sc1
    s_add_u32 s61, s61, 4096
    buffer_load_dwordx4 a[36:39], v220, s[24:27], s61 offen offset:0 sc1
    s_waitcnt lgkmcnt(4)
    v_mfma_f32_16x16x32_bf16 v[72:75], v[116:119], a[0:3], v[72:75]
    v_mfma_f32_16x16x32_bf16 v[92:95], v[116:119], a[4:7], 0
    ds_read_b128 v[136:139], v96 offset:9216
    s_waitcnt vmcnt(6)
    s_waitcnt lgkmcnt(4)
    v_mfma_f32_16x16x32_bf16 v[56:59], v[120:123], a[8:11], v[56:59]
    v_mfma_f32_16x16x32_bf16 v[76:79], v[120:123], a[12:15], v[76:79]
    ds_read_b128 v[100:103], v96 offset:10240
    s_waitcnt lgkmcnt(4)
    v_mfma_f32_16x16x32_bf16 v[60:63], v[124:127], a[8:11], v[60:63]
    v_mfma_f32_16x16x32_bf16 v[80:83], v[124:127], a[12:15], v[80:83]
    ds_read_b128 v[104:107], v96 offset:11264
    s_waitcnt lgkmcnt(4)
    v_mfma_f32_16x16x32_bf16 v[64:67], v[128:131], a[8:11], v[64:67]
    v_mfma_f32_16x16x32_bf16 v[84:87], v[128:131], a[12:15], v[84:87]
    ds_read_b128 v[108:111], v96 offset:12288
    buffer_load_dwordx4 a[40:43], v220, s[24:27], s60 offen offset:1024 sc1
    buffer_load_dwordx4 a[44:47], v220, s[24:27], s61 offen offset:1024 sc1
    s_waitcnt lgkmcnt(4)
    v_mfma_f32_16x16x32_bf16 v[68:71], v[132:135], a[8:11], v[68:71]
    v_mfma_f32_16x16x32_bf16 v[88:91], v[132:135], a[12:15], v[88:91]
    ds_read_b128 v[112:115], v96 offset:13312
    buffer_load_dwordx4 a[48:51], v220, s[24:27], s60 offen offset:2048 sc1
    buffer_load_dwordx4 a[52:55], v220, s[24:27], s61 offen offset:2048 sc1
    s_waitcnt lgkmcnt(4)
    v_mfma_f32_16x16x32_bf16 v[72:75], v[136:139], a[8:11], v[72:75]
    v_mfma_f32_16x16x32_bf16 v[92:95], v[136:139], a[12:15], v[92:95]
    ds_read_b128 v[116:119], v96 offset:14336
    s_waitcnt vmcnt(8)
    s_waitcnt lgkmcnt(4)
    v_mfma_f32_16x16x32_bf16 v[56:59], v[100:103], a[16:19], v[56:59]
    v_mfma_f32_16x16x32_bf16 v[76:79], v[100:103], a[20:23], v[76:79]
    ds_read_b128 v[120:123], v96 offset:15360
    s_waitcnt lgkmcnt(4)
    v_mfma_f32_16x16x32_bf16 v[60:63], v[104:107], a[16:19], v[60:63]
    v_mfma_f32_16x16x32_bf16 v[80:83], v[104:107], a[20:23], v[80:83]
    ds_read_b128 v[124:127], v96 offset:16384
    s_waitcnt lgkmcnt(4)
    v_mfma_f32_16x16x32_bf16 v[64:67], v[108:111], a[16:19], v[64:67]
    v_mfma_f32_16x16x32_bf16 v[84:87], v[108:111], a[20:23], v[84:87]
    ds_read_b128 v[128:131], v96 offset:17408
    buffer_load_dwordx4 a[56:59], v220, s[24:27], s60 offen offset:3072 sc1
    buffer_load_dwordx4 a[60:63], v220, s[24:27], s61 offen offset:3072 sc1
    s_waitcnt lgkmcnt(4)
    v_mfma_f32_16x16x32_bf16 v[68:71], v[112:115], a[16:19], v[68:71]
    v_mfma_f32_16x16x32_bf16 v[88:91], v[112:115], a[20:23], v[88:91]
    ds_read_b128 v[132:135], v96 offset:18432
    s_add_u32 s60, s60, 4096
    buffer_load_dwordx4 a[64:67], v220, s[24:27], s60 offen offset:0 sc1
    s_add_u32 s61, s61, 4096
    buffer_load_dwordx4 a[68:71], v220, s[24:27], s61 offen offset:0 sc1
    s_waitcnt lgkmcnt(4)
    v_mfma_f32_16x16x32_bf16 v[72:75], v[116:119], a[16:19], v[72:75]
    v_mfma_f32_16x16x32_bf16 v[92:95], v[116:119], a[20:23], v[92:95]
    ds_read_b128 v[136:139], v96 offset:19456
    s_waitcnt vmcnt(10)
    s_waitcnt lgkmcnt(4)
    v_mfma_f32_16x16x32_bf16 v[56:59], v[120:123], a[24:27], v[56:59]
    v_mfma_f32_16x16x32_bf16 v[76:79], v[120:123], a[28:31], v[76:79]
    ds_read_b128 v[100:103], v96 offset:20480
    s_waitcnt lgkmcnt(4)
    v_mfma_f32_16x16x32_bf16 v[60:63], v[124:127], a[24:27], v[60:63]
    v_mfma_f32_16x16x32_bf16 v[80:83], v[124:127], a[28:31], v[80:83]
    ds_read_b128 v[104:107], v96 offset:21504
    s_waitcnt lgkmcnt(4)
    v_mfma_f32_16x16x32_bf16 v[64:67], v[128:131], a[24:27], v[64:67]
    v_mfma_f32_16x16x32_bf16 v[84:87], v[128:131], a[28:31], v[84:87]
    ds_read_b128 v[108:111], v96 offset:22528
    buffer_load_dwordx4 a[72:75], v220, s[24:27], s60 offen offset:1024 sc1
    buffer_load_dwordx4 a[76:79], v220, s[24:27], s61 offen offset:1024 sc1
    s_waitcnt lgkmcnt(4)
    v_mfma_f32_16x16x32_bf16 v[68:71], v[132:135], a[24:27], v[68:71]
    v_mfma_f32_16x16x32_bf16 v[88:91], v[132:135], a[28:31], v[88:91]
    ds_read_b128 v[112:115], v96 offset:23552
    buffer_load_dwordx4 a[80:83], v220, s[24:27], s60 offen offset:2048 sc1
    buffer_load_dwordx4 a[84:87], v220, s[24:27], s61 offen offset:2048 sc1
    s_waitcnt lgkmcnt(4)
    v_mfma_f32_16x16x32_bf16 v[72:75], v[136:139], a[24:27], v[72:75]
    v_mfma_f32_16x16x32_bf16 v[92:95], v[136:139], a[28:31], v[92:95]
    ds_read_b128 v[116:119], v96 offset:24576
    s_waitcnt vmcnt(12)
    s_waitcnt lgkmcnt(4)
    v_mfma_f32_16x16x32_bf16 v[56:59], v[100:103], a[32:35], v[56:59]
    v_mfma_f32_16x16x32_bf16 v[76:79], v[100:103], a[36:39], v[76:79]
    ds_read_b128 v[120:123], v96 offset:25600
    s_waitcnt lgkmcnt(4)
    v_mfma_f32_16x16x32_bf16 v[60:63], v[104:107], a[32:35], v[60:63]
    v_mfma_f32_16x16x32_bf16 v[80:83], v[104:107], a[36:39], v[80:83]
    ds_read_b128 v[124:127], v96 offset:26624
    s_waitcnt lgkmcnt(4)
    v_mfma_f32_16x16x32_bf16 v[64:67], v[108:111], a[32:35], v[64:67]
    v_mfma_f32_16x16x32_bf16 v[84:87], v[108:111], a[36:39], v[84:87]
    ds_read_b128 v[128:131], v96 offset:27648
    buffer_load_dwordx4 a[88:91], v220, s[24:27], s60 offen offset:3072 sc1
    buffer_load_dwordx4 a[92:95], v220, s[24:27], s61 offen offset:3072 sc1
    s_waitcnt lgkmcnt(4)
    v_mfma_f32_16x16x32_bf16 v[68:71], v[112:115], a[32:35], v[68:71]
    v_mfma_f32_16x16x32_bf16 v[88:91], v[112:115], a[36:39], v[88:91]
    ds_read_b128 v[132:135], v96 offset:28672
    s_add_u32 s60, s60, 4096
    buffer_load_dwordx4 a[96:99], v220, s[24:27], s60 offen offset:0 sc1
    s_add_u32 s61, s61, 4096
    buffer_load_dwordx4 a[100:103], v220, s[24:27], s61 offen offset:0 sc1
    s_waitcnt lgkmcnt(4)
    v_mfma_f32_16x16x32_bf16 v[72:75], v[116:119], a[32:35], v[72:75]
    v_mfma_f32_16x16x32_bf16 v[92:95], v[116:119], a[36:39], v[92:95]
    ds_read_b128 v[136:139], v96 offset:29696
    s_waitcnt vmcnt(14)
    s_waitcnt lgkmcnt(4)
    v_mfma_f32_16x16x32_bf16 v[56:59], v[120:123], a[40:43], v[56:59]
    v_mfma_f32_16x16x32_bf16 v[76:79], v[120:123], a[44:47], v[76:79]
    ds_read_b128 v[100:103], v96 offset:30720
    s_waitcnt lgkmcnt(4)
    v_mfma_f32_16x16x32_bf16 v[60:63], v[124:127], a[40:43], v[60:63]
    v_mfma_f32_16x16x32_bf16 v[80:83], v[124:127], a[44:47], v[80:83]
    ds_read_b128 v[104:107], v96 offset:31744
    s_waitcnt lgkmcnt(4)
    v_mfma_f32_16x16x32_bf16 v[64:67], v[128:131], a[40:43], v[64:67]
    v_mfma_f32_16x16x32_bf16 v[84:87], v[128:131], a[44:47], v[84:87]
    ds_read_b128 v[108:111], v96 offset:32768
    buffer_load_dwordx4 a[104:107], v220, s[24:27], s60 offen offset:1024 sc1
    buffer_load_dwordx4 a[108:111], v220, s[24:27], s61 offen offset:1024 sc1
    s_waitcnt lgkmcnt(4)
    v_mfma_f32_16x16x32_bf16 v[68:71], v[132:135], a[40:43], v[68:71]
    v_mfma_f32_16x16x32_bf16 v[88:91], v[132:135], a[44:47], v[88:91]
    ds_read_b128 v[112:115], v96 offset:33792
    s_waitcnt lgkmcnt(4)
    v_mfma_f32_16x16x32_bf16 v[72:75], v[136:139], a[40:43], v[72:75]
    v_mfma_f32_16x16x32_bf16 v[92:95], v[136:139], a[44:47], v[92:95]
    ds_read_b128 v[116:119], v96 offset:34816
    s_barrier
    s_waitcnt vmcnt(14)
    s_waitcnt lgkmcnt(4)
    v_mfma_f32_16x16x32_bf16 v[56:59], v[100:103], a[48:51], v[56:59]
    v_mfma_f32_16x16x32_bf16 v[76:79], v[100:103], a[52:55], v[76:79]
    ds_read_b128 v[120:123], v96 offset:35840
    s_add_u32 s69, s82, 81920
    s_add_u32 m0, s81, 0
    s_nop 0
    buffer_load_dwordx4 v220, s[24:27], s69 offen offset:0 lds
    s_waitcnt lgkmcnt(4)
    v_mfma_f32_16x16x32_bf16 v[60:63], v[104:107], a[48:51], v[60:63]
    v_mfma_f32_16x16x32_bf16 v[80:83], v[104:107], a[52:55], v[80:83]
    ds_read_b128 v[124:127], v96 offset:36864
    buffer_load_dwordx4 v220, s[24:27], s69 offen offset:1024 lds
    s_waitcnt lgkmcnt(4)
    v_mfma_f32_16x16x32_bf16 v[64:67], v[108:111], a[48:51], v[64:67]
    v_mfma_f32_16x16x32_bf16 v[84:87], v[108:111], a[52:55], v[84:87]
    ds_read_b128 v[128:131], v96 offset:37888
    buffer_load_dwordx4 a[112:115], v220, s[24:27], s60 offen offset:2048 sc1
    buffer_load_dwordx4 a[116:119], v220, s[24:27], s61 offen offset:2048 sc1
    s_waitcnt lgkmcnt(4)
    v_mfma_f32_16x16x32_bf16 v[68:71], v[112:115], a[48:51], v[68:71]
    v_mfma_f32_16x16x32_bf16 v[88:91], v[112:115], a[52:55], v[88:91]
    ds_read_b128 v[132:135], v96 offset:38912
    s_waitcnt lgkmcnt(4)
    v_mfma_f32_16x16x32_bf16 v[72:75], v[116:119], a[48:51], v[72:75]
    v_mfma_f32_16x16x32_bf16 v[92:95], v[116:119], a[52:55], v[92:95]
    ds_read_b128 v[136:139], v96 offset:39936
    buffer_load_dwordx4 v220, s[24:27], s69 offen offset:2048 lds
    s_waitcnt vmcnt(17)
    s_waitcnt lgkmcnt(4)
    v_mfma_f32_16x16x32_bf16 v[56:59], v[120:123], a[56:59], v[56:59]
    v_mfma_f32_16x16x32_bf16 v[76:79], v[120:123], a[60:63], v[76:79]
    ds_read_b128 v[100:103], v97 offset:0
    buffer_load_dwordx4 v220, s[24:27], s69 offen offset:3072 lds
    s_waitcnt lgkmcnt(4)
    v_mfma_f32_16x16x32_bf16 v[60:63], v[124:127], a[56:59], v[60:63]
    v_mfma_f32_16x16x32_bf16 v[80:83], v[124:127], a[60:63], v[80:83]
    ds_read_b128 v[104:107], v97 offset:1024
    s_add_u32 s69, s82, 86016
    s_add_u32 m0, s81, 4096
    s_nop 0
    buffer_load_dwordx4 v220, s[24:27], s69 offen offset:0 lds
    s_waitcnt lgkmcnt(4)
    v_mfma_f32_16x16x32_bf16 v[64:67], v[128:131], a[56:59], v[64:67]
    v_mfma_f32_16x16x32_bf16 v[84:87], v[128:131], a[60:63], v[84:87]
    ds_read_b128 v[108:111], v97 offset:2048
    buffer_load_dwordx4 a[120:123], v220, s[24:27], s60 offen offset:3072 sc1
    buffer_load_dwordx4 a[124:127], v220, s[24:27], s61 offen offset:3072 sc1
    s_waitcnt lgkmcnt(4)
    v_mfma_f32_16x16x32_bf16 v[68:71], v[132:135], a[56:59], v[68:71]
    v_mfma_f32_16x16x32_bf16 v[88:91], v[132:135], a[60:63], v[88:91]
    ds_read_b128 v[112:115], v97 offset:3072
    s_waitcnt lgkmcnt(4)
    v_mfma_f32_16x16x32_bf16 v[72:75], v[136:139], a[56:59], v[72:75]
    v_mfma_f32_16x16x32_bf16 v[92:95], v[136:139], a[60:63], v[92:95]
    ds_read_b128 v[116:119], v97 offset:4096
    s_add_u32 s69, s82, 92160
    s_add_u32 m0, s81, 10240
    s_nop 0
    buffer_load_dwordx4 v220, s[24:27], s69 offen offset:0 lds
    s_waitcnt vmcnt(20)
    s_waitcnt lgkmcnt(4)
    v_mfma_f32_16x16x32_bf16 v[56:59], v[100:103], a[64:67], v[56:59]
    v_mfma_f32_16x16x32_bf16 v[76:79], v[100:103], a[68:71], v[76:79]
    ds_read_b128 v[120:123], v97 offset:5120
    buffer_load_dwordx4 v220, s[24:27], s69 offen offset:1024 lds
    s_waitcnt lgkmcnt(4)
    v_mfma_f32_16x16x32_bf16 v[60:63], v[104:107], a[64:67], v[60:63]
    v_mfma_f32_16x16x32_bf16 v[80:83], v[104:107], a[68:71], v[80:83]
    ds_read_b128 v[124:127], v97 offset:6144
    buffer_load_dwordx4 v220, s[24:27], s69 offen offset:2048 lds
    s_waitcnt lgkmcnt(4)
    v_mfma_f32_16x16x32_bf16 v[64:67], v[108:111], a[64:67], v[64:67]
    v_mfma_f32_16x16x32_bf16 v[84:87], v[108:111], a[68:71], v[84:87]
    ds_read_b128 v[128:131], v97 offset:7168
    s_add_u32 s60, s60, 4096
    buffer_load_dwordx4 a[128:131], v220, s[24:27], s60 offen offset:0 sc1
    s_add_u32 s61, s61, 4096
    buffer_load_dwordx4 a[132:135], v220, s[24:27], s61 offen offset:0 sc1
    s_waitcnt lgkmcnt(4)
    v_mfma_f32_16x16x32_bf16 v[68:71], v[112:115], a[64:67], v[68:71]
    v_mfma_f32_16x16x32_bf16 v[88:91], v[112:115], a[68:71], v[88:91]
    ds_read_b128 v[132:135], v97 offset:8192
    s_waitcnt lgkmcnt(4)
    v_mfma_f32_16x16x32_bf16 v[72:75], v[116:119], a[64:67], v[72:75]
    v_mfma_f32_16x16x32_bf16 v[92:95], v[116:119], a[68:71], v[92:95]
    ds_read_b128 v[136:139], v97 offset:9216
    buffer_load_dwordx4 v220, s[24:27], s69 offen offset:3072 lds
    s_waitcnt vmcnt(23)
    s_waitcnt lgkmcnt(4)
    v_mfma_f32_16x16x32_bf16 v[56:59], v[120:123], a[72:75], v[56:59]
    v_mfma_f32_16x16x32_bf16 v[76:79], v[120:123], a[76:79], v[76:79]
    ds_read_b128 v[100:103], v97 offset:10240
    s_add_u32 s69, s82, 96256
    s_add_u32 m0, s81, 14336
    s_nop 0
    buffer_load_dwordx4 v220, s[24:27], s69 offen offset:0 lds
    s_waitcnt lgkmcnt(4)
    v_mfma_f32_16x16x32_bf16 v[60:63], v[124:127], a[72:75], v[60:63]
    v_mfma_f32_16x16x32_bf16 v[80:83], v[124:127], a[76:79], v[80:83]
    ds_read_b128 v[104:107], v97 offset:11264
    s_waitcnt lgkmcnt(4)
    v_mfma_f32_16x16x32_bf16 v[64:67], v[128:131], a[72:75], v[64:67]
    v_mfma_f32_16x16x32_bf16 v[84:87], v[128:131], a[76:79], v[84:87]
    ds_read_b128 v[108:111], v97 offset:12288
    buffer_load_dwordx4 a[136:139], v220, s[24:27], s60 offen offset:1024 sc1
    buffer_load_dwordx4 a[140:143], v220, s[24:27], s61 offen offset:1024 sc1
    s_waitcnt lgkmcnt(4)
    v_mfma_f32_16x16x32_bf16 v[68:71], v[132:135], a[72:75], v[68:71]
    v_mfma_f32_16x16x32_bf16 v[88:91], v[132:135], a[76:79], v[88:91]
    ds_read_b128 v[112:115], v97 offset:13312
    s_waitcnt lgkmcnt(4)
    v_mfma_f32_16x16x32_bf16 v[72:75], v[136:139], a[72:75], v[72:75]
    v_mfma_f32_16x16x32_bf16 v[92:95], v[136:139], a[76:79], v[92:95]
    ds_read_b128 v[116:119], v97 offset:14336
    s_barrier
    s_waitcnt vmcnt(24)
    s_waitcnt lgkmcnt(4)
    v_mfma_f32_16x16x32_bf16 v[56:59], v[100:103], a[80:83], v[56:59]
    v_mfma_f32_16x16x32_bf16 v[76:79], v[100:103], a[84:87], v[76:79]
    ds_read_b128 v[120:123], v97 offset:15360
    s_add_u32 s69, s82, 102400
    s_add_u32 m0, s81, 20480
    s_nop 0
    buffer_load_dwordx4 v220, s[24:27], s69 offen offset:0 lds
    s_waitcnt lgkmcnt(4)
    v_mfma_f32_16x16x32_bf16 v[60:63], v[104:107], a[80:83], v[60:63]
    v_mfma_f32_16x16x32_bf16 v[80:83], v[104:107], a[84:87], v[80:83]
    ds_read_b128 v[124:127], v97 offset:16384
    buffer_load_dwordx4 v220, s[24:27], s69 offen offset:1024 lds
    s_waitcnt lgkmcnt(4)
    v_mfma_f32_16x16x32_bf16 v[64:67], v[108:111], a[80:83], v[64:67]
    v_mfma_f32_16x16x32_bf16 v[84:87], v[108:111], a[84:87], v[84:87]
    ds_read_b128 v[128:131], v97 offset:17408
    buffer_load_dwordx4 a[144:147], v220, s[24:27], s60 offen offset:2048 sc1
    buffer_load_dwordx4 a[148:151], v220, s[24:27], s61 offen offset:2048 sc1
    s_waitcnt lgkmcnt(4)
    v_mfma_f32_16x16x32_bf16 v[68:71], v[112:115], a[80:83], v[68:71]
    v_mfma_f32_16x16x32_bf16 v[88:91], v[112:115], a[84:87], v[88:91]
    ds_read_b128 v[132:135], v97 offset:18432
    s_waitcnt lgkmcnt(4)
    v_mfma_f32_16x16x32_bf16 v[72:75], v[116:119], a[80:83], v[72:75]
    v_mfma_f32_16x16x32_bf16 v[92:95], v[116:119], a[84:87], v[92:95]
    ds_read_b128 v[136:139], v97 offset:19456
    buffer_load_dwordx4 v220, s[24:27], s69 offen offset:2048 lds
    s_waitcnt vmcnt(27)
    s_waitcnt lgkmcnt(4)
    v_mfma_f32_16x16x32_bf16 v[56:59], v[120:123], a[88:91], v[56:59]
    v_mfma_f32_16x16x32_bf16 v[76:79], v[120:123], a[92:95], v[76:79]
    ds_read_b128 v[100:103], v97 offset:20480
    buffer_load_dwordx4 v220, s[24:27], s69 offen offset:3072 lds
    s_waitcnt lgkmcnt(4)
    v_mfma_f32_16x16x32_bf16 v[60:63], v[124:127], a[88:91], v[60:63]
    v_mfma_f32_16x16x32_bf16 v[80:83], v[124:127], a[92:95], v[80:83]
    ds_read_b128 v[104:107], v97 offset:21504
    s_add_u32 s69, s82, 106496
    s_add_u32 m0, s81, 24576
    s_nop 0
    buffer_load_dwordx4 v220, s[24:27], s69 offen offset:0 lds
    s_waitcnt lgkmcnt(4)
    v_mfma_f32_16x16x32_bf16 v[64:67], v[128:131], a[88:91], v[64:67]
    v_mfma_f32_16x16x32_bf16 v[84:87], v[128:131], a[92:95], v[84:87]
    ds_read_b128 v[108:111], v97 offset:22528
    buffer_load_dwordx4 a[152:155], v220, s[24:27], s60 offen offset:3072 sc1
    buffer_load_dwordx4 a[156:159], v220, s[24:27], s61 offen offset:3072 sc1
    s_waitcnt lgkmcnt(4)
    v_mfma_f32_16x16x32_bf16 v[68:71], v[132:135], a[88:91], v[68:71]
    v_mfma_f32_16x16x32_bf16 v[88:91], v[132:135], a[92:95], v[88:91]
    ds_read_b128 v[112:115], v97 offset:23552
    s_waitcnt lgkmcnt(4)
    v_mfma_f32_16x16x32_bf16 v[72:75], v[136:139], a[88:91], v[72:75]
    v_mfma_f32_16x16x32_bf16 v[92:95], v[136:139], a[92:95], v[92:95]
    ds_read_b128 v[116:119], v97 offset:24576
    s_add_u32 s69, s82, 112640
    s_add_u32 m0, s81, 30720
    s_nop 0
    buffer_load_dwordx4 v220, s[24:27], s69 offen offset:0 lds
    s_waitcnt vmcnt(30)
    s_waitcnt lgkmcnt(4)
    v_mfma_f32_16x16x32_bf16 v[56:59], v[100:103], a[96:99], v[56:59]
    v_mfma_f32_16x16x32_bf16 v[76:79], v[100:103], a[100:103], v[76:79]
    ds_read_b128 v[120:123], v97 offset:25600
    buffer_load_dwordx4 v220, s[24:27], s69 offen offset:1024 lds
    s_waitcnt lgkmcnt(4)
    v_mfma_f32_16x16x32_bf16 v[60:63], v[104:107], a[96:99], v[60:63]
    v_mfma_f32_16x16x32_bf16 v[80:83], v[104:107], a[100:103], v[80:83]
    ds_read_b128 v[124:127], v97 offset:26624
    buffer_load_dwordx4 v220, s[24:27], s69 offen offset:2048 lds
    s_waitcnt lgkmcnt(4)
    v_mfma_f32_16x16x32_bf16 v[64:67], v[108:111], a[96:99], v[64:67]
    v_mfma_f32_16x16x32_bf16 v[84:87], v[108:111], a[100:103], v[84:87]
    ds_read_b128 v[128:131], v97 offset:27648
    s_add_u32 s60, s60, 4096
    buffer_load_dwordx4 a[160:163], v220, s[24:27], s60 offen offset:0 sc1
    s_add_u32 s61, s61, 4096
    buffer_load_dwordx4 a[164:167], v220, s[24:27], s61 offen offset:0 sc1
    s_waitcnt lgkmcnt(4)
    v_mfma_f32_16x16x32_bf16 v[68:71], v[112:115], a[96:99], v[68:71]
    v_mfma_f32_16x16x32_bf16 v[88:91], v[112:115], a[100:103], v[88:91]
    ds_read_b128 v[132:135], v97 offset:28672
    s_waitcnt lgkmcnt(4)
    v_mfma_f32_16x16x32_bf16 v[72:75], v[116:119], a[96:99], v[72:75]
    v_mfma_f32_16x16x32_bf16 v[92:95], v[116:119], a[100:103], v[92:95]
    ds_read_b128 v[136:139], v97 offset:29696
    buffer_load_dwordx4 v220, s[24:27], s69 offen offset:3072 lds
    s_waitcnt vmcnt(33)
    s_waitcnt lgkmcnt(4)
    v_mfma_f32_16x16x32_bf16 v[56:59], v[120:123], a[104:107], v[56:59]
    v_mfma_f32_16x16x32_bf16 v[76:79], v[120:123], a[108:111], v[76:79]
    ds_read_b128 v[100:103], v97 offset:30720
    s_add_u32 s69, s82, 116736
    s_add_u32 m0, s81, 34816
    s_nop 0
    buffer_load_dwordx4 v220, s[24:27], s69 offen offset:0 lds
    s_waitcnt lgkmcnt(4)
    v_mfma_f32_16x16x32_bf16 v[60:63], v[124:127], a[104:107], v[60:63]
    v_mfma_f32_16x16x32_bf16 v[80:83], v[124:127], a[108:111], v[80:83]
    ds_read_b128 v[104:107], v97 offset:31744
    s_waitcnt lgkmcnt(4)
    v_mfma_f32_16x16x32_bf16 v[64:67], v[128:131], a[104:107], v[64:67]
    v_mfma_f32_16x16x32_bf16 v[84:87], v[128:131], a[108:111], v[84:87]
    ds_read_b128 v[108:111], v97 offset:32768
    buffer_load_dwordx4 a[168:171], v220, s[24:27], s60 offen offset:1024 sc1
    buffer_load_dwordx4 a[172:175], v220, s[24:27], s61 offen offset:1024 sc1
    s_waitcnt lgkmcnt(4)
    v_mfma_f32_16x16x32_bf16 v[68:71], v[132:135], a[104:107], v[68:71]
    v_mfma_f32_16x16x32_bf16 v[88:91], v[132:135], a[108:111], v[88:91]
    ds_read_b128 v[112:115], v97 offset:33792
    s_waitcnt lgkmcnt(4)
    v_mfma_f32_16x16x32_bf16 v[72:75], v[136:139], a[104:107], v[72:75]
    v_mfma_f32_16x16x32_bf16 v[92:95], v[136:139], a[108:111], v[92:95]
    ds_read_b128 v[116:119], v97 offset:34816
    s_waitcnt vmcnt(20)
    s_barrier
    s_waitcnt lgkmcnt(4)
    v_mfma_f32_16x16x32_bf16 v[56:59], v[100:103], a[112:115], v[56:59]
    v_mfma_f32_16x16x32_bf16 v[76:79], v[100:103], a[116:119], v[76:79]
    ds_read_b128 v[120:123], v97 offset:35840
    s_add_u32 s69, s82, 122880
    s_add_u32 m0, s81, 40960
    s_nop 0
    buffer_load_dwordx4 v220, s[24:27], s69 offen offset:0 lds
    s_waitcnt lgkmcnt(4)
    v_mfma_f32_16x16x32_bf16 v[60:63], v[104:107], a[112:115], v[60:63]
    v_mfma_f32_16x16x32_bf16 v[80:83], v[104:107], a[116:119], v[80:83]
    ds_read_b128 v[124:127], v97 offset:36864
    buffer_load_dwordx4 v220, s[24:27], s69 offen offset:1024 lds
    s_waitcnt lgkmcnt(4)
    v_mfma_f32_16x16x32_bf16 v[64:67], v[108:111], a[112:115], v[64:67]
    v_mfma_f32_16x16x32_bf16 v[84:87], v[108:111], a[116:119], v[84:87]
    ds_read_b128 v[128:131], v97 offset:37888
    buffer_load_dwordx4 a[176:179], v220, s[24:27], s60 offen offset:2048 sc1
    buffer_load_dwordx4 a[180:183], v220, s[24:27], s61 offen offset:2048 sc1
    s_waitcnt lgkmcnt(4)
    v_mfma_f32_16x16x32_bf16 v[68:71], v[112:115], a[112:115], v[68:71]
    v_mfma_f32_16x16x32_bf16 v[88:91], v[112:115], a[116:119], v[88:91]
    ds_read_b128 v[132:135], v97 offset:38912
    s_waitcnt lgkmcnt(4)
    v_mfma_f32_16x16x32_bf16 v[72:75], v[116:119], a[112:115], v[72:75]
    v_mfma_f32_16x16x32_bf16 v[92:95], v[116:119], a[116:119], v[92:95]
    ds_read_b128 v[136:139], v97 offset:39936
    buffer_load_dwordx4 v220, s[24:27], s69 offen offset:2048 lds
    s_waitcnt lgkmcnt(4)
    v_mfma_f32_16x16x32_bf16 v[56:59], v[120:123], a[120:123], v[56:59]
    v_mfma_f32_16x16x32_bf16 v[76:79], v[120:123], a[124:127], v[76:79]
    ds_read_b128 v[100:103], v96 offset:0
    buffer_load_dwordx4 v220, s[24:27], s69 offen offset:3072 lds
    s_waitcnt lgkmcnt(4)
    v_mfma_f32_16x16x32_bf16 v[60:63], v[124:127], a[120:123], v[60:63]
    v_mfma_f32_16x16x32_bf16 v[80:83], v[124:127], a[124:127], v[80:83]
    ds_read_b128 v[104:107], v96 offset:1024
    s_add_u32 s69, s82, 126976
    s_add_u32 m0, s81, 45056
    s_nop 0
    buffer_load_dwordx4 v220, s[24:27], s69 offen offset:0 lds
    s_waitcnt lgkmcnt(4)
    v_mfma_f32_16x16x32_bf16 v[64:67], v[128:131], a[120:123], v[64:67]
    v_mfma_f32_16x16x32_bf16 v[84:87], v[128:131], a[124:127], v[84:87]
    ds_read_b128 v[108:111], v96 offset:2048
    buffer_load_dwordx4 a[184:187], v220, s[24:27], s60 offen offset:3072 sc1
    buffer_load_dwordx4 a[188:191], v220, s[24:27], s61 offen offset:3072 sc1
    s_waitcnt lgkmcnt(4)
    v_mfma_f32_16x16x32_bf16 v[68:71], v[132:135], a[120:123], v[68:71]
    v_mfma_f32_16x16x32_bf16 v[88:91], v[132:135], a[124:127], v[88:91]
    ds_read_b128 v[112:115], v96 offset:3072
    s_waitcnt lgkmcnt(4)
    v_mfma_f32_16x16x32_bf16 v[72:75], v[136:139], a[120:123], v[72:75]
    v_mfma_f32_16x16x32_bf16 v[92:95], v[136:139], a[124:127], v[92:95]
    ds_read_b128 v[116:119], v96 offset:4096
    s_add_u32 s69, s82, 133120
    s_add_u32 m0, s81, 51200
    s_nop 0
    buffer_load_dwordx4 v220, s[24:27], s69 offen offset:0 lds
    s_waitcnt lgkmcnt(4)
    v_mfma_f32_16x16x32_bf16 v[56:59], v[100:103], a[128:131], v[56:59]
    v_mfma_f32_16x16x32_bf16 v[76:79], v[100:103], a[132:135], v[76:79]
    ds_read_b128 v[120:123], v96 offset:5120
    buffer_load_dwordx4 v220, s[24:27], s69 offen offset:1024 lds
    s_waitcnt lgkmcnt(4)
    v_mfma_f32_16x16x32_bf16 v[60:63], v[104:107], a[128:131], v[60:63]
    v_mfma_f32_16x16x32_bf16 v[80:83], v[104:107], a[132:135], v[80:83]
    ds_read_b128 v[124:127], v96 offset:6144
    buffer_load_dwordx4 v220, s[24:27], s69 offen offset:2048 lds
    s_waitcnt lgkmcnt(4)
    v_mfma_f32_16x16x32_bf16 v[64:67], v[108:111], a[128:131], v[64:67]
    v_mfma_f32_16x16x32_bf16 v[84:87], v[108:111], a[132:135], v[84:87]
    ds_read_b128 v[128:131], v96 offset:7168
    s_add_u32 s60, s60, 4096
    buffer_load_dwordx4 a[192:195], v220, s[24:27], s60 offen offset:0 sc1
    s_add_u32 s61, s61, 4096
    buffer_load_dwordx4 a[196:199], v220, s[24:27], s61 offen offset:0 sc1
    s_waitcnt lgkmcnt(4)
    v_mfma_f32_16x16x32_bf16 v[68:71], v[112:115], a[128:131], v[68:71]
    v_mfma_f32_16x16x32_bf16 v[88:91], v[112:115], a[132:135], v[88:91]
    ds_read_b128 v[132:135], v96 offset:8192
    s_waitcnt lgkmcnt(4)
    v_mfma_f32_16x16x32_bf16 v[72:75], v[116:119], a[128:131], v[72:75]
    v_mfma_f32_16x16x32_bf16 v[92:95], v[116:119], a[132:135], v[92:95]
    ds_read_b128 v[136:139], v96 offset:9216
    buffer_load_dwordx4 v220, s[24:27], s69 offen offset:3072 lds
    s_waitcnt vmcnt(33)
    s_waitcnt lgkmcnt(4)
    v_mfma_f32_16x16x32_bf16 v[56:59], v[120:123], a[136:139], v[56:59]
    v_mfma_f32_16x16x32_bf16 v[76:79], v[120:123], a[140:143], v[76:79]
    ds_read_b128 v[100:103], v96 offset:10240
    s_add_u32 s69, s82, 137216
    s_add_u32 m0, s81, 55296
    s_nop 0
    buffer_load_dwordx4 v220, s[24:27], s69 offen offset:0 lds
    s_waitcnt lgkmcnt(4)
    v_mfma_f32_16x16x32_bf16 v[60:63], v[124:127], a[136:139], v[60:63]
    v_mfma_f32_16x16x32_bf16 v[80:83], v[124:127], a[140:143], v[80:83]
    ds_read_b128 v[104:107], v96 offset:11264
    s_waitcnt lgkmcnt(4)
    v_mfma_f32_16x16x32_bf16 v[64:67], v[128:131], a[136:139], v[64:67]
    v_mfma_f32_16x16x32_bf16 v[84:87], v[128:131], a[140:143], v[84:87]
    ds_read_b128 v[108:111], v96 offset:12288
    buffer_load_dwordx4 a[200:203], v220, s[24:27], s60 offen offset:1024 sc1
    buffer_load_dwordx4 a[204:207], v220, s[24:27], s61 offen offset:1024 sc1
    s_waitcnt lgkmcnt(4)
    v_mfma_f32_16x16x32_bf16 v[68:71], v[132:135], a[136:139], v[68:71]
    v_mfma_f32_16x16x32_bf16 v[88:91], v[132:135], a[140:143], v[88:91]
    ds_read_b128 v[112:115], v96 offset:13312
    s_waitcnt lgkmcnt(4)
    v_mfma_f32_16x16x32_bf16 v[72:75], v[136:139], a[136:139], v[72:75]
    v_mfma_f32_16x16x32_bf16 v[92:95], v[136:139], a[140:143], v[92:95]
    ds_read_b128 v[116:119], v96 offset:14336
    s_waitcnt vmcnt(20)
    s_barrier
    s_waitcnt lgkmcnt(4)
    v_mfma_f32_16x16x32_bf16 v[56:59], v[100:103], a[144:147], v[56:59]
    v_mfma_f32_16x16x32_bf16 v[76:79], v[100:103], a[148:151], v[76:79]
    ds_read_b128 v[120:123], v96 offset:15360
    s_waitcnt lgkmcnt(4)
    v_mfma_f32_16x16x32_bf16 v[60:63], v[104:107], a[144:147], v[60:63]
    v_mfma_f32_16x16x32_bf16 v[80:83], v[104:107], a[148:151], v[80:83]
    ds_read_b128 v[124:127], v96 offset:16384
    s_waitcnt lgkmcnt(4)
    v_mfma_f32_16x16x32_bf16 v[64:67], v[108:111], a[144:147], v[64:67]
    v_mfma_f32_16x16x32_bf16 v[84:87], v[108:111], a[148:151], v[84:87]
    ds_read_b128 v[128:131], v96 offset:17408
    buffer_load_dwordx4 a[208:211], v220, s[24:27], s60 offen offset:2048 sc1
    buffer_load_dwordx4 a[212:215], v220, s[24:27], s61 offen offset:2048 sc1
    s_waitcnt lgkmcnt(4)
    v_mfma_f32_16x16x32_bf16 v[68:71], v[112:115], a[144:147], v[68:71]
    v_mfma_f32_16x16x32_bf16 v[88:91], v[112:115], a[148:151], v[88:91]
    ds_read_b128 v[132:135], v96 offset:18432
    s_waitcnt lgkmcnt(4)
    v_mfma_f32_16x16x32_bf16 v[72:75], v[116:119], a[144:147], v[72:75]
    v_mfma_f32_16x16x32_bf16 v[92:95], v[116:119], a[148:151], v[92:95]
    ds_read_b128 v[136:139], v96 offset:19456
    s_waitcnt lgkmcnt(4)
    v_mfma_f32_16x16x32_bf16 v[56:59], v[120:123], a[152:155], v[56:59]
    v_mfma_f32_16x16x32_bf16 v[76:79], v[120:123], a[156:159], v[76:79]
    ds_read_b128 v[100:103], v96 offset:20480
    s_waitcnt lgkmcnt(4)
    v_mfma_f32_16x16x32_bf16 v[60:63], v[124:127], a[152:155], v[60:63]
    v_mfma_f32_16x16x32_bf16 v[80:83], v[124:127], a[156:159], v[80:83]
    ds_read_b128 v[104:107], v96 offset:21504
    s_waitcnt lgkmcnt(4)
    v_mfma_f32_16x16x32_bf16 v[64:67], v[128:131], a[152:155], v[64:67]
    v_mfma_f32_16x16x32_bf16 v[84:87], v[128:131], a[156:159], v[84:87]
    ds_read_b128 v[108:111], v96 offset:22528
    s_waitcnt lgkmcnt(4)
    v_mfma_f32_16x16x32_bf16 v[68:71], v[132:135], a[152:155], v[68:71]
    v_mfma_f32_16x16x32_bf16 v[88:91], v[132:135], a[156:159], v[88:91]
    ds_read_b128 v[112:115], v96 offset:23552
    s_waitcnt lgkmcnt(4)
    v_mfma_f32_16x16x32_bf16 v[72:75], v[136:139], a[152:155], v[72:75]
    v_mfma_f32_16x16x32_bf16 v[92:95], v[136:139], a[156:159], v[92:95]
    ds_read_b128 v[116:119], v96 offset:24576
    s_waitcnt lgkmcnt(4)
    v_mfma_f32_16x16x32_bf16 v[56:59], v[100:103], a[160:163], v[56:59]
    v_mfma_f32_16x16x32_bf16 v[76:79], v[100:103], a[164:167], v[76:79]
    ds_read_b128 v[120:123], v96 offset:25600
    s_waitcnt lgkmcnt(4)
    v_mfma_f32_16x16x32_bf16 v[60:63], v[104:107], a[160:163], v[60:63]
    v_mfma_f32_16x16x32_bf16 v[80:83], v[104:107], a[164:167], v[80:83]
    ds_read_b128 v[124:127], v96 offset:26624
    s_waitcnt lgkmcnt(4)
    v_mfma_f32_16x16x32_bf16 v[64:67], v[108:111], a[160:163], v[64:67]
    v_mfma_f32_16x16x32_bf16 v[84:87], v[108:111], a[164:167], v[84:87]
    ds_read_b128 v[128:131], v96 offset:27648
    s_waitcnt lgkmcnt(4)
    v_mfma_f32_16x16x32_bf16 v[68:71], v[112:115], a[160:163], v[68:71]
    v_mfma_f32_16x16x32_bf16 v[88:91], v[112:115], a[164:167], v[88:91]
    ds_read_b128 v[132:135], v96 offset:28672
    s_waitcnt lgkmcnt(4)
    v_mfma_f32_16x16x32_bf16 v[72:75], v[116:119], a[160:163], v[72:75]
    v_mfma_f32_16x16x32_bf16 v[92:95], v[116:119], a[164:167], v[92:95]
    ds_read_b128 v[136:139], v96 offset:29696
    s_waitcnt vmcnt(20)
    s_waitcnt lgkmcnt(4)
    v_mfma_f32_16x16x32_bf16 v[56:59], v[120:123], a[168:171], v[56:59]
    v_mfma_f32_16x16x32_bf16 v[76:79], v[120:123], a[172:175], v[76:79]
    ds_read_b128 v[100:103], v96 offset:30720
    s_waitcnt lgkmcnt(4)
    v_mfma_f32_16x16x32_bf16 v[60:63], v[124:127], a[168:171], v[60:63]
    v_mfma_f32_16x16x32_bf16 v[80:83], v[124:127], a[172:175], v[80:83]
    ds_read_b128 v[104:107], v96 offset:31744
    s_waitcnt lgkmcnt(4)
    v_mfma_f32_16x16x32_bf16 v[64:67], v[128:131], a[168:171], v[64:67]
    v_mfma_f32_16x16x32_bf16 v[84:87], v[128:131], a[172:175], v[84:87]
    ds_read_b128 v[108:111], v96 offset:32768
    s_waitcnt lgkmcnt(4)
    v_mfma_f32_16x16x32_bf16 v[68:71], v[132:135], a[168:171], v[68:71]
    v_mfma_f32_16x16x32_bf16 v[88:91], v[132:135], a[172:175], v[88:91]
    ds_read_b128 v[112:115], v96 offset:33792
    s_waitcnt lgkmcnt(4)
    v_mfma_f32_16x16x32_bf16 v[72:75], v[136:139], a[168:171], v[72:75]
    v_mfma_f32_16x16x32_bf16 v[92:95], v[136:139], a[172:175], v[92:95]
    ds_read_b128 v[116:119], v96 offset:34816
    s_waitcnt vmcnt(4)
    s_barrier
    s_waitcnt lgkmcnt(4)
    v_mfma_f32_16x16x32_bf16 v[56:59], v[100:103], a[176:179], v[56:59]
    v_mfma_f32_16x16x32_bf16 v[76:79], v[100:103], a[180:183], v[76:79]
    ds_read_b128 v[120:123], v96 offset:35840
    s_waitcnt lgkmcnt(4)
    v_mfma_f32_16x16x32_bf16 v[60:63], v[104:107], a[176:179], v[60:63]
    v_mfma_f32_16x16x32_bf16 v[80:83], v[104:107], a[180:183], v[80:83]
    ds_read_b128 v[124:127], v96 offset:36864
    s_waitcnt lgkmcnt(4)
    v_mfma_f32_16x16x32_bf16 v[64:67], v[108:111], a[176:179], v[64:67]
    v_mfma_f32_16x16x32_bf16 v[84:87], v[108:111], a[180:183], v[84:87]
    ds_read_b128 v[128:131], v96 offset:37888
    s_waitcnt lgkmcnt(4)
    v_mfma_f32_16x16x32_bf16 v[68:71], v[112:115], a[176:179], v[68:71]
    v_mfma_f32_16x16x32_bf16 v[88:91], v[112:115], a[180:183], v[88:91]
    ds_read_b128 v[132:135], v96 offset:38912
    s_waitcnt lgkmcnt(4)
    v_mfma_f32_16x16x32_bf16 v[72:75], v[116:119], a[176:179], v[72:75]
    v_mfma_f32_16x16x32_bf16 v[92:95], v[116:119], a[180:183], v[92:95]
    ds_read_b128 v[136:139], v96 offset:39936
    s_waitcnt lgkmcnt(4)
    v_mfma_f32_16x16x32_bf16 v[56:59], v[120:123], a[184:187], v[56:59]
    v_mfma_f32_16x16x32_bf16 v[76:79], v[120:123], a[188:191], v[76:79]
    ds_read_b128 v[100:103], v97 offset:0
    s_waitcnt lgkmcnt(4)
    v_mfma_f32_16x16x32_bf16 v[60:63], v[124:127], a[184:187], v[60:63]
    v_mfma_f32_16x16x32_bf16 v[80:83], v[124:127], a[188:191], v[80:83]
    ds_read_b128 v[104:107], v97 offset:1024
    s_waitcnt lgkmcnt(4)
    v_mfma_f32_16x16x32_bf16 v[64:67], v[128:131], a[184:187], v[64:67]
    v_mfma_f32_16x16x32_bf16 v[84:87], v[128:131], a[188:191], v[84:87]
    ds_read_b128 v[108:111], v97 offset:2048
    s_waitcnt lgkmcnt(4)
    v_mfma_f32_16x16x32_bf16 v[68:71], v[132:135], a[184:187], v[68:71]
    v_mfma_f32_16x16x32_bf16 v[88:91], v[132:135], a[188:191], v[88:91]
    ds_read_b128 v[112:115], v97 offset:3072
    s_waitcnt lgkmcnt(4)
    v_mfma_f32_16x16x32_bf16 v[72:75], v[136:139], a[184:187], v[72:75]
    v_mfma_f32_16x16x32_bf16 v[92:95], v[136:139], a[188:191], v[92:95]
    ds_read_b128 v[116:119], v97 offset:4096
    s_waitcnt lgkmcnt(4)
    v_mfma_f32_16x16x32_bf16 v[56:59], v[100:103], a[192:195], v[56:59]
    v_mfma_f32_16x16x32_bf16 v[76:79], v[100:103], a[196:199], v[76:79]
    ds_read_b128 v[120:123], v97 offset:5120
    s_waitcnt lgkmcnt(4)
    v_mfma_f32_16x16x32_bf16 v[60:63], v[104:107], a[192:195], v[60:63]
    v_mfma_f32_16x16x32_bf16 v[80:83], v[104:107], a[196:199], v[80:83]
    ds_read_b128 v[124:127], v97 offset:6144
    s_waitcnt lgkmcnt(4)
    v_mfma_f32_16x16x32_bf16 v[64:67], v[108:111], a[192:195], v[64:67]
    v_mfma_f32_16x16x32_bf16 v[84:87], v[108:111], a[196:199], v[84:87]
    ds_read_b128 v[128:131], v97 offset:7168
    s_waitcnt lgkmcnt(4)
    v_mfma_f32_16x16x32_bf16 v[68:71], v[112:115], a[192:195], v[68:71]
    v_mfma_f32_16x16x32_bf16 v[88:91], v[112:115], a[196:199], v[88:91]
    ds_read_b128 v[132:135], v97 offset:8192
    s_waitcnt lgkmcnt(4)
    v_mfma_f32_16x16x32_bf16 v[72:75], v[116:119], a[192:195], v[72:75]
    v_mfma_f32_16x16x32_bf16 v[92:95], v[116:119], a[196:199], v[92:95]
    ds_read_b128 v[136:139], v97 offset:9216
    s_waitcnt vmcnt(2)
    s_waitcnt lgkmcnt(4)
    v_mfma_f32_16x16x32_bf16 v[56:59], v[120:123], a[200:203], v[56:59]
    v_mfma_f32_16x16x32_bf16 v[76:79], v[120:123], a[204:207], v[76:79]
    ds_read_b128 v[100:103], v97 offset:10240
    s_waitcnt lgkmcnt(4)
    v_mfma_f32_16x16x32_bf16 v[60:63], v[124:127], a[200:203], v[60:63]
    v_mfma_f32_16x16x32_bf16 v[80:83], v[124:127], a[204:207], v[80:83]
    ds_read_b128 v[104:107], v97 offset:11264
    s_waitcnt lgkmcnt(4)
    v_mfma_f32_16x16x32_bf16 v[64:67], v[128:131], a[200:203], v[64:67]
    v_mfma_f32_16x16x32_bf16 v[84:87], v[128:131], a[204:207], v[84:87]
    ds_read_b128 v[108:111], v97 offset:12288
    s_waitcnt lgkmcnt(4)
    v_mfma_f32_16x16x32_bf16 v[68:71], v[132:135], a[200:203], v[68:71]
    v_mfma_f32_16x16x32_bf16 v[88:91], v[132:135], a[204:207], v[88:91]
    ds_read_b128 v[112:115], v97 offset:13312
    s_waitcnt lgkmcnt(4)
    v_mfma_f32_16x16x32_bf16 v[72:75], v[136:139], a[200:203], v[72:75]
    v_mfma_f32_16x16x32_bf16 v[92:95], v[136:139], a[204:207], v[92:95]
    ds_read_b128 v[116:119], v97 offset:14336
    s_waitcnt vmcnt(0)
    s_waitcnt lgkmcnt(4)
    v_mfma_f32_16x16x32_bf16 v[56:59], v[100:103], a[208:211], v[56:59]
    v_mfma_f32_16x16x32_bf16 v[76:79], v[100:103], a[212:215], v[76:79]
    s_waitcnt lgkmcnt(3)
    v_mfma_f32_16x16x32_bf16 v[60:63], v[104:107], a[208:211], v[60:63]
    v_mfma_f32_16x16x32_bf16 v[80:83], v[104:107], a[212:215], v[80:83]
    s_waitcnt lgkmcnt(2)
    v_mfma_f32_16x16x32_bf16 v[64:67], v[108:111], a[208:211], v[64:67]
    v_mfma_f32_16x16x32_bf16 v[84:87], v[108:111], a[212:215], v[84:87]
    s_waitcnt lgkmcnt(1)
    v_mfma_f32_16x16x32_bf16 v[68:71], v[112:115], a[208:211], v[68:71]
    v_mfma_f32_16x16x32_bf16 v[88:91], v[112:115], a[212:215], v[88:91]
    s_waitcnt lgkmcnt(0)
    v_mfma_f32_16x16x32_bf16 v[72:75], v[116:119], a[208:211], v[72:75]
    v_mfma_f32_16x16x32_bf16 v[92:95], v[116:119], a[212:215], v[92:95]
    s_waitcnt vmcnt(0)
    s_barrier
    s_mul_i32 s66, s3, 5120
    v_add_u32 v1, s66, v220
    s_xor_b32 s67, s3, 2
    s_mul_i32 s67, s67, 5120
    v_add_u32 v2, s67, v220
    ds_write_b128 v1, v[76:79] offset:0
    ds_write_b128 v1, v[80:83] offset:1024
    ds_write_b128 v1, v[84:87] offset:2048
    ds_write_b128 v1, v[88:91] offset:3072
    ds_write_b128 v1, v[92:95] offset:4096
    s_and_b32 s66, s3, 1
    s_lshl_b32 s66, s66, 5
    s_lshr_b32 s67, s3, 1
    s_lshl_b32 s67, s67, 4
    s_add_u32 s66, s66, s67
    s_lshl_b32 s67, s55, 6
    s_add_u32 s66, s66, s67
    s_mul_i32 s66, s66, 1280
    s_mul_i32 s67, s56, 160
    s_add_u32 s66, s66, s67
    s_waitcnt lgkmcnt(0)
    s_barrier
    ds_read_b128 v[100:103], v2 offset:0
    ds_read_b128 v[104:107], v2 offset:1024
    ds_read_b128 v[108:111], v2 offset:2048
    ds_read_b128 v[112:115], v2 offset:3072
    ds_read_b128 v[116:119], v2 offset:4096
    s_waitcnt lgkmcnt(4)
    v_pk_add_f32 v[56:57], v[56:57], v[100:101]
    v_pk_add_f32 v[58:59], v[58:59], v[102:103]
    s_waitcnt lgkmcnt(3)
    v_pk_add_f32 v[60:61], v[60:61], v[104:105]
    v_pk_add_f32 v[62:63], v[62:63], v[106:107]
    s_waitcnt lgkmcnt(2)
    v_pk_add_f32 v[64:65], v[64:65], v[108:109]
    v_pk_add_f32 v[66:67], v[66:67], v[110:111]
    s_waitcnt lgkmcnt(1)
    v_pk_add_f32 v[68:69], v[68:69], v[112:113]
    v_pk_add_f32 v[70:71], v[70:71], v[114:115]
    s_waitcnt lgkmcnt(0)
    v_pk_add_f32 v[72:73], v[72:73], v[116:117]
    v_pk_add_f32 v[74:75], v[74:75], v[118:119]
    v_cvt_pk_bf16_f32 v100, v56, v57
    v_cvt_pk_bf16_f32 v101, v58, v59
    v_cvt_pk_bf16_f32 v104, v60, v61
    v_cvt_pk_bf16_f32 v105, v62, v63
    v_cvt_pk_bf16_f32 v108, v64, v65
    v_cvt_pk_bf16_f32 v109, v66, v67
    v_cvt_pk_bf16_f32 v112, v68, v69
    v_cvt_pk_bf16_f32 v113, v70, v71
    v_cvt_pk_bf16_f32 v116, v72, v73
    v_cvt_pk_bf16_f32 v117, v74, v75
    ds_write_b64 v20, v[100:101] offset:0
    ds_write_b64 v20, v[104:105] offset:32
    ds_write_b64 v20, v[108:109] offset:64
    ds_write_b64 v20, v[112:113] offset:96
    ds_write_b64 v21, v[116:117] offset:0
    s_waitcnt lgkmcnt(0)
    ds_read_b128 v[128:131], v22
    ds_read_b128 v[132:135], v23
    ds_read_b128 v[136:139], v24
    s_waitcnt lgkmcnt(2)
    buffer_store_dwordx4 v[128:131], v25, s[28:31], s66 offen nt
    s_waitcnt lgkmcnt(1)
    buffer_store_dwordx4 v[132:135], v26, s[28:31], s66 offen nt
    s_waitcnt lgkmcnt(0)
    s_mov_b64 exec, 0xffffffff
    buffer_store_dwordx4 v[136:139], v27, s[28:31], s66 offen nt
    s_mov_b64 exec, -1
L_end:
    s_endpgm
L_rare_14:
    s_mov_b32 s42, 0
    v_mov_b32 v1, 0
L_nonce_16:
    global_load_dword v198, v1, s[36:37] sc1
    s_add_u32 s42, s42, 1
    s_waitcnt vmcnt(0)
    v_readfirstlane_b32 s40, v198
    s_cmp_gt_u32 s42, 0x40000
    s_cbranch_scc1 L_nonce_done_17
    s_cmp_eq_u32 s40, 0
    s_cbranch_scc1 L_nonce_16
L_nonce_done_17:
    s_branch L_back_15
L_rare_32:
    s_mov_b32 s42, 0
    v_mov_b32 v1, 0
L_nonce_34:
    global_load_dword v198, v1, s[36:37] sc1
    s_add_u32 s42, s42, 1
    s_waitcnt vmcnt(0)
    v_readfirstlane_b32 s40, v198
    s_cmp_gt_u32 s42, 0x40000
    s_cbranch_scc1 L_nonce_done_35
    s_cmp_eq_u32 s40, 0
    s_cbranch_scc1 L_nonce_34
L_nonce_done_35:
    s_branch L_back_33
L_rare_42:
    s_sub_u32 s66, 2, s53
    s_mul_i32 s67, s66, 10240
    s_mul_i32 s68, s66, 12288
    s_lshl_b32 s66, s3, 10
    v_add_u32 v1, s66, v220
    v_mov_b32 v100, 0
    v_mov_b32 v101, 0
    v_mov_b32 v102, 0
    v_mov_b32 v103, 0
    v_add_u32 v2, 0, v1
    v_cmp_gt_u32 vcc, s67, v2
    s_nop 0
    s_and_saveexec_b64 s[42:43], vcc
    ds_write_b128 v2, v[100:103] offset:10240
    s_mov_b64 exec, s[42:43]
    v_add_u32 v2, 4096, v1
    v_cmp_gt_u32 vcc, s67, v2
    s_nop 0
    s_and_saveexec_b64 s[42:43], vcc
    ds_write_b128 v2, v[100:103] offset:10240
    s_mov_b64 exec, s[42:43]
    v_add_u32 v2, 8192, v1
    v_cmp_gt_u32 vcc, s67, v2
    s_nop 0
    s_and_saveexec_b64 s[42:43], vcc
    ds_write_b128 v2, v[100:103] offset:10240
    s_mov_b64 exec, s[42:43]
    v_add_u32 v2, 12288, v1
    v_cmp_gt_u32 vcc, s67, v2
    s_nop 0
    s_and_saveexec_b64 s[42:43], vcc
    ds_write_b128 v2, v[100:103] offset:10240
    s_mov_b64 exec, s[42:43]
    v_add_u32 v2, 16384, v1
    v_cmp_gt_u32 vcc, s67, v2
    s_nop 0
    s_and_saveexec_b64 s[42:43], vcc
    ds_write_b128 v2, v[100:103] offset:10240
    s_mov_b64 exec, s[42:43]
    v_add_u32 v2, 0, v1
    v_cmp_gt_u32 vcc, s68, v2
    s_nop 0
    s_and_saveexec_b64 s[42:43], vcc
    ds_write_b128 v2, v[100:103] offset:40960
    s_mov_b64 exec, s[42:43]
    v_add_u32 v2, 4096, v1
    v_cmp_gt_u32 vcc, s68, v2
    s_nop 0
    s_and_saveexec_b64 s[42:43], vcc
    ds_write_b128 v2, v[100:103] offset:40960
    s_mov_b64 exec, s[42:43]
    v_add_u32 v2, 8192, v1
    v_cmp_gt_u32 vcc, s68, v2
    s_nop 0
    s_and_saveexec_b64 s[42:43], vcc
    ds_write_b128 v2, v[100:103] offset:40960
    s_mov_b64 exec, s[42:43]
    v_add_u32 v2, 12288, v1
    v_cmp_gt_u32 vcc, s68, v2
    s_nop 0
    s_and_saveexec_b64 s[42:43], vcc
    ds_write_b128 v2, v[100:103] offset:40960
    s_mov_b64 exec, s[42:43]
    v_add_u32 v2, 16384, v1
    v_cmp_gt_u32 vcc, s68, v2
    s_nop 0
    s_and_saveexec_b64 s[42:43], vcc
    ds_write_b128 v2, v[100:103] offset:40960
    s_mov_b64 exec, s[42:43]
    v_add_u32 v2, 20480, v1
    v_cmp_gt_u32 vcc, s68, v2
    s_nop 0
    s_and_saveexec_b64 s[42:43], vcc
    ds_write_b128 v2, v[100:103] offset:40960
    s_mov_b64 exec, s[42:43]
    s_branch L_back_43
L_rare_46:
    s_waitcnt vmcnt(0)
    s_branch L_back_47
L_rare_51:
    s_mov_b32 s42, 0
    s_mov_b64 exec, 0xffff
L_cwl_53:
    buffer_load_dword v177, v176, s[24:27], 0 offen sc1
    s_add_u32 s42, s42, 1
    s_waitcnt vmcnt(0)
    v_cmp_ne_u32 vcc, s40, v177
    s_cmp_gt_u32 s42, 0x40000
    s_cbranch_scc1 L_cwok_54
    s_nop 1
    s_cbranch_vccnz L_cwl_53
L_cwok_54:
    s_mov_b64 exec, -1
    s_branch L_back_52
L_rare_55:
    s_lshl_b32 s61, s53, 2
    s_add_u32 s61, s61, s3
    s_sub_u32 s61, 8, s61
    s_cmp_lt_i32 s61, 0
    s_cselect_b32 s61, 0, s61
    s_mov_b32 s60, s61
    s_mul_i32 s62, s61, 2560
    v_add_u32 v1, s62, v169
    v_add_u32 v1, 0, v1
    v_add_u32 v2, s62, v170
    s_mul_i32 s62, s61, 3072
    v_add_u32 v3, s62, v171
    v_mov_b32 v6, 0xff800000
L_fm_57:
    ds_read_b128 v[128:131], v1
    ds_read_b128 v[132:135], v2
    s_waitcnt lgkmcnt(0)
    s_cmp_eq_u32 s60, 0
    s_cbranch_scc1 L_f0_59
    s_cmp_eq_u32 s60, 8
    s_cbranch_scc1 L_f8_60
    v_mfma_f32_32x32x16_bf16 v[88:103], v[128:131], v[8:11], 0
    s_branch L_fj_61
L_f0_59:
    v_mfma_f32_32x32x16_bf16 v[88:103], v[128:131], v[8:11], v[40:55]
    s_branch L_fj_61
L_f8_60:
    v_mfma_f32_32x32x16_bf16 v[88:103], v[128:131], v[8:11], v[24:39]
L_fj_61:
    v_mfma_f32_32x32x16_bf16 v[88:103], v[132:135], v[12:15], v[88:103]
    s_nop 15
    v_max3_f32 v6, v6, v88, v89
    v_max3_f32 v6, v6, v90, v91
    v_max3_f32 v6, v6, v92, v93
    v_max3_f32 v6, v6, v94, v95
    v_max3_f32 v6, v6, v96, v97
    v_max3_f32 v6, v6, v98, v99
    v_max3_f32 v6, v6, v100, v101
    v_max3_f32 v6, v6, v102, v103
    v_add_u32 v1, 2560, v1
    v_add_u32 v2, 2560, v2
    v_add_u32 v3, 3072, v3
    s_add_u32 s60, s60, 1
    s_cmp_le_u32 s60, 8
    s_cbranch_scc1 L_fm_57
    v_mov_b32 v7, v6
    s_nop 1
    v_permlane32_swap_b32 v6, v7
    s_nop 1
    v_max_f32 v6, v6, v7
    s_mov_b32 s60, s61
    s_mul_i32 s62, s61, 2560
    v_add_u32 v1, s62, v169
    v_add_u32 v1, 0, v1
    v_add_u32 v2, s62, v170
    s_mul_i32 s62, s61, 3072
    v_add_u32 v3, s62, v171
    v_mov_b32 v56, 0
    v_mov_b32 v57, 0
    v_mov_b32 v58, 0
    v_mov_b32 v59, 0
    v_mov_b32 v60, 0
    v_mov_b32 v61, 0
    v_mov_b32 v62, 0
    v_mov_b32 v63, 0
    v_mov_b32 v64, 0
    v_mov_b32 v65, 0
    v_mov_b32 v66, 0
    v_mov_b32 v67, 0
    v_mov_b32 v68, 0
    v_mov_b32 v69, 0
    v_mov_b32 v70, 0
    v_mov_b32 v71, 0
L_fp_58:
    ds_read_b128 v[128:131], v1
    ds_read_b128 v[132:135], v2
    s_waitcnt lgkmcnt(0)
    s_cmp_eq_u32 s60, 0
    s_cbranch_scc1 L_f0_62
    s_cmp_eq_u32 s60, 8
    s_cbranch_scc1 L_f8_63
    v_mfma_f32_32x32x16_bf16 v[88:103], v[128:131], v[8:11], 0
    s_branch L_fj_64
L_f0_62:
    v_mfma_f32_32x32x16_bf16 v[88:103], v[128:131], v[8:11], v[40:55]
    s_branch L_fj_64
L_f8_63:
    v_mfma_f32_32x32x16_bf16 v[88:103], v[128:131], v[8:11], v[24:39]
L_fj_64:
    v_mfma_f32_32x32x16_bf16 v[88:103], v[132:135], v[12:15], v[88:103]
    s_nop 15
    ds_read_b64_tr_b16 v[144:145], v3 offset:0
    ds_read_b64_tr_b16 v[146:147], v3 offset:768
    ds_read_b64_tr_b16 v[148:149], v3 offset:1536
    ds_read_b64_tr_b16 v[150:151], v3 offset:2304
    v_sub_f32 v88, v88, v6
    v_sub_f32 v89, v89, v6
    v_sub_f32 v90, v90, v6
    v_sub_f32 v91, v91, v6
    v_sub_f32 v92, v92, v6
    v_sub_f32 v93, v93, v6
    v_sub_f32 v94, v94, v6
    v_sub_f32 v95, v95, v6
    v_sub_f32 v96, v96, v6
    v_sub_f32 v97, v97, v6
    v_sub_f32 v98, v98, v6
    v_sub_f32 v99, v99, v6
    v_sub_f32 v100, v100, v6
    v_sub_f32 v101, v101, v6
    v_sub_f32 v102, v102, v6
    v_sub_f32 v103, v103, v6
    v_exp_f32 v88, v88
    v_exp_f32 v89, v89
    v_exp_f32 v90, v90
    v_exp_f32 v91, v91
    v_exp_f32 v92, v92
    v_exp_f32 v93, v93
    v_exp_f32 v94, v94
    v_exp_f32 v95, v95
    v_exp_f32 v96, v96
    v_exp_f32 v97, v97
    v_exp_f32 v98, v98
    v_exp_f32 v99, v99
    v_exp_f32 v100, v100
    v_exp_f32 v101, v101
    v_exp_f32 v102, v102
    v_exp_f32 v103, v103
    s_nop 0
    v_cvt_pk_bf16_f32 v120, v88, v89
    v_cvt_pk_bf16_f32 v121, v90, v91
    v_cvt_pk_bf16_f32 v122, v92, v93
    v_cvt_pk_bf16_f32 v123, v94, v95
    v_cvt_pk_bf16_f32 v124, v96, v97
    v_cvt_pk_bf16_f32 v125, v98, v99
    v_cvt_pk_bf16_f32 v126, v100, v101
    v_cvt_pk_bf16_f32 v127, v102, v103
    s_waitcnt lgkmcnt(0)
    s_nop 1
    v_mfma_f32_32x32x16_bf16 v[56:71], v[144:147], v[120:123], v[56:71]
    v_mfma_f32_32x32x16_bf16 v[56:71], v[148:151], v[124:127], v[56:71]
    v_add_u32 v1, 2560, v1
    v_add_u32 v2, 2560, v2
    v_add_u32 v3, 3072, v3
    s_add_u32 s60, s60, 1
    s_cmp_le_u32 s60, 8
    s_cbranch_scc1 L_fp_58
    s_nop 15
    s_mov_b32 s60, s61
    s_mul_i32 s62, s61, 2560
    v_add_u32 v1, s62, v169
    v_add_u32 v1, 48, v1
    v_add_u32 v2, s62, v170
    s_mul_i32 s62, s61, 3072
    v_add_u32 v3, s62, v172
    v_mov_b32 v6, 0xff800000
L_fm_65:
    ds_read_b128 v[128:131], v1
    ds_read_b128 v[132:135], v2
    s_waitcnt lgkmcnt(0)
    s_cmp_eq_u32 s60, 0
    s_cbranch_scc1 L_f0_67
    s_cmp_eq_u32 s60, 8
    s_cbranch_scc1 L_f8_68
    v_mfma_f32_32x32x16_bf16 v[88:103], v[128:131], v[16:19], 0
    s_branch L_fj_69
L_f0_67:
    v_mfma_f32_32x32x16_bf16 v[88:103], v[128:131], v[16:19], v[40:55]
    s_branch L_fj_69
L_f8_68:
    v_mfma_f32_32x32x16_bf16 v[88:103], v[128:131], v[16:19], v[24:39]
L_fj_69:
    v_mfma_f32_32x32x16_bf16 v[88:103], v[132:135], v[20:23], v[88:103]
    s_nop 15
    v_max3_f32 v6, v6, v88, v89
    v_max3_f32 v6, v6, v90, v91
    v_max3_f32 v6, v6, v92, v93
    v_max3_f32 v6, v6, v94, v95
    v_max3_f32 v6, v6, v96, v97
    v_max3_f32 v6, v6, v98, v99
    v_max3_f32 v6, v6, v100, v101
    v_max3_f32 v6, v6, v102, v103
    v_add_u32 v1, 2560, v1
    v_add_u32 v2, 2560, v2
    v_add_u32 v3, 3072, v3
    s_add_u32 s60, s60, 1
    s_cmp_le_u32 s60, 8
    s_cbranch_scc1 L_fm_65
    v_mov_b32 v7, v6
    s_nop 1
    v_permlane32_swap_b32 v6, v7
    s_nop 1
    v_max_f32 v6, v6, v7
    s_mov_b32 s60, s61
    s_mul_i32 s62, s61, 2560
    v_add_u32 v1, s62, v169
    v_add_u32 v1, 48, v1
    v_add_u32 v2, s62, v170
    s_mul_i32 s62, s61, 3072
    v_add_u32 v3, s62, v172
    v_mov_b32 v72, 0
    v_mov_b32 v73, 0
    v_mov_b32 v74, 0
    v_mov_b32 v75, 0
    v_mov_b32 v76, 0
    v_mov_b32 v77, 0
    v_mov_b32 v78, 0
    v_mov_b32 v79, 0
    v_mov_b32 v80, 0
    v_mov_b32 v81, 0
    v_mov_b32 v82, 0
    v_mov_b32 v83, 0
    v_mov_b32 v84, 0
    v_mov_b32 v85, 0
    v_mov_b32 v86, 0
    v_mov_b32 v87, 0
L_fp_66:
    ds_read_b128 v[128:131], v1
    ds_read_b128 v[132:135], v2
    s_waitcnt lgkmcnt(0)
    s_cmp_eq_u32 s60, 0
    s_cbranch_scc1 L_f0_70
    s_cmp_eq_u32 s60, 8
    s_cbranch_scc1 L_f8_71
    v_mfma_f32_32x32x16_bf16 v[88:103], v[128:131], v[16:19], 0
    s_branch L_fj_72
L_f0_70:
    v_mfma_f32_32x32x16_bf16 v[88:103], v[128:131], v[16:19], v[40:55]
    s_branch L_fj_72
L_f8_71:
    v_mfma_f32_32x32x16_bf16 v[88:103], v[128:131], v[16:19], v[24:39]
L_fj_72:
    v_mfma_f32_32x32x16_bf16 v[88:103], v[132:135], v[20:23], v[88:103]
    s_nop 15
    ds_read_b64_tr_b16 v[144:145], v3 offset:0
    ds_read_b64_tr_b16 v[146:147], v3 offset:768
    ds_read_b64_tr_b16 v[148:149], v3 offset:1536
    ds_read_b64_tr_b16 v[150:151], v3 offset:2304
    v_sub_f32 v88, v88, v6
    v_sub_f32 v89, v89, v6
    v_sub_f32 v90, v90, v6
    v_sub_f32 v91, v91, v6
    v_sub_f32 v92, v92, v6
    v_sub_f32 v93, v93, v6
    v_sub_f32 v94, v94, v6
    v_sub_f32 v95, v95, v6
    v_sub_f32 v96, v96, v6
    v_sub_f32 v97, v97, v6
    v_sub_f32 v98, v98, v6
    v_sub_f32 v99, v99, v6
    v_sub_f32 v100, v100, v6
    v_sub_f32 v101, v101, v6
    v_sub_f32 v102, v102, v6
    v_sub_f32 v103, v103, v6
    v_exp_f32 v88, v88
    v_exp_f32 v89, v89
    v_exp_f32 v90, v90
    v_exp_f32 v91, v91
    v_exp_f32 v92, v92
    v_exp_f32 v93, v93
    v_exp_f32 v94, v94
    v_exp_f32 v95, v95
    v_exp_f32 v96, v96
    v_exp_f32 v97, v97
    v_exp_f32 v98, v98
    v_exp_f32 v99, v99
    v_exp_f32 v100, v100
    v_exp_f32 v101, v101
    v_exp_f32 v102, v102
    v_exp_f32 v103, v103
    s_nop 0
    v_cvt_pk_bf16_f32 v120, v88, v89
    v_cvt_pk_bf16_f32 v121, v90, v91
    v_cvt_pk_bf16_f32 v122, v92, v93
    v_cvt_pk_bf16_f32 v123, v94, v95
    v_cvt_pk_bf16_f32 v124, v96, v97
    v_cvt_pk_bf16_f32 v125, v98, v99
    v_cvt_pk_bf16_f32 v126, v100, v101
    v_cvt_pk_bf16_f32 v127, v102, v103
    s_waitcnt lgkmcnt(0)
    s_nop 1
    v_mfma_f32_32x32x16_bf16 v[72:87], v[144:147], v[120:123], v[72:87]
    v_mfma_f32_32x32x16_bf16 v[72:87], v[148:151], v[124:127], v[72:87]
    v_add_u32 v1, 2560, v1
    v_add_u32 v2, 2560, v2
    v_add_u32 v3, 3072, v3
    s_add_u32 s60, s60, 1
    s_cmp_le_u32 s60, 8
    s_cbranch_scc1 L_fp_66
    s_nop 15
    s_branch L_back_56
L_alt_73:
    buffer_store_dwordx4 v[128:131], v8, s[24:27], s60 offen sc1
    buffer_store_dwordx4 v[132:135], v9, s[24:27], s60 offen sc1
    s_mov_b32 exec_lo, 0
    buffer_store_dwordx4 v[136:139], v10, s[24:27], s60 offen sc1
    s_mov_b64 exec, -1
    s_branch L_join_74
L_alt_76:
    s_lshl_b32 s42, s83, 6
    s_add_u32 s42, s42, 16384
    v_mov_b32 v1, 0
    v_mov_b32 v2, s40
    s_mov_b64 exec, 1
    buffer_store_dword v2, v1, s[24:27], s42 offen sc1
    s_mov_b64 exec, -1
    s_branch L_join_77
L_rare_81:
    s_mov_b32 s42, 0
    s_mov_b64 exec, 0xffffffff
L_cwl_83:
    buffer_load_dword v9, v8, s[24:27], 0 offen sc1
    s_add_u32 s42, s42, 1
    s_waitcnt vmcnt(0)
    v_cmp_ne_u32 vcc, s40, v9
    s_cmp_gt_u32 s42, 0x40000
    s_cbranch_scc1 L_cwok_84
    s_nop 1
    s_cbranch_vccnz L_cwl_83
L_cwok_84:
    s_mov_b64 exec, -1
    s_branch L_back_82
L_alt_85:
    buffer_store_dwordx4 v[200:203], v220, s[24:27], s62 offen sc1
    buffer_store_dwordx4 v[204:207], v220, s[24:27], s62 offen offset:1024 sc1
    buffer_store_dwordx2 v[208:209], v220, s[24:27], s63 offen sc1
    s_branch L_join_86
L_alt_87:
    s_mov_b64 exec, 0xffff
    buffer_store_dwordx2 v[4:5], v3, s[24:27], s61 offen sc1
    s_mov_b64 exec, -1
    s_branch L_join_88
L_alt_90:
    s_lshl_b32 s42, s83, 6
    s_add_u32 s42, s42, 32768
    v_mov_b32 v1, 0
    v_mov_b32 v2, s40
    s_mov_b64 exec, 1
    buffer_store_dword v2, v1, s[24:27], s42 offen sc1
    s_mov_b64 exec, -1
    s_branch L_join_91
L_alt_95:
    s_cmp_lt_u32 s54, 12
    s_cbranch_scc0 L_nohalf_98
    s_add_u32 s62, s61, 0
    buffer_store_dwordx2 v[152:153], v220, s[24:27], s62 offen sc1
    s_add_u32 s62, s61, 55296
    buffer_store_dwordx2 v[166:167], v220, s[24:27], s62 offen sc1
L_nohalf_98:
    s_add_u32 s62, s60, 0
    buffer_store_dwordx4 v[140:143], v220, s[24:27], s62 offen sc1
    s_add_u32 s62, s60, 1024
    buffer_store_dwordx4 v[144:147], v220, s[24:27], s62 offen sc1
    s_add_u32 s62, s60, 2048
    buffer_store_dwordx4 v[148:151], v220, s[24:27], s62 offen sc1
    s_add_u32 s62, s60, 55296
    buffer_store_dwordx4 v[154:157], v220, s[24:27], s62 offen sc1
    s_add_u32 s62, s60, 56320
    buffer_store_dwordx4 v[158:161], v220, s[24:27], s62 offen sc1
    s_add_u32 s62, s60, 57344
    buffer_store_dwordx4 v[162:165], v220, s[24:27], s62 offen sc1
    s_branch L_join_96
L_alt_100:
    s_lshl_b32 s42, s83, 6
    s_add_u32 s42, s42, 49152
    v_mov_b32 v1, 0
    v_mov_b32 v2, s40
    s_mov_b64 exec, 1
    buffer_store_dword v2, v1, s[24:27], s42 offen sc1
    s_mov_b64 exec, -1
    s_branch L_join_101
L_codeend:
    s_endpgm
    .p2align 8
    .type L_qtab,@object
L_qtab:
    .long 0x50000, 0xd0001, 0x150002, 0x1d0003, 0x250004, 0x8d0005, 0x950006, 0x9d0007
    .long 0xa50008, 0xad0009, 0x115000a, 0x11d000b, 0x125000c, 0x12d000d, 0x135000e, 0x19d000f
    .long 0x1a50010, 0x1ad0011, 0x1b50012, 0x1bd0013, 0x2250014, 0x22d0015, 0x2350016, 0x23d0017
    .long 0x2450018, 0x2ad0019, 0x2b5001a, 0x2bd001b, 0x2c5001c, 0x2cd001d, 0x335001e, 0x33d001f
    .long 0x3450020, 0x34d0021, 0x3550022, 0x3bd0023, 0x3c50024, 0x3cd0025, 0x3d50026, 0x3dd0027
    .long 0x4450028, 0x44d0029, 0x455002a, 0x45d002b, 0x465002c, 0x4cd002d, 0x4d5002e, 0x4dd002f
    .long 0x4e50030, 0x4ed0031, 0x5550032, 0x55d0033, 0x5650034, 0x56d0035, 0x5750036, 0x5dd0037
    .long 0x5e50038, 0x5ed0039, 0x5f5003a, 0x5fd003b, 0x665003c, 0x66d003d, 0x675003e, 0x67d003f
    .long 0x6850040, 0x6ed0041, 0x6f50042, 0x6fd0043, 0x7050044, 0x70d0045, 0x7750046, 0x77d0047
    .long 0x7850048, 0x78d0049, 0x795004a, 0x7fd004b, 0x805004c, 0x80d004d, 0x815004e, 0x81d004f
    .long 0x8850050, 0x88d0051, 0x8950052, 0x89d0053, 0x8a50054, 0x90d0055, 0x9150056, 0x91d0057
    .long 0x9250058, 0x92d0059, 0x995005a, 0x99d005b, 0x9a5005c, 0x9ad005d, 0x9b5005e, 0xa1d005f
    .long 0xa250060, 0xa2d0061, 0xa350062, 0xa3d0063, 0xaa50064, 0xaad0065, 0xab50066, 0xabd0067
    .long 0xac50068, 0xb2d0069, 0xb35006a, 0xb3d006b, 0xb45006c, 0xb4d006d, 0xbb5006e, 0xbbd006f
    .long 0xbc50070, 0xbcd0071, 0xbd50072, 0xc3d0073, 0xc450074, 0xc4d0075, 0xc550076, 0xc5d0077
    .long 0xcc50078, 0xccd0079, 0xcd5007a, 0xcdd007b, 0xce5007c, 0xd4d007d, 0xd55007e, 0xd5d007f
    .long 0xd650080, 0xd6d0081, 0xdd50082, 0xddd0083, 0xde50084, 0xded0085, 0xdf50086, 0xe5d0087
    .long 0xe650088, 0xe6d0089, 0xe75008a, 0xe7d008b, 0xee5008c, 0xeed008d, 0xef5008e, 0xefd008f
    .long 0xf050090, 0xf6d0091, 0xf750092, 0xf7d0093, 0xf850094, 0xf8d0095, 0xff50096, 0xffd0097
    .long 0x10050098, 0x100d0099, 0x1015009a, 0x107d009b, 0x1085009c, 0x108d009d, 0x1095009e, 0x109d009f
    .long 0x2d0280, 0x350281, 0x3d0282, 0x450283, 0x4d0284, 0xb50285, 0xbd0286, 0xc50287
    .long 0xcd0288, 0xd50289, 0x13d028a, 0x145028b, 0x14d028c, 0x155028d, 0x15d028e, 0x1c5028f
    .long 0x1cd0290, 0x1d50291, 0x1dd0292, 0x1e50293, 0x24d0294, 0x2550295, 0x25d0296, 0x2650297
    .long 0x26d0298, 0x2d50299, 0x2dd029a, 0x2e5029b, 0x2ed029c, 0x2f5029d, 0x35d029e, 0x365029f
    .long 0x36d02a0, 0x37502a1, 0x37d02a2, 0x3e502a3, 0x3ed02a4, 0x3f502a5, 0x3fd02a6, 0x40502a7
    .long 0x46d02a8, 0x47502a9, 0x47d02aa, 0x48502ab, 0x48d02ac, 0x4f502ad, 0x4fd02ae, 0x50502af
    .long 0x50d02b0, 0x51502b1, 0x57d02b2, 0x58502b3, 0x58d02b4, 0x59502b5, 0x59d02b6, 0x60502b7
    .long 0x60d02b8, 0x61502b9, 0x61d02ba, 0x62502bb, 0x68d02bc, 0x69502bd, 0x69d02be, 0x6a502bf
    .long 0x6ad02c0, 0x71502c1, 0x71d02c2, 0x72502c3, 0x72d02c4, 0x73502c5, 0x79d02c6, 0x7a502c7
    .long 0x7ad02c8, 0x7b502c9, 0x7bd02ca, 0x82502cb, 0x82d02cc, 0x83502cd, 0x83d02ce, 0x84502cf
    .long 0x8ad02d0, 0x8b502d1, 0x8bd02d2, 0x8c502d3, 0x8cd02d4, 0x93502d5, 0x93d02d6, 0x94502d7
    .long 0x94d02d8, 0x95502d9, 0x9bd02da, 0x9c502db, 0x9cd02dc, 0x9d502dd, 0x9dd02de, 0xa4502df
    .long 0xa4d02e0, 0xa5502e1, 0xa5d02e2, 0xa6502e3, 0xacd02e4, 0xad502e5, 0xadd02e6, 0xae502e7
    .long 0xaed02e8, 0xb5502e9, 0xb5d02ea, 0xb6502eb, 0xb6d02ec, 0xb7502ed, 0xbdd02ee, 0xbe502ef
    .long 0xbed02f0, 0xbf502f1, 0xbfd02f2, 0xc6502f3, 0xc6d02f4, 0xc7502f5, 0xc7d02f6, 0xc8502f7
    .long 0xced02f8, 0xcf502f9, 0xcfd02fa, 0xd0502fb, 0xd0d02fc, 0xd7502fd, 0xd7d02fe, 0xd8502ff
    .long 0xd8d0300, 0xd950301, 0xdfd0302, 0xe050303, 0xe0d0304, 0xe150305, 0xe1d0306, 0xe850307
    .long 0xe8d0308, 0xe950309, 0xe9d030a, 0xea5030b, 0xf0d030c, 0xf15030d, 0xf1d030e, 0xf25030f
    .long 0xf2d0310, 0xf950311, 0xf9d0312, 0xfa50313, 0xfad0314, 0xfb50315, 0x101d0316, 0x10250317
    .long 0x102d0318, 0x10350319, 0x103d031a, 0x10a5031b, 0x10ad031c, 0x10b5031d, 0x10bd031e, 0x10c5031f
    .long 0x550500, 0x5d0501, 0x650502, 0x6d0503, 0x750504, 0xdd0505, 0xe50506, 0xed0507
    .long 0xf50508, 0xfd0509, 0x165050a, 0x16d050b, 0x175050c, 0x17d050d, 0x185050e, 0x1ed050f
    .long 0x1f50510, 0x1fd0511, 0x2050512, 0x20d0513, 0x2750514, 0x27d0515, 0x2850516, 0x28d0517
    .long 0x2950518, 0x2fd0519, 0x305051a, 0x30d051b, 0x315051c, 0x31d051d, 0x385051e, 0x38d051f
    .long 0x3950520, 0x39d0521, 0x3a50522, 0x40d0523, 0x4150524, 0x41d0525, 0x4250526, 0x42d0527
    .long 0x4950528, 0x49d0529, 0x4a5052a, 0x4ad052b, 0x4b5052c, 0x51d052d, 0x525052e, 0x52d052f
    .long 0x5350530, 0x53d0531, 0x5a50532, 0x5ad0533, 0x5b50534, 0x5bd0535, 0x5c50536, 0x62d0537
    .long 0x6350538, 0x63d0539, 0x645053a, 0x64d053b, 0x6b5053c, 0x6bd053d, 0x6c5053e, 0x6cd053f
    .long 0x6d50540, 0x73d0541, 0x7450542, 0x74d0543, 0x7550544, 0x75d0545, 0x7c50546, 0x7cd0547
    .long 0x7d50548, 0x7dd0549, 0x7e5054a, 0x84d054b, 0x855054c, 0x85d054d, 0x865054e, 0x86d054f
    .long 0x8d50550, 0x8dd0551, 0x8e50552, 0x8ed0553, 0x8f50554, 0x95d0555, 0x9650556, 0x96d0557
    .long 0x9750558, 0x97d0559, 0x9e5055a, 0x9ed055b, 0x9f5055c, 0x9fd055d, 0xa05055e, 0xa6d055f
    .long 0xa750560, 0xa7d0561, 0xa850562, 0xa8d0563, 0xaf50564, 0xafd0565, 0xb050566, 0xb0d0567
    .long 0xb150568, 0xb7d0569, 0xb85056a, 0xb8d056b, 0xb95056c, 0xb9d056d, 0xc05056e, 0xc0d056f
    .long 0xc150570, 0xc1d0571, 0xc250572, 0xc8d0573, 0xc950574, 0xc9d0575, 0xca50576, 0xcad0577
    .long 0xd150578, 0xd1d0579, 0xd25057a, 0xd2d057b, 0xd35057c, 0xd9d057d, 0xda5057e, 0xdad057f
    .long 0xdb50580, 0xdbd0581, 0xe250582, 0xe2d0583, 0xe350584, 0xe3d0585, 0xe450586, 0xead0587
    .long 0xeb50588, 0xebd0589, 0xec5058a, 0xecd058b, 0xf35058c, 0xf3d058d, 0xf45058e, 0xf4d058f
    .long 0xf550590, 0xfbd0591, 0xfc50592, 0xfcd0593, 0xfd50594, 0xfdd0595, 0x10450596, 0x104d0597
    .long 0x10550598, 0x105d0599, 0x1065059a, 0x10cd059b, 0x10d5059c, 0x10dd059d, 0x10e5059e, 0x10ed059f
    .long 0x790780, 0x1010781, 0x1890782, 0x2110783, 0x2990784, 0x3210785, 0x3a90786, 0x4310787
    .long 0x4b90788, 0x5410789, 0x5c9078a, 0x651078b, 0x6d9078c, 0x761078d, 0x7e9078e, 0x871078f
    .long 0x8f90790, 0x9810791, 0xa090792, 0xa910793, 0xb190794, 0xba10795, 0xc290796, 0xcb10797
    .long 0xd390798, 0xdc10799, 0xe49079a, 0xed1079b, 0xf59079c, 0xfe1079d, 0x1069079e, 0x10f1079f
    .long 0x40080, 0xc0081, 0x140082, 0x1c0083, 0x8c0084, 0x940085, 0x9c0086, 0xa40087
    .long 0x1140088, 0x11c0089, 0x124008a, 0x12c008b, 0x19c008c, 0x1a4008d, 0x1ac008e, 0x1b4008f
    .long 0x2240090, 0x22c0091, 0x2340092, 0x23c0093, 0x2ac0094, 0x2b40095, 0x2bc0096, 0x2c40097
    .long 0x3340098, 0x33c0099, 0x344009a, 0x34c009b, 0x3bc009c, 0x3c4009d, 0x3cc009e, 0x3d4009f
    .long 0x44400a0, 0x44c00a1, 0x45400a2, 0x45c00a3, 0x4cc00a4, 0x4d400a5, 0x4dc00a6, 0x4e400a7
    .long 0x55400a8, 0x55c00a9, 0x56400aa, 0x56c00ab, 0x5dc00ac, 0x5e400ad, 0x5ec00ae, 0x5f400af
    .long 0x66400b0, 0x66c00b1, 0x67400b2, 0x67c00b3, 0x6ec00b4, 0x6f400b5, 0x6fc00b6, 0x70400b7
    .long 0x77400b8, 0x77c00b9, 0x78400ba, 0x78c00bb, 0x7fc00bc, 0x80400bd, 0x80c00be, 0x81400bf
    .long 0x88400c0, 0x88c00c1, 0x89400c2, 0x89c00c3, 0x90c00c4, 0x91400c5, 0x91c00c6, 0x92400c7
    .long 0x99400c8, 0x99c00c9, 0x9a400ca, 0x9ac00cb, 0xa1c00cc, 0xa2400cd, 0xa2c00ce, 0xa3400cf
    .long 0xaa400d0, 0xaac00d1, 0xab400d2, 0xabc00d3, 0xb2c00d4, 0xb3400d5, 0xb3c00d6, 0xb4400d7
    .long 0xbb400d8, 0xbbc00d9, 0xbc400da, 0xbcc00db, 0xc3c00dc, 0xc4400dd, 0xc4c00de, 0xc5400df
    .long 0xcc400e0, 0xccc00e1, 0xcd400e2, 0xcdc00e3, 0xd4c00e4, 0xd5400e5, 0xd5c00e6, 0xd6400e7
    .long 0xdd400e8, 0xddc00e9, 0xde400ea, 0xdec00eb, 0xe5c00ec, 0xe6400ed, 0xe6c00ee, 0xe7400ef
    .long 0xee400f0, 0xeec00f1, 0xef400f2, 0xefc00f3, 0xf6c00f4, 0xf7400f5, 0xf7c00f6, 0xf8400f7
    .long 0xff400f8, 0xffc00f9, 0x100400fa, 0x100c00fb, 0x107c00fc, 0x108400fd, 0x108c00fe, 0x109400ff
    .long 0x250280, 0x2d0281, 0x350282, 0x3d0283, 0x450284, 0xad0285, 0xb50286, 0xbd0287
    .long 0xc50288, 0xcd0289, 0x135028a, 0x13d028b, 0x145028c, 0x14d028d, 0x155028e, 0x1bd028f
    .long 0x1c50290, 0x1cd0291, 0x1d50292, 0x1dd0293, 0x2450294, 0x24d0295, 0x2550296, 0x25d0297
    .long 0x2650298, 0x2cd0299, 0x2d5029a, 0x2dd029b, 0x2e5029c, 0x2ed029d, 0x355029e, 0x35d029f
    .long 0x36502a0, 0x36d02a1, 0x37502a2, 0x3dd02a3, 0x3e502a4, 0x3ed02a5, 0x3f502a6, 0x3fd02a7
    .long 0x46502a8, 0x46d02a9, 0x47502aa, 0x47d02ab, 0x48502ac, 0x4ed02ad, 0x4f502ae, 0x4fd02af
    .long 0x50502b0, 0x50d02b1, 0x57502b2, 0x57d02b3, 0x58502b4, 0x58d02b5, 0x59502b6, 0x5fd02b7
    .long 0x60502b8, 0x60d02b9, 0x61502ba, 0x61d02bb, 0x68502bc, 0x68d02bd, 0x69502be, 0x69d02bf
    .long 0x6a502c0, 0x70d02c1, 0x71502c2, 0x71d02c3, 0x72502c4, 0x72d02c5, 0x79502c6, 0x79d02c7
    .long 0x7a502c8, 0x7ad02c9, 0x7b502ca, 0x81d02cb, 0x82502cc, 0x82d02cd, 0x83502ce, 0x83d02cf
    .long 0x8a502d0, 0x8ad02d1, 0x8b502d2, 0x8bd02d3, 0x8c502d4, 0x92d02d5, 0x93502d6, 0x93d02d7
    .long 0x94502d8, 0x94d02d9, 0x9b502da, 0x9bd02db, 0x9c502dc, 0x9cd02dd, 0x9d502de, 0xa3d02df
    .long 0xa4502e0, 0xa4d02e1, 0xa5502e2, 0xa5d02e3, 0xac502e4, 0xacd02e5, 0xad502e6, 0xadd02e7
    .long 0xae502e8, 0xb4d02e9, 0xb5502ea, 0xb5d02eb, 0xb6502ec, 0xb6d02ed, 0xbd502ee, 0xbdd02ef
    .long 0xbe502f0, 0xbed02f1, 0xbf502f2, 0xc5d02f3, 0xc6502f4, 0xc6d02f5, 0xc7502f6, 0xc7d02f7
    .long 0xce502f8, 0xced02f9, 0xcf502fa, 0xcfd02fb, 0xd0502fc, 0xd6d02fd, 0xd7502fe, 0xd7d02ff
    .long 0xd850300, 0xd8d0301, 0xdf50302, 0xdfd0303, 0xe050304, 0xe0d0305, 0xe150306, 0xe7d0307
    .long 0xe850308, 0xe8d0309, 0xe95030a, 0xe9d030b, 0xf05030c, 0xf0d030d, 0xf15030e, 0xf1d030f
    .long 0xf250310, 0xf8d0311, 0xf950312, 0xf9d0313, 0xfa50314, 0xfad0315, 0x10150316, 0x101d0317
    .long 0x10250318, 0x102d0319, 0x1035031a, 0x109d031b, 0x10a5031c, 0x10ad031d, 0x10b5031e, 0x10bd031f
    .long 0x4d0500, 0x550501, 0x5d0502, 0x650503, 0x6d0504, 0xd50505, 0xdd0506, 0xe50507
    .long 0xed0508, 0xf50509, 0x15d050a, 0x165050b, 0x16d050c, 0x175050d, 0x17d050e, 0x1e5050f
    .long 0x1ed0510, 0x1f50511, 0x1fd0512, 0x2050513, 0x26d0514, 0x2750515, 0x27d0516, 0x2850517
    .long 0x28d0518, 0x2f50519, 0x2fd051a, 0x305051b, 0x30d051c, 0x315051d, 0x37d051e, 0x385051f
    .long 0x38d0520, 0x3950521, 0x39d0522, 0x4050523, 0x40d0524, 0x4150525, 0x41d0526, 0x4250527
    .long 0x48d0528, 0x4950529, 0x49d052a, 0x4a5052b, 0x4ad052c, 0x515052d, 0x51d052e, 0x525052f
    .long 0x52d0530, 0x5350531, 0x59d0532, 0x5a50533, 0x5ad0534, 0x5b50535, 0x5bd0536, 0x6250537
    .long 0x62d0538, 0x6350539, 0x63d053a, 0x645053b, 0x6ad053c, 0x6b5053d, 0x6bd053e, 0x6c5053f
    .long 0x6cd0540, 0x7350541, 0x73d0542, 0x7450543, 0x74d0544, 0x7550545, 0x7bd0546, 0x7c50547
    .long 0x7cd0548, 0x7d50549, 0x7dd054a, 0x845054b, 0x84d054c, 0x855054d, 0x85d054e, 0x865054f
    .long 0x8cd0550, 0x8d50551, 0x8dd0552, 0x8e50553, 0x8ed0554, 0x9550555, 0x95d0556, 0x9650557
    .long 0x96d0558, 0x9750559, 0x9dd055a, 0x9e5055b, 0x9ed055c, 0x9f5055d, 0x9fd055e, 0xa65055f
    .long 0xa6d0560, 0xa750561, 0xa7d0562, 0xa850563, 0xaed0564, 0xaf50565, 0xafd0566, 0xb050567
    .long 0xb0d0568, 0xb750569, 0xb7d056a, 0xb85056b, 0xb8d056c, 0xb95056d, 0xbfd056e, 0xc05056f
    .long 0xc0d0570, 0xc150571, 0xc1d0572, 0xc850573, 0xc8d0574, 0xc950575, 0xc9d0576, 0xca50577
    .long 0xd0d0578, 0xd150579, 0xd1d057a, 0xd25057b, 0xd2d057c, 0xd95057d, 0xd9d057e, 0xda5057f
    .long 0xdad0580, 0xdb50581, 0xe1d0582, 0xe250583, 0xe2d0584, 0xe350585, 0xe3d0586, 0xea50587
    .long 0xead0588, 0xeb50589, 0xebd058a, 0xec5058b, 0xf2d058c, 0xf35058d, 0xf3d058e, 0xf45058f
    .long 0xf4d0590, 0xfb50591, 0xfbd0592, 0xfc50593, 0xfcd0594, 0xfd50595, 0x103d0596, 0x10450597
    .long 0x104d0598, 0x10550599, 0x105d059a, 0x10c5059b, 0x10cd059c, 0x10d5059d, 0x10dd059e, 0x10e5059f
    .long 0x720780, 0x7a0781, 0xfa0782, 0x1020783, 0x1820784, 0x18a0785, 0x20a0786, 0x2120787
    .long 0x2920788, 0x29a0789, 0x31a078a, 0x322078b, 0x3a2078c, 0x3aa078d, 0x42a078e, 0x432078f
    .long 0x4b20790, 0x4ba0791, 0x53a0792, 0x5420793, 0x5c20794, 0x5ca0795, 0x64a0796, 0x6520797
    .long 0x6d20798, 0x6da0799, 0x75a079a, 0x762079b, 0x7e2079c, 0x7ea079d, 0x86a079e, 0x872079f
    .long 0x8f207a0, 0x8fa07a1, 0x97a07a2, 0x98207a3, 0xa0207a4, 0xa0a07a5, 0xa8a07a6, 0xa9207a7
    .long 0xb1207a8, 0xb1a07a9, 0xb9a07aa, 0xba207ab, 0xc2207ac, 0xc2a07ad, 0xcaa07ae, 0xcb207af
    .long 0xd3207b0, 0xd3a07b1, 0xdba07b2, 0xdc207b3, 0xe4207b4, 0xe4a07b5, 0xeca07b6, 0xed207b7
    .long 0xf5207b8, 0xf5a07b9, 0xfda07ba, 0xfe207bb, 0x106207bc, 0x106a07bd, 0x10ea07be, 0x10f207bf
    .long 0x30100, 0xb0101, 0x130102, 0x8b0103, 0x930104, 0x9b0105, 0x1130106, 0x11b0107
    .long 0x1230108, 0x19b0109, 0x1a3010a, 0x1ab010b, 0x223010c, 0x22b010d, 0x233010e, 0x2ab010f
    .long 0x2b30110, 0x2bb0111, 0x3330112, 0x33b0113, 0x3430114, 0x3bb0115, 0x3c30116, 0x3cb0117
    .long 0x4430118, 0x44b0119, 0x453011a, 0x4cb011b, 0x4d3011c, 0x4db011d, 0x553011e, 0x55b011f
    .long 0x5630120, 0x5db0121, 0x5e30122, 0x5eb0123, 0x6630124, 0x66b0125, 0x6730126, 0x6eb0127
    .long 0x6f30128, 0x6fb0129, 0x773012a, 0x77b012b, 0x783012c, 0x7fb012d, 0x803012e, 0x80b012f
    .long 0x8830130, 0x88b0131, 0x8930132, 0x90b0133, 0x9130134, 0x91b0135, 0x9930136, 0x99b0137
    .long 0x9a30138, 0xa1b0139, 0xa23013a, 0xa2b013b, 0xaa3013c, 0xaab013d, 0xab3013e, 0xb2b013f
    .long 0xb330140, 0xb3b0141, 0xbb30142, 0xbbb0143, 0xbc30144, 0xc3b0145, 0xc430146, 0xc4b0147
    .long 0xcc30148, 0xccb0149, 0xcd3014a, 0xd4b014b, 0xd53014c, 0xd5b014d, 0xdd3014e, 0xddb014f
    .long 0xde30150, 0xe5b0151, 0xe630152, 0xe6b0153, 0xee30154, 0xeeb0155, 0xef30156, 0xf6b0157
    .long 0xf730158, 0xf7b0159, 0xff3015a, 0xffb015b, 0x1003015c, 0x107b015d, 0x1083015e, 0x108b015f
    .long 0x1d0280, 0x250281, 0x2d0282, 0x350283, 0x3d0284, 0xa50285, 0xad0286, 0xb50287
    .long 0xbd0288, 0xc50289, 0x12d028a, 0x135028b, 0x13d028c, 0x145028d, 0x14d028e, 0x1b5028f
    .long 0x1bd0290, 0x1c50291, 0x1cd0292, 0x1d50293, 0x23d0294, 0x2450295, 0x24d0296, 0x2550297
    .long 0x25d0298, 0x2c50299, 0x2cd029a, 0x2d5029b, 0x2dd029c, 0x2e5029d, 0x34d029e, 0x355029f
    .long 0x35d02a0, 0x36502a1, 0x36d02a2, 0x3d502a3, 0x3dd02a4, 0x3e502a5, 0x3ed02a6, 0x3f502a7
    .long 0x45d02a8, 0x46502a9, 0x46d02aa, 0x47502ab, 0x47d02ac, 0x4e502ad, 0x4ed02ae, 0x4f502af
    .long 0x4fd02b0, 0x50502b1, 0x56d02b2, 0x57502b3, 0x57d02b4, 0x58502b5, 0x58d02b6, 0x5f502b7
    .long 0x5fd02b8, 0x60502b9, 0x60d02ba, 0x61502bb, 0x67d02bc, 0x68502bd, 0x68d02be, 0x69502bf
    .long 0x69d02c0, 0x70502c1, 0x70d02c2, 0x71502c3, 0x71d02c4, 0x72502c5, 0x78d02c6, 0x79502c7
    .long 0x79d02c8, 0x7a502c9, 0x7ad02ca, 0x81502cb, 0x81d02cc, 0x82502cd, 0x82d02ce, 0x83502cf
    .long 0x89d02d0, 0x8a502d1, 0x8ad02d2, 0x8b502d3, 0x8bd02d4, 0x92502d5, 0x92d02d6, 0x93502d7
    .long 0x93d02d8, 0x94502d9, 0x9ad02da, 0x9b502db, 0x9bd02dc, 0x9c502dd, 0x9cd02de, 0xa3502df
    .long 0xa3d02e0, 0xa4502e1, 0xa4d02e2, 0xa5502e3, 0xabd02e4, 0xac502e5, 0xacd02e6, 0xad502e7
    .long 0xadd02e8, 0xb4502e9, 0xb4d02ea, 0xb5502eb, 0xb5d02ec, 0xb6502ed, 0xbcd02ee, 0xbd502ef
    .long 0xbdd02f0, 0xbe502f1, 0xbed02f2, 0xc5502f3, 0xc5d02f4, 0xc6502f5, 0xc6d02f6, 0xc7502f7
    .long 0xcdd02f8, 0xce502f9, 0xced02fa, 0xcf502fb, 0xcfd02fc, 0xd6502fd, 0xd6d02fe, 0xd7502ff
    .long 0xd7d0300, 0xd850301, 0xded0302, 0xdf50303, 0xdfd0304, 0xe050305, 0xe0d0306, 0xe750307
    .long 0xe7d0308, 0xe850309, 0xe8d030a, 0xe95030b, 0xefd030c, 0xf05030d, 0xf0d030e, 0xf15030f
    .long 0xf1d0310, 0xf850311, 0xf8d0312, 0xf950313, 0xf9d0314, 0xfa50315, 0x100d0316, 0x10150317
    .long 0x101d0318, 0x10250319, 0x102d031a, 0x1095031b, 0x109d031c, 0x10a5031d, 0x10ad031e, 0x10b5031f
    .long 0x450500, 0x4d0501, 0x550502, 0x5d0503, 0x650504, 0xcd0505, 0xd50506, 0xdd0507
    .long 0xe50508, 0xed0509, 0x155050a, 0x15d050b, 0x165050c, 0x16d050d, 0x175050e, 0x1dd050f
    .long 0x1e50510, 0x1ed0511, 0x1f50512, 0x1fd0513, 0x2650514, 0x26d0515, 0x2750516, 0x27d0517
    .long 0x2850518, 0x2ed0519, 0x2f5051a, 0x2fd051b, 0x305051c, 0x30d051d, 0x375051e, 0x37d051f
    .long 0x3850520, 0x38d0521, 0x3950522, 0x3fd0523, 0x4050524, 0x40d0525, 0x4150526, 0x41d0527
    .long 0x4850528, 0x48d0529, 0x495052a, 0x49d052b, 0x4a5052c, 0x50d052d, 0x515052e, 0x51d052f
    .long 0x5250530, 0x52d0531, 0x5950532, 0x59d0533, 0x5a50534, 0x5ad0535, 0x5b50536, 0x61d0537
    .long 0x6250538, 0x62d0539, 0x635053a, 0x63d053b, 0x6a5053c, 0x6ad053d, 0x6b5053e, 0x6bd053f
    .long 0x6c50540, 0x72d0541, 0x7350542, 0x73d0543, 0x7450544, 0x74d0545, 0x7b50546, 0x7bd0547
    .long 0x7c50548, 0x7cd0549, 0x7d5054a, 0x83d054b, 0x845054c, 0x84d054d, 0x855054e, 0x85d054f
    .long 0x8c50550, 0x8cd0551, 0x8d50552, 0x8dd0553, 0x8e50554, 0x94d0555, 0x9550556, 0x95d0557
    .long 0x9650558, 0x96d0559, 0x9d5055a, 0x9dd055b, 0x9e5055c, 0x9ed055d, 0x9f5055e, 0xa5d055f
    .long 0xa650560, 0xa6d0561, 0xa750562, 0xa7d0563, 0xae50564, 0xaed0565, 0xaf50566, 0xafd0567
    .long 0xb050568, 0xb6d0569, 0xb75056a, 0xb7d056b, 0xb85056c, 0xb8d056d, 0xbf5056e, 0xbfd056f
    .long 0xc050570, 0xc0d0571, 0xc150572, 0xc7d0573, 0xc850574, 0xc8d0575, 0xc950576, 0xc9d0577
    .long 0xd050578, 0xd0d0579, 0xd15057a, 0xd1d057b, 0xd25057c, 0xd8d057d, 0xd95057e, 0xd9d057f
    .long 0xda50580, 0xdad0581, 0xe150582, 0xe1d0583, 0xe250584, 0xe2d0585, 0xe350586, 0xe9d0587
    .long 0xea50588, 0xead0589, 0xeb5058a, 0xebd058b, 0xf25058c, 0xf2d058d, 0xf35058e, 0xf3d058f
    .long 0xf450590, 0xfad0591, 0xfb50592, 0xfbd0593, 0xfc50594, 0xfcd0595, 0x10350596, 0x103d0597
    .long 0x10450598, 0x104d0599, 0x1055059a, 0x10bd059b, 0x10c5059c, 0x10cd059d, 0x10d5059e, 0x10dd059f
    .long 0x6b0780, 0x730781, 0x7b0782, 0xf30783, 0xfb0784, 0x1030785, 0x17b0786, 0x1830787
    .long 0x18b0788, 0x2030789, 0x20b078a, 0x213078b, 0x28b078c, 0x293078d, 0x29b078e, 0x313078f
    .long 0x31b0790, 0x3230791, 0x39b0792, 0x3a30793, 0x3ab0794, 0x4230795, 0x42b0796, 0x4330797
    .long 0x4ab0798, 0x4b30799, 0x4bb079a, 0x533079b, 0x53b079c, 0x543079d, 0x5bb079e, 0x5c3079f
    .long 0x5cb07a0, 0x64307a1, 0x64b07a2, 0x65307a3, 0x6cb07a4, 0x6d307a5, 0x6db07a6, 0x75307a7
    .long 0x75b07a8, 0x76307a9, 0x7db07aa, 0x7e307ab, 0x7eb07ac, 0x86307ad, 0x86b07ae, 0x87307af
    .long 0x8eb07b0, 0x8f307b1, 0x8fb07b2, 0x97307b3, 0x97b07b4, 0x98307b5, 0x9fb07b6, 0xa0307b7
    .long 0xa0b07b8, 0xa8307b9, 0xa8b07ba, 0xa9307bb, 0xb0b07bc, 0xb1307bd, 0xb1b07be, 0xb9307bf
    .long 0xb9b07c0, 0xba307c1, 0xc1b07c2, 0xc2307c3, 0xc2b07c4, 0xca307c5, 0xcab07c6, 0xcb307c7
    .long 0xd2b07c8, 0xd3307c9, 0xd3b07ca, 0xdb307cb, 0xdbb07cc, 0xdc307cd, 0xe3b07ce, 0xe4307cf
    .long 0xe4b07d0, 0xec307d1, 0xecb07d2, 0xed307d3, 0xf4b07d4, 0xf5307d5, 0xf5b07d6, 0xfd307d7
    .long 0xfdb07d8, 0xfe307d9, 0x105b07da, 0x106307db, 0x106b07dc, 0x10e307dd, 0x10eb07de, 0x10f307df
    .long 0x20180, 0xa0181, 0x8a0182, 0x920183, 0x1120184, 0x11a0185, 0x19a0186, 0x1a20187
    .long 0x2220188, 0x22a0189, 0x2aa018a, 0x2b2018b, 0x332018c, 0x33a018d, 0x3ba018e, 0x3c2018f
    .long 0x4420190, 0x44a0191, 0x4ca0192, 0x4d20193, 0x5520194, 0x55a0195, 0x5da0196, 0x5e20197
    .long 0x6620198, 0x66a0199, 0x6ea019a, 0x6f2019b, 0x772019c, 0x77a019d, 0x7fa019e, 0x802019f
    .long 0x88201a0, 0x88a01a1, 0x90a01a2, 0x91201a3, 0x99201a4, 0x99a01a5, 0xa1a01a6, 0xa2201a7
    .long 0xaa201a8, 0xaaa01a9, 0xb2a01aa, 0xb3201ab, 0xbb201ac, 0xbba01ad, 0xc3a01ae, 0xc4201af
    .long 0xcc201b0, 0xcca01b1, 0xd4a01b2, 0xd5201b3, 0xdd201b4, 0xdda01b5, 0xe5a01b6, 0xe6201b7
    .long 0xee201b8, 0xeea01b9, 0xf6a01ba, 0xf7201bb, 0xff201bc, 0xffa01bd, 0x107a01be, 0x108201bf
    .long 0x150280, 0x1d0281, 0x250282, 0x2d0283, 0x350284, 0x9d0285, 0xa50286, 0xad0287
    .long 0xb50288, 0xbd0289, 0x125028a, 0x12d028b, 0x135028c, 0x13d028d, 0x145028e, 0x1ad028f
    .long 0x1b50290, 0x1bd0291, 0x1c50292, 0x1cd0293, 0x2350294, 0x23d0295, 0x2450296, 0x24d0297
    .long 0x2550298, 0x2bd0299, 0x2c5029a, 0x2cd029b, 0x2d5029c, 0x2dd029d, 0x345029e, 0x34d029f
    .long 0x35502a0, 0x35d02a1, 0x36502a2, 0x3cd02a3, 0x3d502a4, 0x3dd02a5, 0x3e502a6, 0x3ed02a7
    .long 0x45502a8, 0x45d02a9, 0x46502aa, 0x46d02ab, 0x47502ac, 0x4dd02ad, 0x4e502ae, 0x4ed02af
    .long 0x4f502b0, 0x4fd02b1, 0x56502b2, 0x56d02b3, 0x57502b4, 0x57d02b5, 0x58502b6, 0x5ed02b7
    .long 0x5f502b8, 0x5fd02b9, 0x60502ba, 0x60d02bb, 0x67502bc, 0x67d02bd, 0x68502be, 0x68d02bf
    .long 0x69502c0, 0x6fd02c1, 0x70502c2, 0x70d02c3, 0x71502c4, 0x71d02c5, 0x78502c6, 0x78d02c7
    .long 0x79502c8, 0x79d02c9, 0x7a502ca, 0x80d02cb, 0x81502cc, 0x81d02cd, 0x82502ce, 0x82d02cf
    .long 0x89502d0, 0x89d02d1, 0x8a502d2, 0x8ad02d3, 0x8b502d4, 0x91d02d5, 0x92502d6, 0x92d02d7
    .long 0x93502d8, 0x93d02d9, 0x9a502da, 0x9ad02db, 0x9b502dc, 0x9bd02dd, 0x9c502de, 0xa2d02df
    .long 0xa3502e0, 0xa3d02e1, 0xa4502e2, 0xa4d02e3, 0xab502e4, 0xabd02e5, 0xac502e6, 0xacd02e7
    .long 0xad502e8, 0xb3d02e9, 0xb4502ea, 0xb4d02eb, 0xb5502ec, 0xb5d02ed, 0xbc502ee, 0xbcd02ef
    .long 0xbd502f0, 0xbdd02f1, 0xbe502f2, 0xc4d02f3, 0xc5502f4, 0xc5d02f5, 0xc6502f6, 0xc6d02f7
    .long 0xcd502f8, 0xcdd02f9, 0xce502fa, 0xced02fb, 0xcf502fc, 0xd5d02fd, 0xd6502fe, 0xd6d02ff
    .long 0xd750300, 0xd7d0301, 0xde50302, 0xded0303, 0xdf50304, 0xdfd0305, 0xe050306, 0xe6d0307
    .long 0xe750308, 0xe7d0309, 0xe85030a, 0xe8d030b, 0xef5030c, 0xefd030d, 0xf05030e, 0xf0d030f
    .long 0xf150310, 0xf7d0311, 0xf850312, 0xf8d0313, 0xf950314, 0xf9d0315, 0x10050316, 0x100d0317
    .long 0x10150318, 0x101d0319, 0x1025031a, 0x108d031b, 0x1095031c, 0x109d031d, 0x10a5031e, 0x10ad031f
    .long 0x3d0500, 0x450501, 0x4d0502, 0x550503, 0x5d0504, 0xc50505, 0xcd0506, 0xd50507
    .long 0xdd0508, 0xe50509, 0x14d050a, 0x155050b, 0x15d050c, 0x165050d, 0x16d050e, 0x1d5050f
    .long 0x1dd0510, 0x1e50511, 0x1ed0512, 0x1f50513, 0x25d0514, 0x2650515, 0x26d0516, 0x2750517
    .long 0x27d0518, 0x2e50519, 0x2ed051a, 0x2f5051b, 0x2fd051c, 0x305051d, 0x36d051e, 0x375051f
    .long 0x37d0520, 0x3850521, 0x38d0522, 0x3f50523, 0x3fd0524, 0x4050525, 0x40d0526, 0x4150527
    .long 0x47d0528, 0x4850529, 0x48d052a, 0x495052b, 0x49d052c, 0x505052d, 0x50d052e, 0x515052f
    .long 0x51d0530, 0x5250531, 0x58d0532, 0x5950533, 0x59d0534, 0x5a50535, 0x5ad0536, 0x6150537
    .long 0x61d0538, 0x6250539, 0x62d053a, 0x635053b, 0x69d053c, 0x6a5053d, 0x6ad053e, 0x6b5053f
    .long 0x6bd0540, 0x7250541, 0x72d0542, 0x7350543, 0x73d0544, 0x7450545, 0x7ad0546, 0x7b50547
    .long 0x7bd0548, 0x7c50549, 0x7cd054a, 0x835054b, 0x83d054c, 0x845054d, 0x84d054e, 0x855054f
    .long 0x8bd0550, 0x8c50551, 0x8cd0552, 0x8d50553, 0x8dd0554, 0x9450555, 0x94d0556, 0x9550557
    .long 0x95d0558, 0x9650559, 0x9cd055a, 0x9d5055b, 0x9dd055c, 0x9e5055d, 0x9ed055e, 0xa55055f
    .long 0xa5d0560, 0xa650561, 0xa6d0562, 0xa750563, 0xadd0564, 0xae50565, 0xaed0566, 0xaf50567
    .long 0xafd0568, 0xb650569, 0xb6d056a, 0xb75056b, 0xb7d056c, 0xb85056d, 0xbed056e, 0xbf5056f
    .long 0xbfd0570, 0xc050571, 0xc0d0572, 0xc750573, 0xc7d0574, 0xc850575, 0xc8d0576, 0xc950577
    .long 0xcfd0578, 0xd050579, 0xd0d057a, 0xd15057b, 0xd1d057c, 0xd85057d, 0xd8d057e, 0xd95057f
    .long 0xd9d0580, 0xda50581, 0xe0d0582, 0xe150583, 0xe1d0584, 0xe250585, 0xe2d0586, 0xe950587
    .long 0xe9d0588, 0xea50589, 0xead058a, 0xeb5058b, 0xf1d058c, 0xf25058d, 0xf2d058e, 0xf35058f
    .long 0xf3d0590, 0xfa50591, 0xfad0592, 0xfb50593, 0xfbd0594, 0xfc50595, 0x102d0596, 0x10350597
    .long 0x103d0598, 0x10450599, 0x104d059a, 0x10b5059b, 0x10bd059c, 0x10c5059d, 0x10cd059e, 0x10d5059f
    .long 0x640780, 0x6c0781, 0x740782, 0x7c0783, 0xec0784, 0xf40785, 0xfc0786, 0x1040787
    .long 0x1740788, 0x17c0789, 0x184078a, 0x18c078b, 0x1fc078c, 0x204078d, 0x20c078e, 0x214078f
    .long 0x2840790, 0x28c0791, 0x2940792, 0x29c0793, 0x30c0794, 0x3140795, 0x31c0796, 0x3240797
    .long 0x3940798, 0x39c0799, 0x3a4079a, 0x3ac079b, 0x41c079c, 0x424079d, 0x42c079e, 0x434079f
    .long 0x4a407a0, 0x4ac07a1, 0x4b407a2, 0x4bc07a3, 0x52c07a4, 0x53407a5, 0x53c07a6, 0x54407a7
    .long 0x5b407a8, 0x5bc07a9, 0x5c407aa, 0x5cc07ab, 0x63c07ac, 0x64407ad, 0x64c07ae, 0x65407af
    .long 0x6c407b0, 0x6cc07b1, 0x6d407b2, 0x6dc07b3, 0x74c07b4, 0x75407b5, 0x75c07b6, 0x76407b7
    .long 0x7d407b8, 0x7dc07b9, 0x7e407ba, 0x7ec07bb, 0x85c07bc, 0x86407bd, 0x86c07be, 0x87407bf
    .long 0x8e407c0, 0x8ec07c1, 0x8f407c2, 0x8fc07c3, 0x96c07c4, 0x97407c5, 0x97c07c6, 0x98407c7
    .long 0x9f407c8, 0x9fc07c9, 0xa0407ca, 0xa0c07cb, 0xa7c07cc, 0xa8407cd, 0xa8c07ce, 0xa9407cf
    .long 0xb0407d0, 0xb0c07d1, 0xb1407d2, 0xb1c07d3, 0xb8c07d4, 0xb9407d5, 0xb9c07d6, 0xba407d7
    .long 0xc1407d8, 0xc1c07d9, 0xc2407da, 0xc2c07db, 0xc9c07dc, 0xca407dd, 0xcac07de, 0xcb407df
    .long 0xd2407e0, 0xd2c07e1, 0xd3407e2, 0xd3c07e3, 0xdac07e4, 0xdb407e5, 0xdbc07e6, 0xdc407e7
    .long 0xe3407e8, 0xe3c07e9, 0xe4407ea, 0xe4c07eb, 0xebc07ec, 0xec407ed, 0xecc07ee, 0xed407ef
    .long 0xf4407f0, 0xf4c07f1, 0xf5407f2, 0xf5c07f3, 0xfcc07f4, 0xfd407f5, 0xfdc07f6, 0xfe407f7
    .long 0x105407f8, 0x105c07f9, 0x106407fa, 0x106c07fb, 0x10dc07fc, 0x10e407fd, 0x10ec07fe, 0x10f407ff
    .long 0x10200, 0x890201, 0x1110202, 0x1990203, 0x2210204, 0x2a90205, 0x3310206, 0x3b90207
    .long 0x4410208, 0x4c90209, 0x551020a, 0x5d9020b, 0x661020c, 0x6e9020d, 0x771020e, 0x7f9020f
    .long 0x8810210, 0x9090211, 0x9910212, 0xa190213, 0xaa10214, 0xb290215, 0xbb10216, 0xc390217
    .long 0xcc10218, 0xd490219, 0xdd1021a, 0xe59021b, 0xee1021c, 0xf69021d, 0xff1021e, 0x1079021f
    .long 0xd0280, 0x150281, 0x1d0282, 0x250283, 0x2d0284, 0x950285, 0x9d0286, 0xa50287
    .long 0xad0288, 0xb50289, 0x11d028a, 0x125028b, 0x12d028c, 0x135028d, 0x13d028e, 0x1a5028f
    .long 0x1ad0290, 0x1b50291, 0x1bd0292, 0x1c50293, 0x22d0294, 0x2350295, 0x23d0296, 0x2450297
    .long 0x24d0298, 0x2b50299, 0x2bd029a, 0x2c5029b, 0x2cd029c, 0x2d5029d, 0x33d029e, 0x345029f
    .long 0x34d02a0, 0x35502a1, 0x35d02a2, 0x3c502a3, 0x3cd02a4, 0x3d502a5, 0x3dd02a6, 0x3e502a7
    .long 0x44d02a8, 0x45502a9, 0x45d02aa, 0x46502ab, 0x46d02ac, 0x4d502ad, 0x4dd02ae, 0x4e502af
    .long 0x4ed02b0, 0x4f502b1, 0x55d02b2, 0x56502b3, 0x56d02b4, 0x57502b5, 0x57d02b6, 0x5e502b7
    .long 0x5ed02b8, 0x5f502b9, 0x5fd02ba, 0x60502bb, 0x66d02bc, 0x67502bd, 0x67d02be, 0x68502bf
    .long 0x68d02c0, 0x6f502c1, 0x6fd02c2, 0x70502c3, 0x70d02c4, 0x71502c5, 0x77d02c6, 0x78502c7
    .long 0x78d02c8, 0x79502c9, 0x79d02ca, 0x80502cb, 0x80d02cc, 0x81502cd, 0x81d02ce, 0x82502cf
    .long 0x88d02d0, 0x89502d1, 0x89d02d2, 0x8a502d3, 0x8ad02d4, 0x91502d5, 0x91d02d6, 0x92502d7
    .long 0x92d02d8, 0x93502d9, 0x99d02da, 0x9a502db, 0x9ad02dc, 0x9b502dd, 0x9bd02de, 0xa2502df
    .long 0xa2d02e0, 0xa3502e1, 0xa3d02e2, 0xa4502e3, 0xaad02e4, 0xab502e5, 0xabd02e6, 0xac502e7
    .long 0xacd02e8, 0xb3502e9, 0xb3d02ea, 0xb4502eb, 0xb4d02ec, 0xb5502ed, 0xbbd02ee, 0xbc502ef
    .long 0xbcd02f0, 0xbd502f1, 0xbdd02f2, 0xc4502f3, 0xc4d02f4, 0xc5502f5, 0xc5d02f6, 0xc6502f7
    .long 0xccd02f8, 0xcd502f9, 0xcdd02fa, 0xce502fb, 0xced02fc, 0xd5502fd, 0xd5d02fe, 0xd6502ff
    .long 0xd6d0300, 0xd750301, 0xddd0302, 0xde50303, 0xded0304, 0xdf50305, 0xdfd0306, 0xe650307
    .long 0xe6d0308, 0xe750309, 0xe7d030a, 0xe85030b, 0xeed030c, 0xef5030d, 0xefd030e, 0xf05030f
    .long 0xf0d0310, 0xf750311, 0xf7d0312, 0xf850313, 0xf8d0314, 0xf950315, 0xffd0316, 0x10050317
    .long 0x100d0318, 0x10150319, 0x101d031a, 0x1085031b, 0x108d031c, 0x1095031d, 0x109d031e, 0x10a5031f
    .long 0x350500, 0x3d0501, 0x450502, 0x4d0503, 0x550504, 0xbd0505, 0xc50506, 0xcd0507
    .long 0xd50508, 0xdd0509, 0x145050a, 0x14d050b, 0x155050c, 0x15d050d, 0x165050e, 0x1cd050f
    .long 0x1d50510, 0x1dd0511, 0x1e50512, 0x1ed0513, 0x2550514, 0x25d0515, 0x2650516, 0x26d0517
    .long 0x2750518, 0x2dd0519, 0x2e5051a, 0x2ed051b, 0x2f5051c, 0x2fd051d, 0x365051e, 0x36d051f
    .long 0x3750520, 0x37d0521, 0x3850522, 0x3ed0523, 0x3f50524, 0x3fd0525, 0x4050526, 0x40d0527
    .long 0x4750528, 0x47d0529, 0x485052a, 0x48d052b, 0x495052c, 0x4fd052d, 0x505052e, 0x50d052f
    .long 0x5150530, 0x51d0531, 0x5850532, 0x58d0533, 0x5950534, 0x59d0535, 0x5a50536, 0x60d0537
    .long 0x6150538, 0x61d0539, 0x625053a, 0x62d053b, 0x695053c, 0x69d053d, 0x6a5053e, 0x6ad053f
    .long 0x6b50540, 0x71d0541, 0x7250542, 0x72d0543, 0x7350544, 0x73d0545, 0x7a50546, 0x7ad0547
    .long 0x7b50548, 0x7bd0549, 0x7c5054a, 0x82d054b, 0x835054c, 0x83d054d, 0x845054e, 0x84d054f
    .long 0x8b50550, 0x8bd0551, 0x8c50552, 0x8cd0553, 0x8d50554, 0x93d0555, 0x9450556, 0x94d0557
    .long 0x9550558, 0x95d0559, 0x9c5055a, 0x9cd055b, 0x9d5055c, 0x9dd055d, 0x9e5055e, 0xa4d055f
    .long 0xa550560, 0xa5d0561, 0xa650562, 0xa6d0563, 0xad50564, 0xadd0565, 0xae50566, 0xaed0567
    .long 0xaf50568, 0xb5d0569, 0xb65056a, 0xb6d056b, 0xb75056c, 0xb7d056d, 0xbe5056e, 0xbed056f
    .long 0xbf50570, 0xbfd0571, 0xc050572, 0xc6d0573, 0xc750574, 0xc7d0575, 0xc850576, 0xc8d0577
    .long 0xcf50578, 0xcfd0579, 0xd05057a, 0xd0d057b, 0xd15057c, 0xd7d057d, 0xd85057e, 0xd8d057f
    .long 0xd950580, 0xd9d0581, 0xe050582, 0xe0d0583, 0xe150584, 0xe1d0585, 0xe250586, 0xe8d0587
    .long 0xe950588, 0xe9d0589, 0xea5058a, 0xead058b, 0xf15058c, 0xf1d058d, 0xf25058e, 0xf2d058f
    .long 0xf350590, 0xf9d0591, 0xfa50592, 0xfad0593, 0xfb50594, 0xfbd0595, 0x10250596, 0x102d0597
    .long 0x10350598, 0x103d0599, 0x1045059a, 0x10ad059b, 0x10b5059c, 0x10bd059d, 0x10c5059e, 0x10cd059f
    .long 0x5d0780, 0x650781, 0x6d0782, 0x750783, 0x7d0784, 0xe50785, 0xed0786, 0xf50787
    .long 0xfd0788, 0x1050789, 0x16d078a, 0x175078b, 0x17d078c, 0x185078d, 0x18d078e, 0x1f5078f
    .long 0x1fd0790, 0x2050791, 0x20d0792, 0x2150793, 0x27d0794, 0x2850795, 0x28d0796, 0x2950797
    .long 0x29d0798, 0x3050799, 0x30d079a, 0x315079b, 0x31d079c, 0x325079d, 0x38d079e, 0x395079f
    .long 0x39d07a0, 0x3a507a1, 0x3ad07a2, 0x41507a3, 0x41d07a4, 0x42507a5, 0x42d07a6, 0x43507a7
    .long 0x49d07a8, 0x4a507a9, 0x4ad07aa, 0x4b507ab, 0x4bd07ac, 0x52507ad, 0x52d07ae, 0x53507af
    .long 0x53d07b0, 0x54507b1, 0x5ad07b2, 0x5b507b3, 0x5bd07b4, 0x5c507b5, 0x5cd07b6, 0x63507b7
    .long 0x63d07b8, 0x64507b9, 0x64d07ba, 0x65507bb, 0x6bd07bc, 0x6c507bd, 0x6cd07be, 0x6d507bf
    .long 0x6dd07c0, 0x74507c1, 0x74d07c2, 0x75507c3, 0x75d07c4, 0x76507c5, 0x7cd07c6, 0x7d507c7
    .long 0x7dd07c8, 0x7e507c9, 0x7ed07ca, 0x85507cb, 0x85d07cc, 0x86507cd, 0x86d07ce, 0x87507cf
    .long 0x8dd07d0, 0x8e507d1, 0x8ed07d2, 0x8f507d3, 0x8fd07d4, 0x96507d5, 0x96d07d6, 0x97507d7
    .long 0x97d07d8, 0x98507d9, 0x9ed07da, 0x9f507db, 0x9fd07dc, 0xa0507dd, 0xa0d07de, 0xa7507df
    .long 0xa7d07e0, 0xa8507e1, 0xa8d07e2, 0xa9507e3, 0xafd07e4, 0xb0507e5, 0xb0d07e6, 0xb1507e7
    .long 0xb1d07e8, 0xb8507e9, 0xb8d07ea, 0xb9507eb, 0xb9d07ec, 0xba507ed, 0xc0d07ee, 0xc1507ef
    .long 0xc1d07f0, 0xc2507f1, 0xc2d07f2, 0xc9507f3, 0xc9d07f4, 0xca507f5, 0xcad07f6, 0xcb507f7
    .long 0xd1d07f8, 0xd2507f9, 0xd2d07fa, 0xd3507fb, 0xd3d07fc, 0xda507fd, 0xdad07fe, 0xdb507ff
    .long 0xdbd0800, 0xdc50801, 0xe2d0802, 0xe350803, 0xe3d0804, 0xe450805, 0xe4d0806, 0xeb50807
    .long 0xebd0808, 0xec50809, 0xecd080a, 0xed5080b, 0xf3d080c, 0xf45080d, 0xf4d080e, 0xf55080f
    .long 0xf5d0810, 0xfc50811, 0xfcd0812, 0xfd50813, 0xfdd0814, 0xfe50815, 0x104d0816, 0x10550817
    .long 0x105d0818, 0x10650819, 0x106d081a, 0x10d5081b, 0x10dd081c, 0x10e5081d, 0x10ed081e, 0x10f5081f
    .size L_qtab, 10240

.section .rodata,"a"
.p2align 6
.amdhsa_kernel sequential_preLN__sliding_block__dense_activation_squared_relu__prompt_kernel
  .amdhsa_next_free_vgpr 496
  .amdhsa_next_free_sgpr 102
  .amdhsa_accum_offset 256
  .amdhsa_group_segment_fixed_size 0
  .amdhsa_kernarg_size 88
  .amdhsa_user_sgpr_count 2
  .amdhsa_user_sgpr_kernarg_segment_ptr 1
  .amdhsa_system_sgpr_workgroup_id_x 1
.end_amdhsa_kernel
```
